```python
import torch

def _softmax(x, axis=-1):
    return torch.softmax(x, dim=axis)

def _gelu(x):
    return torch.nn.functional.gelu(x, approximate='tanh')

def _silu(x):
    return torch.nn.functional.silu(x)

def _sigmoid(x):
    return torch.sigmoid(x)

def _layernorm(x, axis=-1, eps=1e-05):
    m = x.mean(dim=axis, keepdim=True)
    v = x.var(dim=axis, keepdim=True, unbiased=False)
    return (x - m) / torch.sqrt(v + eps)

def _scatter_add(tgt, idx, src, axis=0):
    return tgt.clone().index_add_(axis, idx, src)

def _segment_sum(src, seg, n):
    out = torch.zeros((n,) + src.shape[1:], dtype=src.dtype)
    return out.index_add_(0, seg, src)

def _pad(x, pw):
    flat = tuple((v for pair in reversed(pw) for v in pair))
    return torch.nn.functional.pad(x, flat)
kernel_name = 'adaLN_cond__sliding_block__mixer_channel_mlp__prompt'

def setup_inputs():

    _w = lambda a: (lambda t: t.to(torch.bfloat16) if t.is_floating_point() else t)(torch.as_tensor(a))

    def _A_setup():
        B, S, D = (1, 2048, 640)
        return {'x': _w((lambda *s: torch.randn(*s, dtype=torch.bfloat16) * 0.05)(B, S, D)), 'wqkv': _w((lambda *s: torch.randn(*s, dtype=torch.bfloat16) * 0.05)(D, 3 * D)), 'wo': _w((lambda *s: torch.randn(*s, dtype=torch.bfloat16) * 0.05)(D, D))}
    _A_in = _A_setup()

    def _B_setup():
        B, S, D, F = (1, 2048, 640, 1536)
        return {'x': _w((lambda *s: torch.randn(*s, dtype=torch.bfloat16) * 0.05)(B, S, D)), 'w1': _w((lambda *s: torch.randn(*s, dtype=torch.bfloat16) * 3.2)(D, F) * D ** (-0.5)), 'b1': _w((lambda *s: torch.randn(*s, dtype=torch.bfloat16) * 1.6)(F)), 'w2': _w((lambda *s: torch.randn(*s, dtype=torch.bfloat16) * 0.4)(F, D) * F ** (-0.5)), 'b2': _w((lambda *s: torch.randn(*s, dtype=torch.bfloat16) * 0.8)(D))}
    _B_in = _B_setup()
    return {'A_x': _A_in['x'], 'A_wqkv': _A_in['wqkv'], 'A_wo': _A_in['wo'], 'B_x': _B_in['x'], 'B_w1': _B_in['w1'], 'B_b1': _B_in['b1'], 'B_w2': _B_in['w2'], 'B_b2': _B_in['b2'], 'c': _w((lambda *s: torch.randn(*s, dtype=torch.bfloat16) * 0.1)(1, 640) * 8.0), 'w_mod': _w((lambda *s: torch.randn(*s, dtype=torch.bfloat16) * 0.1)(640, 6 * 640) * 640 ** (-0.5) * 8.0)}

def reference(A_x, A_wqkv, A_wo, B_x, B_w1, B_b1, B_w2, B_b2, c, w_mod):

    def _A_ref(x, wqkv, wo):
        B, S, D = x.shape
        H = 32
        Dh = D // H
        W = 256
        qkv = (lambda x, *d: x.permute(*d))((x @ wqkv).reshape(B, S, 3, H, Dh), 2, 0, 3, 1, 4)
        q, k, v = (qkv[0], qkv[1], qkv[2])
        scores = torch.einsum('bhqd,bhkd->bhqk', q, k) * Dh ** (-0.5)
        idx = torch.arange(S)
        mask = (idx[:, None] - idx[None, :] >= 0) & (idx[:, None] - idx[None, :] < W)
        scores = torch.where(mask[None, None], scores, -1000000000.0)
        p = _softmax(scores, axis=-1)
        o = torch.einsum('bhqk,bhkd->bhqd', p, v)
        return (lambda x, *d: x.permute(*d))(o, 0, 2, 1, 3).reshape(B, S, D) @ wo

    def _B_ref(x, w1, b1, w2, b2):
        y = _layernorm(x, axis=-1)
        h = _gelu(torch.einsum('bsd,df->bsf', y, w1) + b1)
        return torch.einsum('bsf,fd->bsd', h, w2) + b2
    x = A_x
    mod = (_silu(c) @ w_mod).reshape(c.shape[0], 6, 1, -1)
    sa, ca, ga, sb, cb, gb = (mod[:, 0].clone(), mod[:, 1].clone(), mod[:, 2].clone(), mod[:, 3].clone(), mod[:, 4].clone(), mod[:, 5].clone())
    h = _layernorm(x, axis=-1) * (1 + ca) + sa
    x = x + ga * _A_ref(h, A_wqkv, A_wo)
    h = _layernorm(x, axis=-1) * (1 + cb) + sb
    x = x + gb * _B_ref(h, B_w1, B_b1, B_w2, B_b2)
    return x
```

```asm
; @launch grid=(256,1,1) block=(256,1,1) lds=163840
.amdgcn_target "amdgcn-amd-amdhsa--gfx950"
.text
.globl adaLN_cond__sliding_block__mixer_channel_mlp__prompt_kernel
.p2align 8
.type adaLN_cond__sliding_block__mixer_channel_mlp__prompt_kernel,@function
adaLN_cond__sliding_block__mixer_channel_mlp__prompt_kernel:
L_code_begin:
s_cmp_ge_u32 s2, 256
s_cbranch_scc1 L_end
s_load_dwordx16 s[16:31], s[0:1], 0
s_load_dwordx8 s[32:39], s[0:1], 64
s_load_dwordx2 s[40:41], s[0:1], 96
s_getpc_b64 s[64:65]
L_pc:
s_add_u32 s64, s64, L_code_begin-L_pc
s_addc_u32 s65, s65, -1
v_and_b32 v1, 63, v0
v_lshrrev_b32 v2, 6, v0
s_lshr_b32 s3, s2, 3
v_readfirstlane_b32 s4, v2
s_and_b32 s13, s2, 7
s_nop 2
s_cmp_lg_u32 s4, 3
s_cbranch_scc1 L_nopf
s_lshl_b32 s14, s3, 6
v_add_u32 v3, s14, v1
v_lshlrev_b32 v3, 6, v3
v_min_u32 v3, L_code_end-L_code_begin-4, v3
global_load_dword v248, v3, s[64:65]
L_nopf:
s_lshr_b32 s14, s13, 2
s_lshl_b32 s14, s14, 3
s_and_b32 s15, s3, 7
s_add_u32 s7, s14, s15
s_and_b32 s14, s13, 3
s_lshl_b32 s14, s14, 2
s_lshr_b32 s15, s3, 3
s_add_u32 s6, s14, s15
s_lshr_b32 s14, s13, 1
s_lshl_b32 s14, s14, 3
s_and_b32 s15, s3, 7
s_add_u32 s8, s14, s15
s_and_b32 s14, s13, 1
s_lshl_b32 s14, s14, 2
s_lshr_b32 s15, s3, 3
s_add_u32 s9, s14, s15
s_lshr_b32 s14, s13, 1
s_lshl_b32 s14, s14, 2
s_and_b32 s15, s3, 3
s_add_u32 s10, s14, s15
s_and_b32 s14, s13, 1
s_lshl_b32 s14, s14, 3
s_lshr_b32 s15, s3, 2
s_add_u32 s11, s14, s15
s_waitcnt lgkmcnt(0)
s_mov_b32 s22, s64
s_mov_b32 s23, s65
s_mov_b32 s44, s40
s_mov_b32 s45, s41
s_mov_b32 s46, 0x10000000
s_mov_b32 s47, 0x00020000
s_mov_b32 s60, s38
s_mov_b32 s61, s39
s_mov_b32 s62, 0x100
s_mov_b32 s63, 0x00020000
s_cmp_lg_u32 s2, 0
s_cbranch_scc1 L_noep
s_cmp_lg_u32 s4, 0
s_cbranch_scc1 L_noep
s_memrealtime s[66:67]
s_waitcnt lgkmcnt(0)
s_or_b32 s66, s66, 1
v_mov_b32 v3, s66
v_mov_b32 v4, 0
s_mov_b64 exec, 1
buffer_store_dword v3, v4, s[60:63], 0 offen sc1
s_mov_b64 exec, -1
L_noep:
s_mov_b32 s72, s18
s_mov_b32 s73, s19
s_mov_b32 s74, 0x258000
s_mov_b32 s75, 0x00020000
s_mov_b32 s48, s32
s_mov_b32 s49, s33
s_mov_b32 s50, 0x500
s_mov_b32 s51, 0x00020000
s_mov_b32 s52, s34
s_mov_b32 s53, s35
s_mov_b32 s54, 0x4b0000
s_mov_b32 s55, 0x00020000
s_mov_b32 s56, s16
s_mov_b32 s57, s17
s_mov_b32 s58, 0x280000
s_mov_b32 s59, 0x00020000
v_and_b32 v2, 7, v1
v_lshrrev_b32 v3, 3, v1
s_mul_hi_u32 s12, s2, 71582789
s_mul_i32 s13, s12, 60
s_sub_u32 s13, s2, s13
s_mul_i32 s14, s12, 160
s_mul_i32 s15, s4, 40
s_add_u32 s14, s14, s15
v_add_u32 v4, s14, v3
v_lshlrev_b32 v5, 1, v4
s_movk_i32 s15, 7680
v_mul_lo_u32 v6, v4, s15
s_lshl_b32 s15, s13, 7
v_lshl_add_u32 v7, v2, 4, s15
v_add_u32 v6, v6, v7
buffer_load_ushort v8, v5, s[48:51], 0 offen offset:0
buffer_load_ushort v9, v5, s[48:51], 0 offen offset:16
buffer_load_ushort v10, v5, s[48:51], 0 offen offset:32
buffer_load_ushort v11, v5, s[48:51], 0 offen offset:48
buffer_load_ushort v12, v5, s[48:51], 0 offen offset:64
s_mov_b32 s15, 0
buffer_load_dwordx4 v[16:19], v6, s[52:55], s15 offen
s_mov_b32 s15, 61440
buffer_load_dwordx4 v[20:23], v6, s[52:55], s15 offen
s_mov_b32 s15, 122880
buffer_load_dwordx4 v[24:27], v6, s[52:55], s15 offen
s_mov_b32 s15, 184320
buffer_load_dwordx4 v[28:31], v6, s[52:55], s15 offen
s_mov_b32 s15, 245760
buffer_load_dwordx4 v[32:35], v6, s[52:55], s15 offen
s_lshl_b32 s14, s2, 3
v_add_u32 v7, s14, v2
s_movk_i32 s15, 1280
v_mul_lo_u32 v7, v7, s15
s_mul_i32 s15, s4, 20
v_add_u32 v13, s15, v3
v_lshl_add_u32 v7, v13, 4, v7
v_add_u32 v14, 256, v7
v_cmp_gt_u32 vcc, 4, v3
v_mov_b32 v15, 0x7f000000
s_nop 0
v_cndmask_b32 v14, v15, v14, vcc
buffer_load_dwordx4 v[36:39], v7, s[56:59], 0 offen
buffer_load_dwordx4 v[40:43], v7, s[56:59], 0 offen offset:128
buffer_load_dwordx4 v[44:47], v14, s[56:59], 0 offen
s_sub_u32 s70, s2, 96
s_and_b32 s71, s70, 3
s_lshr_b32 s70, s70, 2
s_mul_i32 s14, s71, 320
s_mul_i32 s15, s70, 61440
s_add_u32 s14, s14, s15
s_cmp_ge_u32 s2, 96
s_cselect_b32 s14, s14, 0x7f000000
s_lshl_b32 s15, s4, 10
v_add_u32 v56, 0, v0
v_mul_u32_u24 v57, 1093, v56
v_lshrrev_b32 v57, 16, v57
v_mul_u32_u24 v58, 60, v57
v_sub_u32 v58, v56, v58
v_mul_u32_u24 v59, 3277, v58
v_lshrrev_b32 v59, 16, v59
v_mul_u32_u24 v13, 20, v59
v_sub_u32 v58, v58, v13
v_mul_u32_u24 v57, 3840, v57
v_mul_u32_u24 v59, 1280, v59
v_lshl_add_u32 v57, v58, 4, v57
v_add_u32 v60, v57, v59
v_add_u32 v56, 256, v0
v_mul_u32_u24 v57, 1093, v56
v_lshrrev_b32 v57, 16, v57
v_mul_u32_u24 v58, 60, v57
v_sub_u32 v58, v56, v58
v_mul_u32_u24 v59, 3277, v58
v_lshrrev_b32 v59, 16, v59
v_mul_u32_u24 v13, 20, v59
v_sub_u32 v58, v58, v13
v_mul_u32_u24 v57, 3840, v57
v_mul_u32_u24 v59, 1280, v59
v_lshl_add_u32 v57, v58, 4, v57
v_add_u32 v61, v57, v59
v_add_u32 v56, 512, v0
v_mul_u32_u24 v57, 1093, v56
v_lshrrev_b32 v57, 16, v57
v_mul_u32_u24 v58, 60, v57
v_sub_u32 v58, v56, v58
v_mul_u32_u24 v59, 3277, v58
v_lshrrev_b32 v59, 16, v59
v_mul_u32_u24 v13, 20, v59
v_sub_u32 v58, v58, v13
v_mul_u32_u24 v57, 3840, v57
v_mul_u32_u24 v59, 1280, v59
v_lshl_add_u32 v57, v58, 4, v57
v_add_u32 v62, v57, v59
v_add_u32 v56, 768, v0
v_mul_u32_u24 v57, 1093, v56
v_lshrrev_b32 v57, 16, v57
v_mul_u32_u24 v58, 60, v57
v_sub_u32 v58, v56, v58
v_mul_u32_u24 v59, 3277, v58
v_lshrrev_b32 v59, 16, v59
v_mul_u32_u24 v13, 20, v59
v_sub_u32 v58, v58, v13
v_mul_u32_u24 v57, 3840, v57
v_mul_u32_u24 v59, 1280, v59
v_lshl_add_u32 v57, v58, 4, v57
v_add_u32 v63, v57, v59
v_mov_b32 v13, 0x7f000000
v_cmp_gt_u32 vcc, 192, v0
s_nop 1
v_cndmask_b32 v63, v13, v63, vcc
s_add_u32 m0, s15, 0
s_nop 0
buffer_load_dwordx4 v60, s[72:75], s14 offen lds
s_add_u32 m0, s15, 4096
s_nop 0
buffer_load_dwordx4 v61, s[72:75], s14 offen lds
s_add_u32 m0, s15, 8192
s_nop 0
buffer_load_dwordx4 v62, s[72:75], s14 offen lds
s_add_u32 m0, s15, 12288
s_nop 0
buffer_load_dwordx4 v63, s[72:75], s14 offen lds
s_waitcnt vmcnt(12)
v_lshlrev_b32 v8, 16, v8
v_mul_f32 v13, 0xbfb8aa3b, v8
v_exp_f32 v13, v13
s_nop 0
v_add_f32 v13, 1.0, v13
v_rcp_f32 v13, v13
s_nop 0
v_mul_f32 v13, v8, v13
v_cvt_pk_bf16_f32 v13, v13, v13
v_lshlrev_b32 v8, 16, v13
v_lshlrev_b32 v9, 16, v9
v_mul_f32 v13, 0xbfb8aa3b, v9
v_exp_f32 v13, v13
s_nop 0
v_add_f32 v13, 1.0, v13
v_rcp_f32 v13, v13
s_nop 0
v_mul_f32 v13, v9, v13
v_cvt_pk_bf16_f32 v13, v13, v13
v_lshlrev_b32 v9, 16, v13
v_lshlrev_b32 v10, 16, v10
v_mul_f32 v13, 0xbfb8aa3b, v10
v_exp_f32 v13, v13
s_nop 0
v_add_f32 v13, 1.0, v13
v_rcp_f32 v13, v13
s_nop 0
v_mul_f32 v13, v10, v13
v_cvt_pk_bf16_f32 v13, v13, v13
v_lshlrev_b32 v10, 16, v13
v_lshlrev_b32 v11, 16, v11
v_mul_f32 v13, 0xbfb8aa3b, v11
v_exp_f32 v13, v13
s_nop 0
v_add_f32 v13, 1.0, v13
v_rcp_f32 v13, v13
s_nop 0
v_mul_f32 v13, v11, v13
v_cvt_pk_bf16_f32 v13, v13, v13
v_lshlrev_b32 v11, 16, v13
v_lshlrev_b32 v12, 16, v12
v_mul_f32 v13, 0xbfb8aa3b, v12
v_exp_f32 v13, v13
s_nop 0
v_add_f32 v13, 1.0, v13
v_rcp_f32 v13, v13
s_nop 0
v_mul_f32 v13, v12, v13
v_cvt_pk_bf16_f32 v13, v13, v13
v_lshlrev_b32 v12, 16, v13
v_mov_b32 v48, 0
v_mov_b32 v49, 0
v_mov_b32 v50, 0
v_mov_b32 v51, 0
v_mov_b32 v52, 0
v_mov_b32 v53, 0
v_mov_b32 v54, 0
v_mov_b32 v55, 0
s_waitcnt vmcnt(11)
v_lshlrev_b32 v13, 16, v16
v_and_b32 v15, 0xffff0000, v16
v_fmac_f32 v48, v8, v13
v_fmac_f32 v49, v8, v15
v_lshlrev_b32 v13, 16, v17
v_and_b32 v15, 0xffff0000, v17
v_fmac_f32 v50, v8, v13
v_fmac_f32 v51, v8, v15
v_lshlrev_b32 v13, 16, v18
v_and_b32 v15, 0xffff0000, v18
v_fmac_f32 v52, v8, v13
v_fmac_f32 v53, v8, v15
v_lshlrev_b32 v13, 16, v19
v_and_b32 v15, 0xffff0000, v19
v_fmac_f32 v54, v8, v13
v_fmac_f32 v55, v8, v15
s_waitcnt vmcnt(10)
v_lshlrev_b32 v13, 16, v20
v_and_b32 v15, 0xffff0000, v20
v_fmac_f32 v48, v9, v13
v_fmac_f32 v49, v9, v15
v_lshlrev_b32 v13, 16, v21
v_and_b32 v15, 0xffff0000, v21
v_fmac_f32 v50, v9, v13
v_fmac_f32 v51, v9, v15
v_lshlrev_b32 v13, 16, v22
v_and_b32 v15, 0xffff0000, v22
v_fmac_f32 v52, v9, v13
v_fmac_f32 v53, v9, v15
v_lshlrev_b32 v13, 16, v23
v_and_b32 v15, 0xffff0000, v23
v_fmac_f32 v54, v9, v13
v_fmac_f32 v55, v9, v15
s_waitcnt vmcnt(9)
v_lshlrev_b32 v13, 16, v24
v_and_b32 v15, 0xffff0000, v24
v_fmac_f32 v48, v10, v13
v_fmac_f32 v49, v10, v15
v_lshlrev_b32 v13, 16, v25
v_and_b32 v15, 0xffff0000, v25
v_fmac_f32 v50, v10, v13
v_fmac_f32 v51, v10, v15
v_lshlrev_b32 v13, 16, v26
v_and_b32 v15, 0xffff0000, v26
v_fmac_f32 v52, v10, v13
v_fmac_f32 v53, v10, v15
v_lshlrev_b32 v13, 16, v27
v_and_b32 v15, 0xffff0000, v27
v_fmac_f32 v54, v10, v13
v_fmac_f32 v55, v10, v15
s_waitcnt vmcnt(8)
v_lshlrev_b32 v13, 16, v28
v_and_b32 v15, 0xffff0000, v28
v_fmac_f32 v48, v11, v13
v_fmac_f32 v49, v11, v15
v_lshlrev_b32 v13, 16, v29
v_and_b32 v15, 0xffff0000, v29
v_fmac_f32 v50, v11, v13
v_fmac_f32 v51, v11, v15
v_lshlrev_b32 v13, 16, v30
v_and_b32 v15, 0xffff0000, v30
v_fmac_f32 v52, v11, v13
v_fmac_f32 v53, v11, v15
v_lshlrev_b32 v13, 16, v31
v_and_b32 v15, 0xffff0000, v31
v_fmac_f32 v54, v11, v13
v_fmac_f32 v55, v11, v15
s_waitcnt vmcnt(7)
v_lshlrev_b32 v13, 16, v32
v_and_b32 v15, 0xffff0000, v32
v_fmac_f32 v48, v12, v13
v_fmac_f32 v49, v12, v15
v_lshlrev_b32 v13, 16, v33
v_and_b32 v15, 0xffff0000, v33
v_fmac_f32 v50, v12, v13
v_fmac_f32 v51, v12, v15
v_lshlrev_b32 v13, 16, v34
v_and_b32 v15, 0xffff0000, v34
v_fmac_f32 v52, v12, v13
v_fmac_f32 v53, v12, v15
v_lshlrev_b32 v13, 16, v35
v_and_b32 v15, 0xffff0000, v35
v_fmac_f32 v54, v12, v13
v_fmac_f32 v55, v12, v15
v_permlane32_swap_b32 v48, v49
v_permlane32_swap_b32 v50, v51
v_permlane32_swap_b32 v52, v53
v_permlane32_swap_b32 v54, v55
v_add_f32 v48, v48, v49
v_add_f32 v50, v50, v51
v_add_f32 v52, v52, v53
v_add_f32 v54, v54, v55
v_permlane16_swap_b32 v48, v50
s_nop 0
v_permlane16_swap_b32 v52, v54
v_add_f32 v48, v48, v50
v_add_f32 v52, v52, v54
s_nop 0
v_add_f32_dpp v48, v48, v48 row_ror:8 row_mask:0xf bank_mask:0xf
v_add_f32_dpp v52, v52, v52 row_ror:8 row_mask:0xf bank_mask:0xf
v_lshrrev_b32 v13, 4, v1
v_and_b32 v15, 1, v13
v_lshlrev_b32 v15, 1, v15
v_lshrrev_b32 v13, 1, v13
v_add_u32 v13, v13, v15
v_bfe_u32 v15, v1, 3, 1
v_lshl_add_u32 v13, v15, 2, v13
v_lshl_add_u32 v13, v2, 3, v13
v_cmp_eq_u32 vcc, 1, v15
s_lshl_b32 s14, s4, 8
s_add_u32 s14, s14, 158720
v_lshl_add_u32 v13, v13, 2, s14
v_cndmask_b32 v48, v48, v52, vcc
ds_write_b32 v13, v48
v_mov_b32 v251, 0
s_cmp_lg_u32 s4, 0
s_cbranch_scc1 L_ep0_1
buffer_load_dword v250, v251, s[60:63], 0 offen sc1
L_ep0_1:
s_waitcnt vmcnt(4)
v_mov_b32 v56, 0
v_mov_b32 v57, 0
v_mov_b32 v58, 0x3f803f80
v_dot2_f32_bf16 v56, v36, v58, v56
v_dot2_f32_bf16 v57, v36, v36, v57
v_dot2_f32_bf16 v56, v37, v58, v56
v_dot2_f32_bf16 v57, v37, v37, v57
v_dot2_f32_bf16 v56, v38, v58, v56
v_dot2_f32_bf16 v57, v38, v38, v57
v_dot2_f32_bf16 v56, v39, v58, v56
v_dot2_f32_bf16 v57, v39, v39, v57
v_dot2_f32_bf16 v56, v40, v58, v56
v_dot2_f32_bf16 v57, v40, v40, v57
v_dot2_f32_bf16 v56, v41, v58, v56
v_dot2_f32_bf16 v57, v41, v41, v57
v_dot2_f32_bf16 v56, v42, v58, v56
v_dot2_f32_bf16 v57, v42, v42, v57
v_dot2_f32_bf16 v56, v43, v58, v56
v_dot2_f32_bf16 v57, v43, v43, v57
v_dot2_f32_bf16 v56, v44, v58, v56
v_dot2_f32_bf16 v57, v44, v44, v57
v_dot2_f32_bf16 v56, v45, v58, v56
v_dot2_f32_bf16 v57, v45, v45, v57
v_dot2_f32_bf16 v56, v46, v58, v56
v_dot2_f32_bf16 v57, v46, v46, v57
v_dot2_f32_bf16 v56, v47, v58, v56
v_dot2_f32_bf16 v57, v47, v47, v57
s_nop 2
v_permlane32_swap_b32 v56, v57
v_add_f32 v56, v56, v57
v_mov_b32 v57, v56
s_nop 1
v_permlane16_swap_b32 v56, v57
v_add_f32 v56, v56, v57
s_nop 1
v_add_f32_dpp v56, v56, v56 row_ror:8 row_mask:0xf bank_mask:0xf
v_lshrrev_b32 v13, 5, v1
v_lshl_add_u32 v13, v13, 3, v2
v_lshlrev_b32 v13, 4, v13
s_lshl_b32 s14, s4, 2
s_add_u32 s14, s14, 159744
v_add_u32 v13, s14, v13
ds_write_b32 v13, v56
s_waitcnt vmcnt(0) lgkmcnt(0)
s_barrier
v_lshrrev_b32 v8, 5, v1
v_bfe_u32 v9, v1, 2, 2
v_lshl_add_u32 v9, v8, 3, v9
v_mul_u32_u24 v9, 960, v9
v_bfe_u32 v10, v1, 4, 1
v_and_b32 v11, 3, v1
v_lshl_add_u32 v10, v10, 2, v11
v_and_b32 v11, 1, v10
v_lshl_add_u32 v9, v11, 3, v9
s_mul_i32 s14, s4, 80
v_add_u32 v9, s14, v9
v_lshrrev_b32 v10, 1, v10
v_add_u32 v11, 0, v10
v_min_u32 v11, 14, v11
v_mul_u32_u24 v56, 52, v11
v_lshrrev_b32 v56, 8, v56
v_mul_u32_u24 v57, 5, v56
v_sub_u32 v11, v11, v57
v_add_u32 v56, 1, v56
v_cmp_eq_u32 vcc, 3, v56
v_mul_u32_u24 v56, 320, v56
v_lshl_add_u32 v11, v11, 4, v56
v_subrev_u32 v56, 960, v11
v_cndmask_b32 v11, v11, v56, vcc
v_add_u32 v11, v9, v11
ds_read_b64_tr_b16 v[64:65], v11
ds_read_b64_tr_b16 v[66:67], v11 offset:3840
v_add_u32 v11, 4, v10
v_min_u32 v11, 14, v11
v_mul_u32_u24 v56, 52, v11
v_lshrrev_b32 v56, 8, v56
v_mul_u32_u24 v57, 5, v56
v_sub_u32 v11, v11, v57
v_add_u32 v56, 1, v56
v_cmp_eq_u32 vcc, 3, v56
v_mul_u32_u24 v56, 320, v56
v_lshl_add_u32 v11, v11, 4, v56
v_subrev_u32 v56, 960, v11
v_cndmask_b32 v11, v11, v56, vcc
v_add_u32 v11, v9, v11
ds_read_b64_tr_b16 v[68:69], v11
ds_read_b64_tr_b16 v[70:71], v11 offset:3840
v_add_u32 v11, 8, v10
v_min_u32 v11, 14, v11
v_mul_u32_u24 v56, 52, v11
v_lshrrev_b32 v56, 8, v56
v_mul_u32_u24 v57, 5, v56
v_sub_u32 v11, v11, v57
v_add_u32 v56, 1, v56
v_cmp_eq_u32 vcc, 3, v56
v_mul_u32_u24 v56, 320, v56
v_lshl_add_u32 v11, v11, 4, v56
v_subrev_u32 v56, 960, v11
v_cndmask_b32 v11, v11, v56, vcc
v_add_u32 v11, v9, v11
ds_read_b64_tr_b16 v[72:73], v11
ds_read_b64_tr_b16 v[74:75], v11 offset:3840
v_add_u32 v11, 12, v10
v_min_u32 v11, 14, v11
v_mul_u32_u24 v56, 52, v11
v_lshrrev_b32 v56, 8, v56
v_mul_u32_u24 v57, 5, v56
v_sub_u32 v11, v11, v57
v_add_u32 v56, 1, v56
v_cmp_eq_u32 vcc, 3, v56
v_mul_u32_u24 v56, 320, v56
v_lshl_add_u32 v11, v11, 4, v56
v_subrev_u32 v56, 960, v11
v_cndmask_b32 v11, v11, v56, vcc
v_add_u32 v11, v9, v11
ds_read_b64_tr_b16 v[76:77], v11
ds_read_b64_tr_b16 v[78:79], v11 offset:3840
s_cmp_lg_u32 s4, 0
s_cbranch_scc1 L_m0_2
s_cmp_ge_u32 s2, 240
s_cbranch_scc1 L_m0_2
v_lshlrev_b32 v13, 2, v1
v_add_u32 v15, 158720, v13
ds_read_b32 v48, v15
ds_read_b32 v49, v15 offset:256
ds_read_b32 v50, v15 offset:512
ds_read_b32 v51, v15 offset:768
s_mul_i32 s14, s12, 3840*4
s_lshl_b32 s15, s13, 8
s_add_u32 s14, s14, s15
s_add_u32 s14, s14, 0x40000
s_waitcnt lgkmcnt(0)
v_add_f32 v48, v48, v49
v_add_f32 v50, v50, v51
v_add_f32 v48, v48, v50
buffer_store_dword v48, v13, s[44:47], s14 offen sc1
L_m0_2:
v_lshlrev_b32 v13, 4, v2
v_add_u32 v13, 159744, v13
ds_read_b128 v[48:51], v13
ds_read_b128 v[52:55], v13 offset:128
s_waitcnt lgkmcnt(0)
v_add_f32 v48, v48, v49
v_add_f32 v50, v50, v51
v_add_f32 v52, v52, v53
v_add_f32 v54, v54, v55
v_add_f32 v48, v48, v50
v_add_f32 v52, v52, v54
v_mul_f32 v48, 0x3acccccd, v48
v_mul_f32 v52, 0x3acccccd, v52
v_fma_f32 v52, -v48, v48, v52
v_max_f32 v52, 0, v52
v_add_f32 v52, 0x3727c5ac, v52
v_rsq_f32 v52, v52
s_nop 0
v_mul_f32 v48, v48, v52
v_sub_f32 v48, 0, v48
v_lshlrev_b32 v13, 16, v36
v_and_b32 v15, 0xffff0000, v36
v_fma_f32 v13, v13, v52, v48
v_fma_f32 v15, v15, v52, v48
v_cvt_pk_f16_f32 v36, v13, v15
v_lshlrev_b32 v13, 16, v37
v_and_b32 v15, 0xffff0000, v37
v_fma_f32 v13, v13, v52, v48
v_fma_f32 v15, v15, v52, v48
v_cvt_pk_f16_f32 v37, v13, v15
v_lshlrev_b32 v13, 16, v38
v_and_b32 v15, 0xffff0000, v38
v_fma_f32 v13, v13, v52, v48
v_fma_f32 v15, v15, v52, v48
v_cvt_pk_f16_f32 v38, v13, v15
v_lshlrev_b32 v13, 16, v39
v_and_b32 v15, 0xffff0000, v39
v_fma_f32 v13, v13, v52, v48
v_fma_f32 v15, v15, v52, v48
v_cvt_pk_f16_f32 v39, v13, v15
v_lshlrev_b32 v13, 16, v40
v_and_b32 v15, 0xffff0000, v40
v_fma_f32 v13, v13, v52, v48
v_fma_f32 v15, v15, v52, v48
v_cvt_pk_f16_f32 v40, v13, v15
v_lshlrev_b32 v13, 16, v41
v_and_b32 v15, 0xffff0000, v41
v_fma_f32 v13, v13, v52, v48
v_fma_f32 v15, v15, v52, v48
v_cvt_pk_f16_f32 v41, v13, v15
v_lshlrev_b32 v13, 16, v42
v_and_b32 v15, 0xffff0000, v42
v_fma_f32 v13, v13, v52, v48
v_fma_f32 v15, v15, v52, v48
v_cvt_pk_f16_f32 v42, v13, v15
v_lshlrev_b32 v13, 16, v43
v_and_b32 v15, 0xffff0000, v43
v_fma_f32 v13, v13, v52, v48
v_fma_f32 v15, v15, v52, v48
v_cvt_pk_f16_f32 v43, v13, v15
v_lshlrev_b32 v13, 16, v44
v_and_b32 v15, 0xffff0000, v44
v_fma_f32 v13, v13, v52, v48
v_fma_f32 v15, v15, v52, v48
v_cvt_pk_f16_f32 v44, v13, v15
v_lshlrev_b32 v13, 16, v45
v_and_b32 v15, 0xffff0000, v45
v_fma_f32 v13, v13, v52, v48
v_fma_f32 v15, v15, v52, v48
v_cvt_pk_f16_f32 v45, v13, v15
v_lshlrev_b32 v13, 16, v46
v_and_b32 v15, 0xffff0000, v46
v_fma_f32 v13, v13, v52, v48
v_fma_f32 v15, v15, v52, v48
v_cvt_pk_f16_f32 v46, v13, v15
v_lshlrev_b32 v13, 16, v47
v_and_b32 v15, 0xffff0000, v47
v_fma_f32 v13, v13, v52, v48
v_fma_f32 v15, v15, v52, v48
v_cvt_pk_f16_f32 v47, v13, v15
s_mul_i32 s15, s4, 20
v_add_u32 v13, s15, v3
v_lshrrev_b32 v15, 1, v13
v_lshlrev_b32 v15, 10, v15
v_and_b32 v13, 1, v13
v_lshl_add_u32 v15, v13, 9, v15
s_and_b32 s14, s2, 3
s_lshl_b32 s14, s14, 3
v_add_u32 v13, s14, v2
v_lshl_add_u32 v15, v13, 4, v15
v_add_u32 v13, 8192, v15
v_cmp_gt_u32 vcc, 4, v3
v_mov_b32 v7, 0x7f000000
s_lshr_b32 s14, s2, 2
s_mul_i32 s14, s14, 40960
v_cndmask_b32 v13, v7, v13, vcc
s_add_u32 s14, s14, 0x100000
buffer_store_dwordx4 v[36:39], v15, s[44:47], s14 offen sc1
s_add_u32 s15, s14, 4096
buffer_store_dwordx4 v[40:43], v15, s[44:47], s15 offen sc1
buffer_store_dwordx4 v[44:47], v13, s[44:47], s14 offen sc1
s_mul_i32 s14, s70, 3840
s_lshl_b32 s15, s71, 2
s_add_u32 s15, s15, s4
s_mul_i32 s15, s15, 153600
s_add_u32 s14, s14, s15
s_add_u32 s14, s14, 0x2000000
s_cmp_ge_u32 s2, 96
s_cselect_b32 s14, s14, 0x7f000000
v_lshlrev_b32 v8, 4, v1
v_and_b32 v9, 31, v1
v_lshrrev_b32 v10, 5, v1
v_mul_u32_u24 v10, 24, v10
v_add_u32 v10, v10, v9
v_lshlrev_b32 v10, 4, v10
v_add_u32 v10, 3072, v10
v_mov_b32 v11, 0x7f000000
v_cmp_gt_u32 vcc, 24, v9
s_waitcnt lgkmcnt(0)
s_nop 0
v_cndmask_b32 v10, v11, v10, vcc
buffer_store_dwordx4 v[64:67], v8, s[44:47], s14 offen sc1
buffer_store_dwordx4 v[68:71], v8, s[44:47], s14 offen offset:1024 sc1
buffer_store_dwordx4 v[72:75], v8, s[44:47], s14 offen offset:2048 sc1
buffer_store_dwordx4 v[76:79], v10, s[44:47], s14 offen sc1
s_waitcnt vmcnt(0)
s_cmp_lg_u32 s4, 0
s_cbranch_scc1 L_epd_4
s_mov_b32 s64, 0
L_ep_3:
v_readfirstlane_b32 s5, v250
s_nop 3
s_cmp_lg_u32 s5, 0
s_cbranch_scc1 L_epd_4
s_add_u32 s64, s64, 1
s_cmp_gt_u32 s64, 1048576
s_cbranch_scc1 L_epd_4
buffer_load_dword v250, v251, s[60:63], 0 offen sc1
s_waitcnt vmcnt(0)
s_branch L_ep_3
L_epd_4:
s_barrier
s_cmp_lg_u32 s4, 0
s_cbranch_scc1 L_fs_5
s_lshl_b32 s64, s2, 7
s_add_u32 s64, s64, 0x0
v_mov_b32 v252, s5
v_mov_b32 v253, 0
s_mov_b64 exec, 1
buffer_store_dword v252, v253, s[44:47], s64 offen sc1
s_mov_b64 exec, -1
L_fs_5:
s_cmp_lg_u32 s4, 3
s_cbranch_scc1 L_ct_6
s_lshl_b32 s64, s3, 4
v_and_b32 v249, 15, v1
v_add_u32 v249, s64, v249
v_lshlrev_b32 v249, 7, v249
v_min_u32 v249, L_code_end-L_code_begin-4, v249
global_load_dword v249, v249, s[22:23]
L_ct_6:
v_add_u32 v12, 0, v1
v_mul_u32_u24 v13, 6554, v12
v_lshrrev_b32 v13, 16, v13
v_mul_u32_u24 v14, 10, v13
v_sub_u32 v14, v12, v14
v_mul_u32_u24 v13, 1280, v13
v_lshl_add_u32 v240, v14, 4, v13
v_add_u32 v12, 64, v1
v_mul_u32_u24 v13, 6554, v12
v_lshrrev_b32 v13, 16, v13
v_mul_u32_u24 v14, 10, v13
v_sub_u32 v14, v12, v14
v_mul_u32_u24 v13, 1280, v13
v_lshl_add_u32 v241, v14, 4, v13
v_add_u32 v12, 128, v1
v_mul_u32_u24 v13, 6554, v12
v_lshrrev_b32 v13, 16, v13
v_mul_u32_u24 v14, 10, v13
v_sub_u32 v14, v12, v14
v_mul_u32_u24 v13, 1280, v13
v_lshl_add_u32 v242, v14, 4, v13
v_add_u32 v12, 192, v1
v_mul_u32_u24 v13, 6554, v12
v_lshrrev_b32 v13, 16, v13
v_mul_u32_u24 v14, 10, v13
v_sub_u32 v14, v12, v14
v_mul_u32_u24 v13, 1280, v13
v_lshl_add_u32 v243, v14, 4, v13
v_add_u32 v12, 256, v1
v_mul_u32_u24 v13, 6554, v12
v_lshrrev_b32 v13, 16, v13
v_mul_u32_u24 v14, 10, v13
v_sub_u32 v14, v12, v14
v_mul_u32_u24 v13, 1280, v13
v_lshl_add_u32 v244, v14, 4, v13
v_add_u32 v12, 0, v1
v_mul_u32_u24 v13, 5462, v12
v_lshrrev_b32 v13, 16, v13
v_mul_u32_u24 v14, 12, v13
v_sub_u32 v14, v12, v14
v_mul_u32_u24 v13, 3072, v13
v_lshl_add_u32 v245, v14, 4, v13
v_add_u32 v12, 64, v1
v_mul_u32_u24 v13, 5462, v12
v_lshrrev_b32 v13, 16, v13
v_mul_u32_u24 v14, 12, v13
v_sub_u32 v14, v12, v14
v_mul_u32_u24 v13, 3072, v13
v_lshl_add_u32 v246, v14, 4, v13
v_add_u32 v12, 128, v1
v_mul_u32_u24 v13, 5462, v12
v_lshrrev_b32 v13, 16, v13
v_mul_u32_u24 v14, 12, v13
v_sub_u32 v14, v12, v14
v_mul_u32_u24 v13, 3072, v13
v_lshl_add_u32 v247, v14, 4, v13
s_cmp_ge_u32 s2, 128
s_cbranch_scc1 L_pt2_7
s_and_b32 s83, s2, 15
s_lshr_b32 s84, s2, 4
s_mul_i32 s80, s84, 245760
s_mul_i32 s83, s83, 192
s_add_u32 s80, s80, s83
s_movk_i32 s81, 3072
s_movk_i32 s82, 80
s_mov_b32 s84, s24
s_mov_b32 s85, s25
s_mov_b32 s86, 1966080
s_branch L_pte_9
L_pt2_7:
s_cmp_ge_u32 s2, 224
s_cbranch_scc1 L_pto_8
s_sub_u32 s83, s2, 128
s_lshr_b32 s84, s83, 3
s_and_b32 s83, s83, 7
s_mul_i32 s80, s84, 163840
s_mul_i32 s83, s83, 160
s_add_u32 s80, s80, s83
s_movk_i32 s81, 1280
s_movk_i32 s82, 128
s_mov_b32 s84, s28
s_mov_b32 s85, s29
s_mov_b32 s86, 1966080
s_branch L_pte_9
L_pto_8:
s_sub_u32 s83, s2, 224
s_lshr_b32 s84, s83, 3
s_and_b32 s83, s83, 7
s_mul_i32 s80, s84, 204800
s_mul_i32 s83, s83, 160
s_add_u32 s80, s80, s83
s_movk_i32 s81, 1280
s_movk_i32 s82, 160
s_mov_b32 s84, s20
s_mov_b32 s85, s21
s_mov_b32 s86, 819200
L_pte_9:
s_mov_b32 s87, 0x00020000
s_cmp_ge_u32 s2, 128
s_cbranch_scc1 L_pd2_10
s_mul_i32 s14, s4, 49152
s_add_u32 s14, s14, s80
s_mul_i32 s15, s4, 3072
s_add_u32 m0, s15, 128000
s_nop 0
buffer_load_dwordx4 v245, s[84:87], s14 offen lds
s_add_u32 m0, s15, 129024
s_nop 0
buffer_load_dwordx4 v246, s[84:87], s14 offen lds
s_add_u32 m0, s15, 130048
s_nop 0
buffer_load_dwordx4 v247, s[84:87], s14 offen lds
s_add_u32 s14, s80, 196608
s_movk_i32 s15, 12288
s_add_u32 m0, s15, 128000
s_nop 0
buffer_load_dwordx4 v245, s[84:87], s14 offen lds
s_add_u32 m0, s15, 129024
s_nop 0
buffer_load_dwordx4 v246, s[84:87], s14 offen lds
s_add_u32 m0, s15, 130048
s_nop 0
buffer_load_dwordx4 v247, s[84:87], s14 offen lds
s_branch L_pde_12
L_pd2_10:
s_mul_i32 s14, s4, 40960
s_add_u32 s14, s14, s80
s_mul_i32 s15, s4, 5120
s_add_u32 m0, s15, 128000
s_nop 0
buffer_load_dwordx4 v240, s[84:87], s14 offen lds
s_add_u32 m0, s15, 129024
s_nop 0
buffer_load_dwordx4 v241, s[84:87], s14 offen lds
s_add_u32 m0, s15, 130048
s_nop 0
buffer_load_dwordx4 v242, s[84:87], s14 offen lds
s_add_u32 m0, s15, 131072
s_nop 0
buffer_load_dwordx4 v243, s[84:87], s14 offen lds
s_add_u32 m0, s15, 132096
s_nop 0
buffer_load_dwordx4 v244, s[84:87], s14 offen lds
s_cmp_ge_u32 s2, 224
s_cbranch_scc0 L_pde_12
s_add_u32 s14, s80, 163840
s_movk_i32 s15, 20480
s_add_u32 m0, s15, 128000
s_nop 0
buffer_load_dwordx4 v240, s[84:87], s14 offen lds
s_add_u32 m0, s15, 129024
s_nop 0
buffer_load_dwordx4 v241, s[84:87], s14 offen lds
s_add_u32 m0, s15, 130048
s_nop 0
buffer_load_dwordx4 v242, s[84:87], s14 offen lds
s_add_u32 m0, s15, 131072
s_nop 0
buffer_load_dwordx4 v243, s[84:87], s14 offen lds
s_add_u32 m0, s15, 132096
s_nop 0
buffer_load_dwordx4 v244, s[84:87], s14 offen lds
L_pde_12:
v_lshlrev_b32 v8, 7, v1
v_add_u32 v9, 64*128, v8
v_add_u32 v10, 128*128, v8
v_add_u32 v11, 192*128, v8
v_lshlrev_b32 v2, 4, v1
v_lshrrev_b32 v12, 5, v1
v_lshlrev_b32 v3, 5, v12
v_add_u32 v3, 153600, v3
v_add_u32 v4, 61440, v2
v_add_u32 v5, 122880, v2
v_and_b32 v13, 31, v1
v_min_u32 v13, 23, v13
v_mul_u32_u24 v12, 24, v12
v_add_u32 v12, v12, v13
v_lshlrev_b32 v12, 4, v12
v_add_u32 v6, 3072, v12
v_add_u32 v7, 61440, v6
v_add_u32 v15, 122880, v6
v_lshrrev_b32 v12, 2, v0
v_lshlrev_b32 v12, 7, v12
v_bfe_u32 v13, v0, 1, 1
v_lshl_add_u32 v12, v13, 6, v12
v_and_b32 v13, 1, v0
v_lshl_add_u32 v12, v13, 4, v12
v_add_u32 v14, 153600, v12
v_lshlrev_b32 v12, 4, v0
v_mov_b32 v13, 0x7f000000
v_cmp_gt_u32 vcc, 160, v0
s_nop 1
v_cndmask_b32 v52, v13, v12, vcc
s_lshl_b32 s12, s7, 2
s_add_u32 s12, s12, s4
s_mul_i32 s12, s12, 40960
s_add_u32 s12, s12, 0x100000
s_mul_i32 s76, s6, 153600
s_add_u32 s76, s76, 0x2000000
s_lshl_b32 s77, s4, 10
s_add_u32 s76, s76, s77
s_cmp_eq_u32 s4, 3
s_cselect_b32 s78, 0, 12288
v_lshrrev_b32 v12, 2, v0
v_lshlrev_b32 v12, 6, v12
v_bfe_u32 v13, v0, 1, 1
v_lshl_add_u32 v12, v13, 5, v12
v_and_b32 v13, 1, v0
v_lshl_add_u32 v12, v13, 4, v12
v_add_u32 v14, 153600, v12
s_cmp_lg_u32 s4, 0
s_cbranch_scc1 L_pd_14
s_mov_b32 s64, 0
L_pl_13:
buffer_load_dword v250, v8, s[44:47], 0 offen sc1
buffer_load_dword v251, v9, s[44:47], 0 offen sc1
buffer_load_dword v252, v10, s[44:47], 0 offen sc1
buffer_load_dword v253, v11, s[44:47], 0 offen sc1
s_add_u32 s64, s64, 1
s_cmp_gt_u32 s64, 1048576
s_cbranch_scc1 L_pd_14
s_waitcnt vmcnt(0)
v_cmp_ne_u32 vcc, s5, v250
v_cmp_ne_u32 s[66:67], s5, v251
s_nop 3
s_or_b64 vcc, vcc, s[66:67]
v_cmp_ne_u32 s[66:67], s5, v252
s_nop 3
s_or_b64 vcc, vcc, s[66:67]
v_cmp_ne_u32 s[66:67], s5, v253
s_nop 3
s_or_b64 vcc, vcc, s[66:67]
s_nop 3
s_cmp_eq_u64 vcc, 0
s_cbranch_scc1 L_pd_14
s_branch L_pl_13
L_pd_14:
s_waitcnt vmcnt(0)
s_barrier
s_mov_b32 s14, 262144
buffer_load_dwordx4 v[16:19], v52, s[44:47], s14 offen sc1
buffer_load_dwordx4 v[32:35], v52, s[44:47], s14 offen offset:2560 sc1
s_mov_b32 s14, 277504
buffer_load_dwordx4 v[20:23], v52, s[44:47], s14 offen sc1
buffer_load_dwordx4 v[36:39], v52, s[44:47], s14 offen offset:2560 sc1
s_mov_b32 s14, 292864
buffer_load_dwordx4 v[24:27], v52, s[44:47], s14 offen sc1
buffer_load_dwordx4 v[40:43], v52, s[44:47], s14 offen offset:2560 sc1
s_mov_b32 s14, 308224
buffer_load_dwordx4 v[28:31], v52, s[44:47], s14 offen sc1
buffer_load_dwordx4 v[44:47], v52, s[44:47], s14 offen offset:2560 sc1
s_add_u32 m0, s77, 0
s_add_u32 s79, s76, 0
buffer_load_dwordx4 v2, s[44:47], s79 offen sc1 lds
s_add_u32 m0, s77, 4096
s_add_u32 s79, s76, 4096
buffer_load_dwordx4 v2, s[44:47], s79 offen sc1 lds
s_add_u32 m0, s77, 8192
s_add_u32 s79, s76, 8192
buffer_load_dwordx4 v2, s[44:47], s79 offen sc1 lds
s_add_u32 s79, s78, 0
s_add_u32 m0, s77, s79
s_add_u32 s79, s76, s79
buffer_load_dwordx4 v2, s[44:47], s79 offen sc1 lds
buffer_load_dwordx4 v[64:67], v2, s[44:47], s12 offen offset:0 sc1
buffer_load_dwordx4 v[68:71], v2, s[44:47], s12 offen offset:1024 sc1
s_add_u32 m0, s77, 15360
s_add_u32 s79, s76, 15360
buffer_load_dwordx4 v2, s[44:47], s79 offen sc1 lds
s_add_u32 m0, s77, 19456
s_add_u32 s79, s76, 19456
buffer_load_dwordx4 v2, s[44:47], s79 offen sc1 lds
s_add_u32 m0, s77, 23552
s_add_u32 s79, s76, 23552
buffer_load_dwordx4 v2, s[44:47], s79 offen sc1 lds
s_add_u32 s79, s78, 15360
s_add_u32 m0, s77, s79
s_add_u32 s79, s76, s79
buffer_load_dwordx4 v2, s[44:47], s79 offen sc1 lds
buffer_load_dwordx4 v[72:75], v2, s[44:47], s12 offen offset:2048 sc1
buffer_load_dwordx4 v[76:79], v2, s[44:47], s12 offen offset:3072 sc1
s_add_u32 s12, s12, 4096
buffer_load_dwordx4 v[80:83], v2, s[44:47], s12 offen offset:0 sc1
buffer_load_dwordx4 v[84:87], v2, s[44:47], s12 offen offset:1024 sc1
buffer_load_dwordx4 v[88:91], v2, s[44:47], s12 offen offset:2048 sc1
buffer_load_dwordx4 v[92:95], v2, s[44:47], s12 offen offset:3072 sc1
s_add_u32 m0, s77, 30720
s_add_u32 s79, s76, 30720
buffer_load_dwordx4 v2, s[44:47], s79 offen sc1 lds
s_add_u32 m0, s77, 34816
s_add_u32 s79, s76, 34816
buffer_load_dwordx4 v2, s[44:47], s79 offen sc1 lds
s_add_u32 m0, s77, 38912
s_add_u32 s79, s76, 38912
buffer_load_dwordx4 v2, s[44:47], s79 offen sc1 lds
s_add_u32 s79, s78, 30720
s_add_u32 m0, s77, s79
s_add_u32 s79, s76, s79
buffer_load_dwordx4 v2, s[44:47], s79 offen sc1 lds
s_add_u32 m0, s77, 46080
s_add_u32 s79, s76, 46080
buffer_load_dwordx4 v2, s[44:47], s79 offen sc1 lds
s_add_u32 m0, s77, 50176
s_add_u32 s79, s76, 50176
buffer_load_dwordx4 v2, s[44:47], s79 offen sc1 lds
s_add_u32 m0, s77, 54272
s_add_u32 s79, s76, 54272
buffer_load_dwordx4 v2, s[44:47], s79 offen sc1 lds
s_add_u32 s79, s78, 46080
s_add_u32 m0, s77, s79
s_add_u32 s79, s76, s79
buffer_load_dwordx4 v2, s[44:47], s79 offen sc1 lds
s_waitcnt vmcnt(24)
v_add_f32 v16, v16, v20
v_add_f32 v24, v24, v28
v_add_f32 v32, v32, v36
v_add_f32 v40, v40, v44
v_add_f32 v16, v16, v24
v_add_f32 v32, v32, v40
v_add_f32 v17, v17, v21
v_add_f32 v25, v25, v29
v_add_f32 v33, v33, v37
v_add_f32 v41, v41, v45
v_add_f32 v17, v17, v25
v_add_f32 v33, v33, v41
v_add_f32 v18, v18, v22
v_add_f32 v26, v26, v30
v_add_f32 v34, v34, v38
v_add_f32 v42, v42, v46
v_add_f32 v18, v18, v26
v_add_f32 v34, v34, v42
v_add_f32 v19, v19, v23
v_add_f32 v27, v27, v31
v_add_f32 v35, v35, v39
v_add_f32 v43, v43, v47
v_add_f32 v19, v19, v27
v_add_f32 v35, v35, v43
v_cvt_pk_bf16_f32 v20, v16, v17
v_cvt_pk_bf16_f32 v21, v18, v19
v_cvt_pk_bf16_f32 v22, v32, v33
v_cvt_pk_bf16_f32 v23, v34, v35
v_lshlrev_b32 v16, 16, v20
v_and_b32 v17, 0xffff0000, v20
v_lshlrev_b32 v18, 16, v21
v_and_b32 v19, 0xffff0000, v21
v_lshlrev_b32 v32, 16, v22
v_and_b32 v33, 0xffff0000, v22
v_lshlrev_b32 v34, 16, v23
v_and_b32 v35, 0xffff0000, v23
v_add_f32 v32, 1.0, v32
v_add_f32 v33, 1.0, v33
v_add_f32 v34, 1.0, v34
v_add_f32 v35, 1.0, v35
v_cvt_pk_bf16_f32 v22, v32, v33
v_cvt_pk_bf16_f32 v23, v34, v35
v_lshlrev_b32 v32, 16, v22
v_and_b32 v33, 0xffff0000, v22
v_lshlrev_b32 v34, 16, v23
v_and_b32 v35, 0xffff0000, v23
v_cvt_pk_f16_f32 v36, v32, v16
v_cvt_pk_f16_f32 v37, v33, v17
v_cvt_pk_f16_f32 v38, v34, v18
v_cvt_pk_f16_f32 v39, v35, v19
v_cmp_gt_u32 vcc, 160, v0
s_nop 3
s_and_saveexec_b64 s[66:67], vcc
ds_write_b128 v14, v[36:39]
s_mov_b64 exec, s[66:67]
s_waitcnt vmcnt(20) lgkmcnt(0)
s_barrier
ds_read_b128 v[16:19], v3 offset:0
ds_read_b128 v[20:23], v3 offset:16
ds_read_b128 v[24:27], v3 offset:64
ds_read_b128 v[28:31], v3 offset:80
ds_read_b128 a[64:67], v2 offset:0
ds_read_b128 a[68:71], v2 offset:1024
ds_read_b128 a[72:75], v2 offset:2048
ds_read_b128 a[76:79], v6 offset:0
s_waitcnt vmcnt(19) lgkmcnt(6)
v_fma_mix_f32 v48, v64, v16, v16 op_sel:[0,0,1] op_sel_hi:[1,1,1]
v_fma_mix_f32 v49, v64, v17, v17 op_sel:[1,0,1] op_sel_hi:[1,1,1]
v_cvt_pk_bf16_f32 v64, v48, v49
v_fma_mix_f32 v50, v65, v18, v18 op_sel:[0,0,1] op_sel_hi:[1,1,1]
v_fma_mix_f32 v51, v65, v19, v19 op_sel:[1,0,1] op_sel_hi:[1,1,1]
v_cvt_pk_bf16_f32 v65, v50, v51
v_fma_mix_f32 v48, v66, v20, v20 op_sel:[0,0,1] op_sel_hi:[1,1,1]
v_fma_mix_f32 v49, v66, v21, v21 op_sel:[1,0,1] op_sel_hi:[1,1,1]
v_cvt_pk_bf16_f32 v66, v48, v49
v_fma_mix_f32 v50, v67, v22, v22 op_sel:[0,0,1] op_sel_hi:[1,1,1]
v_fma_mix_f32 v51, v67, v23, v23 op_sel:[1,0,1] op_sel_hi:[1,1,1]
v_cvt_pk_bf16_f32 v67, v50, v51
ds_read_b128 a[80:83], v2 offset:3840
ds_read_b128 a[84:87], v2 offset:4864
ds_read_b128 a[88:91], v2 offset:5888
ds_read_b128 a[92:95], v6 offset:3840
s_waitcnt vmcnt(18) lgkmcnt(4)
v_mfma_f32_32x32x16_bf16 a[0:15], a[64:67], v[64:67], 0
ds_read_b128 v[16:19], v3 offset:128
ds_read_b128 v[20:23], v3 offset:144
v_fma_mix_f32 v48, v68, v24, v24 op_sel:[0,0,1] op_sel_hi:[1,1,1]
v_fma_mix_f32 v49, v68, v25, v25 op_sel:[1,0,1] op_sel_hi:[1,1,1]
v_cvt_pk_bf16_f32 v68, v48, v49
s_add_u32 m0, s77, 61440
s_add_u32 s79, s76, 61440
buffer_load_dwordx4 v2, s[44:47], s79 offen sc1 lds
v_mfma_f32_32x32x16_bf16 a[16:31], a[68:71], v[64:67], 0
ds_read_b128 a[96:99], v2 offset:7680
ds_read_b128 a[100:103], v2 offset:8704
v_fma_mix_f32 v50, v69, v26, v26 op_sel:[0,0,1] op_sel_hi:[1,1,1]
v_fma_mix_f32 v51, v69, v27, v27 op_sel:[1,0,1] op_sel_hi:[1,1,1]
v_cvt_pk_bf16_f32 v69, v50, v51
v_mfma_f32_32x32x16_bf16 a[32:47], a[72:75], v[64:67], 0
ds_read_b128 a[104:107], v2 offset:9728
ds_read_b128 a[108:111], v6 offset:7680
v_fma_mix_f32 v48, v70, v28, v28 op_sel:[0,0,1] op_sel_hi:[1,1,1]
v_fma_mix_f32 v49, v70, v29, v29 op_sel:[1,0,1] op_sel_hi:[1,1,1]
v_cvt_pk_bf16_f32 v70, v48, v49
s_add_u32 s12, s12, 4096
buffer_load_dwordx4 v[96:99], v2, s[44:47], s12 offen offset:0 sc1
v_mfma_f32_32x32x16_bf16 a[48:63], a[76:79], v[64:67], 0
v_fma_mix_f32 v50, v71, v30, v30 op_sel:[0,0,1] op_sel_hi:[1,1,1]
v_fma_mix_f32 v51, v71, v31, v31 op_sel:[1,0,1] op_sel_hi:[1,1,1]
v_cvt_pk_bf16_f32 v71, v50, v51
s_waitcnt vmcnt(15) lgkmcnt(4)
s_nop 0
v_mfma_f32_32x32x16_bf16 a[0:15], a[80:83], v[68:71], a[0:15]
ds_read_b128 v[24:27], v3 offset:192
ds_read_b128 v[28:31], v3 offset:208
v_fma_mix_f32 v48, v72, v16, v16 op_sel:[0,0,1] op_sel_hi:[1,1,1]
v_fma_mix_f32 v49, v72, v17, v17 op_sel:[1,0,1] op_sel_hi:[1,1,1]
v_cvt_pk_bf16_f32 v72, v48, v49
s_add_u32 m0, s77, 65536
s_add_u32 s79, s76, 65536
buffer_load_dwordx4 v2, s[44:47], s79 offen sc1 lds
v_mfma_f32_32x32x16_bf16 a[16:31], a[84:87], v[68:71], a[16:31]
ds_read_b128 a[64:67], v2 offset:11520
ds_read_b128 a[68:71], v2 offset:12544
v_fma_mix_f32 v50, v73, v18, v18 op_sel:[0,0,1] op_sel_hi:[1,1,1]
v_fma_mix_f32 v51, v73, v19, v19 op_sel:[1,0,1] op_sel_hi:[1,1,1]
v_cvt_pk_bf16_f32 v73, v50, v51
v_mfma_f32_32x32x16_bf16 a[32:47], a[88:91], v[68:71], a[32:47]
ds_read_b128 a[72:75], v2 offset:13568
ds_read_b128 a[76:79], v6 offset:11520
v_fma_mix_f32 v48, v74, v20, v20 op_sel:[0,0,1] op_sel_hi:[1,1,1]
v_fma_mix_f32 v49, v74, v21, v21 op_sel:[1,0,1] op_sel_hi:[1,1,1]
v_cvt_pk_bf16_f32 v74, v48, v49
buffer_load_dwordx4 v[100:103], v2, s[44:47], s12 offen offset:1024 sc1
v_mfma_f32_32x32x16_bf16 a[48:63], a[92:95], v[68:71], a[48:63]
v_fma_mix_f32 v50, v75, v22, v22 op_sel:[0,0,1] op_sel_hi:[1,1,1]
v_fma_mix_f32 v51, v75, v23, v23 op_sel:[1,0,1] op_sel_hi:[1,1,1]
v_cvt_pk_bf16_f32 v75, v50, v51
s_barrier
s_waitcnt vmcnt(16) lgkmcnt(4)
v_mfma_f32_32x32x16_bf16 a[0:15], a[96:99], v[72:75], a[0:15]
ds_read_b128 v[16:19], v3 offset:256
ds_read_b128 v[20:23], v3 offset:272
v_fma_mix_f32 v48, v76, v24, v24 op_sel:[0,0,1] op_sel_hi:[1,1,1]
v_fma_mix_f32 v49, v76, v25, v25 op_sel:[1,0,1] op_sel_hi:[1,1,1]
v_cvt_pk_bf16_f32 v76, v48, v49
s_add_u32 m0, s77, 69632
s_add_u32 s79, s76, 69632
buffer_load_dwordx4 v2, s[44:47], s79 offen sc1 lds
v_mfma_f32_32x32x16_bf16 a[16:31], a[100:103], v[72:75], a[16:31]
ds_read_b128 a[80:83], v2 offset:15360
ds_read_b128 a[84:87], v2 offset:16384
v_fma_mix_f32 v50, v77, v26, v26 op_sel:[0,0,1] op_sel_hi:[1,1,1]
v_fma_mix_f32 v51, v77, v27, v27 op_sel:[1,0,1] op_sel_hi:[1,1,1]
v_cvt_pk_bf16_f32 v77, v50, v51
v_mfma_f32_32x32x16_bf16 a[32:47], a[104:107], v[72:75], a[32:47]
ds_read_b128 a[88:91], v2 offset:17408
ds_read_b128 a[92:95], v6 offset:15360
v_fma_mix_f32 v48, v78, v28, v28 op_sel:[0,0,1] op_sel_hi:[1,1,1]
v_fma_mix_f32 v49, v78, v29, v29 op_sel:[1,0,1] op_sel_hi:[1,1,1]
v_cvt_pk_bf16_f32 v78, v48, v49
buffer_load_dwordx4 v[104:107], v2, s[44:47], s12 offen offset:2048 sc1
v_mfma_f32_32x32x16_bf16 a[48:63], a[108:111], v[72:75], a[48:63]
v_fma_mix_f32 v50, v79, v30, v30 op_sel:[0,0,1] op_sel_hi:[1,1,1]
v_fma_mix_f32 v51, v79, v31, v31 op_sel:[1,0,1] op_sel_hi:[1,1,1]
v_cvt_pk_bf16_f32 v79, v50, v51
s_waitcnt lgkmcnt(0)
s_cmp_ge_u32 s2, 128
s_cbranch_scc1 L_ps2_15
s_min_u32 s14, s4, 2
v_lshrrev_b32 v188, 5, v1
v_bfe_u32 v189, v1, 2, 2
v_bfe_u32 v190, v1, 4, 1
v_and_b32 v191, 3, v1
v_lshl_add_u32 v190, v190, 2, v191
v_lshlrev_b32 v190, 3, v190
s_lshl_b32 s15, s14, 6
s_add_u32 s15, s15, 128000
v_add_u32 v190, s15, v190
v_lshl_add_u32 v191, v188, 2, v189
v_mul_u32_u24 v191, 192, v191
v_add_u32 v192, v191, v190
v_lshl_add_u32 v191, v188, 3, v189
v_mul_u32_u24 v191, 192, v191
v_add_u32 v193, v191, v190
ds_read_b64_tr_b16 v[196:197], v192 offset:0
ds_read_b64_tr_b16 v[198:199], v192 offset:3072
ds_read_b64_tr_b16 v[200:201], v192 offset:1536
ds_read_b64_tr_b16 v[202:203], v192 offset:4608
ds_read_b64_tr_b16 v[204:205], v192 offset:6144
ds_read_b64_tr_b16 v[206:207], v192 offset:9216
ds_read_b64_tr_b16 v[208:209], v192 offset:7680
ds_read_b64_tr_b16 v[210:211], v192 offset:10752
ds_read_b64_tr_b16 v[212:213], v193 offset:12288
ds_read_b64_tr_b16 v[214:215], v193 offset:13056
s_and_b32 s15, s2, 15
s_mul_i32 s15, s15, 122880
s_lshr_b32 s64, s2, 4
s_mul_i32 s64, s64, 15360
s_add_u32 s15, s15, s64
s_lshl_b32 s14, s14, 10
s_add_u32 s15, s15, s14
s_add_u32 s15, s15, 0x2600000
s_waitcnt lgkmcnt(0)
buffer_store_dwordx4 v[196:199], v2, s[44:47], s15 offen sc1
s_add_u32 s15, s15, 3072
buffer_store_dwordx4 v[200:203], v2, s[44:47], s15 offen sc1
s_add_u32 s15, s15, 3072
buffer_store_dwordx4 v[204:207], v2, s[44:47], s15 offen sc1
s_add_u32 s15, s15, 3072
buffer_store_dwordx4 v[208:211], v2, s[44:47], s15 offen sc1
s_add_u32 s15, s15, 3072
buffer_store_dwordx4 v[212:215], v2, s[44:47], s15 offen sc1
s_branch L_pse_17
L_ps2_15:
v_lshrrev_b32 v188, 4, v1
v_bfe_u32 v189, v1, 2, 2
v_and_b32 v190, 3, v1
v_lshlrev_b32 v190, 3, v190
v_add_u32 v190, 128000, v190
v_and_b32 v191, 1, v188
s_cmp_ge_u32 s2, 224
s_cbranch_scc1 L_pso_16
v_lshrrev_b32 v192, 1, v188
v_lshlrev_b32 v192, 4, v192
v_lshl_add_u32 v192, v191, 2, v192
v_add_u32 v192, v192, v189
v_mul_u32_u24 v192, 160, v192
v_add_u32 v192, v192, v190
s_mul_i32 s14, s4, 5120
v_add_u32 v192, s14, v192
ds_read_b64_tr_b16 v[196:197], v192 offset:0
ds_read_b64_tr_b16 v[198:199], v192 offset:1280
ds_read_b64_tr_b16 v[200:201], v192 offset:32
ds_read_b64_tr_b16 v[202:203], v192 offset:1312
ds_read_b64_tr_b16 v[204:205], v192 offset:64
ds_read_b64_tr_b16 v[206:207], v192 offset:1344
ds_read_b64_tr_b16 v[208:209], v192 offset:96
ds_read_b64_tr_b16 v[210:211], v192 offset:1376
ds_read_b64_tr_b16 v[212:213], v192 offset:128
ds_read_b64_tr_b16 v[214:215], v192 offset:1408
s_sub_u32 s15, s2, 128
s_and_b32 s14, s15, 7
s_mul_i32 s14, s14, 245760
s_lshr_b32 s15, s15, 3
s_lshl_b32 s15, s15, 2
s_add_u32 s15, s15, s4
s_mul_i32 s15, s15, 5120
s_add_u32 s15, s15, s14
s_add_u32 s15, s15, 0x2a00000
s_add_u32 s14, s15, 4096
s_waitcnt lgkmcnt(0)
buffer_store_dwordx4 v[196:199], v2, s[44:47], s15 offen offset:0 sc1
buffer_store_dwordx4 v[200:203], v2, s[44:47], s15 offen offset:1024 sc1
buffer_store_dwordx4 v[204:207], v2, s[44:47], s15 offen offset:2048 sc1
buffer_store_dwordx4 v[208:211], v2, s[44:47], s15 offen offset:3072 sc1
buffer_store_dwordx4 v[212:215], v2, s[44:47], s14 offen sc1
s_branch L_pse_17
L_pso_16:
v_lshrrev_b32 v192, 1, v188
v_mul_u32_u24 v192, 24, v192
v_lshl_add_u32 v192, v191, 2, v192
v_add_u32 v192, v192, v189
v_mul_u32_u24 v192, 160, v192
v_add_u32 v192, v192, v190
s_mul_i32 s14, s4, 6400
v_add_u32 v192, s14, v192
v_mul_u32_u24 v193, 40, v188
v_add_u32 v193, v193, v189
v_add_u32 v193, 16, v193
v_lshl_add_u32 v194, v191, 2, v193
v_mul_u32_u24 v194, 160, v194
v_add_u32 v194, v194, v190
v_xor_b32 v191, 1, v191
v_lshl_add_u32 v195, v191, 2, v193
v_mul_u32_u24 v195, 160, v195
v_add_u32 v195, v195, v190
s_lshl_b32 s14, s4, 5
v_add_u32 v188, s14, v194
v_add_u32 v189, s14, v195
ds_read_b64_tr_b16 v[196:197], v192 offset:0
ds_read_b64_tr_b16 v[198:199], v192 offset:1280
ds_read_b64_tr_b16 v[200:201], v192 offset:32
ds_read_b64_tr_b16 v[202:203], v192 offset:1312
ds_read_b64_tr_b16 v[204:205], v192 offset:64
ds_read_b64_tr_b16 v[206:207], v192 offset:1344
ds_read_b64_tr_b16 v[208:209], v192 offset:96
ds_read_b64_tr_b16 v[210:211], v192 offset:1376
ds_read_b64_tr_b16 v[212:213], v192 offset:128
ds_read_b64_tr_b16 v[214:215], v192 offset:1408
ds_read_b64_tr_b16 v[216:217], v188
ds_read_b64_tr_b16 v[218:219], v189
ds_read_b64_tr_b16 v[220:221], v194 offset:128
ds_read_b64_tr_b16 v[222:223], v195 offset:128
s_sub_u32 s15, s2, 224
s_and_b32 s14, s15, 7
s_mul_i32 s14, s14, 102400
s_lshr_b32 s15, s15, 3
s_lshr_b32 s64, s15, 1
s_mul_i32 s64, s64, 51200
s_add_u32 s14, s14, s64
s_add_u32 s14, s14, 0x2400000
s_and_b32 s15, s15, 1
s_lshl_b32 s64, s15, 2
s_add_u32 s64, s64, s4
s_mul_i32 s64, s64, 5120
s_add_u32 s64, s64, s14
s_add_u32 s15, s15, 8
s_mul_i32 s15, s15, 5120
s_add_u32 s15, s15, s14
s_add_u32 s65, s64, 4096
s_waitcnt lgkmcnt(0)
buffer_store_dwordx4 v[196:199], v2, s[44:47], s64 offen offset:0 sc1
buffer_store_dwordx4 v[200:203], v2, s[44:47], s64 offen offset:1024 sc1
buffer_store_dwordx4 v[204:207], v2, s[44:47], s64 offen offset:2048 sc1
buffer_store_dwordx4 v[208:211], v2, s[44:47], s64 offen offset:3072 sc1
buffer_store_dwordx4 v[212:215], v2, s[44:47], s65 offen sc1
s_add_u32 s14, s15, 4096
buffer_store_dwordx4 v[220:223], v2, s[44:47], s14 offen sc1
s_lshl_b32 s14, s4, 10
s_add_u32 s15, s15, s14
buffer_store_dwordx4 v[216:219], v2, s[44:47], s15 offen sc1
L_pse_17:
s_waitcnt vmcnt(22) lgkmcnt(4)
v_mfma_f32_32x32x16_bf16 a[0:15], a[64:67], v[76:79], a[0:15]
ds_read_b128 v[24:27], v3 offset:320
ds_read_b128 v[28:31], v3 offset:336
v_fma_mix_f32 v48, v80, v16, v16 op_sel:[0,0,1] op_sel_hi:[1,1,1]
v_fma_mix_f32 v49, v80, v17, v17 op_sel:[1,0,1] op_sel_hi:[1,1,1]
v_cvt_pk_bf16_f32 v80, v48, v49
s_add_u32 s79, s78, 61440
s_add_u32 m0, s77, s79
s_add_u32 s79, s76, s79
buffer_load_dwordx4 v2, s[44:47], s79 offen sc1 lds
v_mfma_f32_32x32x16_bf16 a[16:31], a[68:71], v[76:79], a[16:31]
ds_read_b128 a[96:99], v2 offset:19200
ds_read_b128 a[100:103], v2 offset:20224
v_fma_mix_f32 v50, v81, v18, v18 op_sel:[0,0,1] op_sel_hi:[1,1,1]
v_fma_mix_f32 v51, v81, v19, v19 op_sel:[1,0,1] op_sel_hi:[1,1,1]
v_cvt_pk_bf16_f32 v81, v50, v51
v_mfma_f32_32x32x16_bf16 a[32:47], a[72:75], v[76:79], a[32:47]
ds_read_b128 a[104:107], v2 offset:21248
ds_read_b128 a[108:111], v6 offset:19200
v_fma_mix_f32 v48, v82, v20, v20 op_sel:[0,0,1] op_sel_hi:[1,1,1]
v_fma_mix_f32 v49, v82, v21, v21 op_sel:[1,0,1] op_sel_hi:[1,1,1]
v_cvt_pk_bf16_f32 v82, v48, v49
buffer_load_dwordx4 v[108:111], v2, s[44:47], s12 offen offset:3072 sc1
v_mfma_f32_32x32x16_bf16 a[48:63], a[76:79], v[76:79], a[48:63]
v_fma_mix_f32 v50, v83, v22, v22 op_sel:[0,0,1] op_sel_hi:[1,1,1]
v_fma_mix_f32 v51, v83, v23, v23 op_sel:[1,0,1] op_sel_hi:[1,1,1]
v_cvt_pk_bf16_f32 v83, v50, v51
s_waitcnt vmcnt(23) lgkmcnt(4)
s_nop 0
v_mfma_f32_32x32x16_bf16 a[0:15], a[80:83], v[80:83], a[0:15]
ds_read_b128 v[16:19], v3 offset:384
ds_read_b128 v[20:23], v3 offset:400
v_fma_mix_f32 v48, v84, v24, v24 op_sel:[0,0,1] op_sel_hi:[1,1,1]
v_fma_mix_f32 v49, v84, v25, v25 op_sel:[1,0,1] op_sel_hi:[1,1,1]
v_cvt_pk_bf16_f32 v84, v48, v49
s_add_u32 m0, s77, 76800
s_add_u32 s79, s76, 76800
buffer_load_dwordx4 v2, s[44:47], s79 offen sc1 lds
v_mfma_f32_32x32x16_bf16 a[16:31], a[84:87], v[80:83], a[16:31]
ds_read_b128 a[64:67], v2 offset:23040
ds_read_b128 a[68:71], v2 offset:24064
v_fma_mix_f32 v50, v85, v26, v26 op_sel:[0,0,1] op_sel_hi:[1,1,1]
v_fma_mix_f32 v51, v85, v27, v27 op_sel:[1,0,1] op_sel_hi:[1,1,1]
v_cvt_pk_bf16_f32 v85, v50, v51
v_mfma_f32_32x32x16_bf16 a[32:47], a[88:91], v[80:83], a[32:47]
ds_read_b128 a[72:75], v2 offset:25088
ds_read_b128 a[76:79], v6 offset:23040
v_fma_mix_f32 v48, v86, v28, v28 op_sel:[0,0,1] op_sel_hi:[1,1,1]
v_fma_mix_f32 v49, v86, v29, v29 op_sel:[1,0,1] op_sel_hi:[1,1,1]
v_cvt_pk_bf16_f32 v86, v48, v49
s_add_u32 s12, s12, 4096
buffer_load_dwordx4 v[112:115], v2, s[44:47], s12 offen offset:0 sc1
v_mfma_f32_32x32x16_bf16 a[48:63], a[92:95], v[80:83], a[48:63]
v_fma_mix_f32 v50, v87, v30, v30 op_sel:[0,0,1] op_sel_hi:[1,1,1]
v_fma_mix_f32 v51, v87, v31, v31 op_sel:[1,0,1] op_sel_hi:[1,1,1]
v_cvt_pk_bf16_f32 v87, v50, v51
s_waitcnt vmcnt(24) lgkmcnt(4)
s_nop 0
v_mfma_f32_32x32x16_bf16 a[0:15], a[96:99], v[84:87], a[0:15]
ds_read_b128 v[24:27], v3 offset:448
ds_read_b128 v[28:31], v3 offset:464
v_fma_mix_f32 v48, v88, v16, v16 op_sel:[0,0,1] op_sel_hi:[1,1,1]
v_fma_mix_f32 v49, v88, v17, v17 op_sel:[1,0,1] op_sel_hi:[1,1,1]
v_cvt_pk_bf16_f32 v88, v48, v49
s_add_u32 m0, s77, 80896
s_add_u32 s79, s76, 80896
buffer_load_dwordx4 v2, s[44:47], s79 offen sc1 lds
v_mfma_f32_32x32x16_bf16 a[16:31], a[100:103], v[84:87], a[16:31]
ds_read_b128 a[80:83], v2 offset:26880
ds_read_b128 a[84:87], v2 offset:27904
v_fma_mix_f32 v50, v89, v18, v18 op_sel:[0,0,1] op_sel_hi:[1,1,1]
v_fma_mix_f32 v51, v89, v19, v19 op_sel:[1,0,1] op_sel_hi:[1,1,1]
v_cvt_pk_bf16_f32 v89, v50, v51
v_mfma_f32_32x32x16_bf16 a[32:47], a[104:107], v[84:87], a[32:47]
ds_read_b128 a[88:91], v2 offset:28928
ds_read_b128 a[92:95], v6 offset:26880
v_fma_mix_f32 v48, v90, v20, v20 op_sel:[0,0,1] op_sel_hi:[1,1,1]
v_fma_mix_f32 v49, v90, v21, v21 op_sel:[1,0,1] op_sel_hi:[1,1,1]
v_cvt_pk_bf16_f32 v90, v48, v49
buffer_load_dwordx4 v[116:119], v2, s[44:47], s12 offen offset:1024 sc1
v_mfma_f32_32x32x16_bf16 a[48:63], a[108:111], v[84:87], a[48:63]
v_fma_mix_f32 v50, v91, v22, v22 op_sel:[0,0,1] op_sel_hi:[1,1,1]
v_fma_mix_f32 v51, v91, v23, v23 op_sel:[1,0,1] op_sel_hi:[1,1,1]
v_cvt_pk_bf16_f32 v91, v50, v51
s_waitcnt vmcnt(21)
s_barrier
s_waitcnt lgkmcnt(4)
v_mfma_f32_32x32x16_bf16 a[0:15], a[64:67], v[88:91], a[0:15]
ds_read_b128 v[16:19], v3 offset:512
ds_read_b128 v[20:23], v3 offset:528
v_fma_mix_f32 v48, v92, v24, v24 op_sel:[0,0,1] op_sel_hi:[1,1,1]
v_fma_mix_f32 v49, v92, v25, v25 op_sel:[1,0,1] op_sel_hi:[1,1,1]
v_cvt_pk_bf16_f32 v92, v48, v49
s_add_u32 m0, s77, 84992
s_add_u32 s79, s76, 84992
buffer_load_dwordx4 v2, s[44:47], s79 offen sc1 lds
v_mfma_f32_32x32x16_bf16 a[16:31], a[68:71], v[88:91], a[16:31]
ds_read_b128 a[96:99], v2 offset:30720
ds_read_b128 a[100:103], v2 offset:31744
v_fma_mix_f32 v50, v93, v26, v26 op_sel:[0,0,1] op_sel_hi:[1,1,1]
v_fma_mix_f32 v51, v93, v27, v27 op_sel:[1,0,1] op_sel_hi:[1,1,1]
v_cvt_pk_bf16_f32 v93, v50, v51
v_mfma_f32_32x32x16_bf16 a[32:47], a[72:75], v[88:91], a[32:47]
ds_read_b128 a[104:107], v2 offset:32768
ds_read_b128 a[108:111], v6 offset:30720
v_fma_mix_f32 v48, v94, v28, v28 op_sel:[0,0,1] op_sel_hi:[1,1,1]
v_fma_mix_f32 v49, v94, v29, v29 op_sel:[1,0,1] op_sel_hi:[1,1,1]
v_cvt_pk_bf16_f32 v94, v48, v49
buffer_load_dwordx4 v[120:123], v2, s[44:47], s12 offen offset:2048 sc1
v_mfma_f32_32x32x16_bf16 a[48:63], a[76:79], v[88:91], a[48:63]
v_fma_mix_f32 v50, v95, v30, v30 op_sel:[0,0,1] op_sel_hi:[1,1,1]
v_fma_mix_f32 v51, v95, v31, v31 op_sel:[1,0,1] op_sel_hi:[1,1,1]
v_cvt_pk_bf16_f32 v95, v50, v51
s_waitcnt vmcnt(17) lgkmcnt(4)
s_nop 0
v_mfma_f32_32x32x16_bf16 a[0:15], a[80:83], v[92:95], a[0:15]
ds_read_b128 v[24:27], v3 offset:576
ds_read_b128 v[28:31], v3 offset:592
v_fma_mix_f32 v48, v96, v16, v16 op_sel:[0,0,1] op_sel_hi:[1,1,1]
v_fma_mix_f32 v49, v96, v17, v17 op_sel:[1,0,1] op_sel_hi:[1,1,1]
v_cvt_pk_bf16_f32 v96, v48, v49
s_add_u32 s79, s78, 76800
s_add_u32 m0, s77, s79
s_add_u32 s79, s76, s79
buffer_load_dwordx4 v2, s[44:47], s79 offen sc1 lds
v_mfma_f32_32x32x16_bf16 a[16:31], a[84:87], v[92:95], a[16:31]
ds_read_b128 a[64:67], v2 offset:34560
ds_read_b128 a[68:71], v2 offset:35584
v_fma_mix_f32 v50, v97, v18, v18 op_sel:[0,0,1] op_sel_hi:[1,1,1]
v_fma_mix_f32 v51, v97, v19, v19 op_sel:[1,0,1] op_sel_hi:[1,1,1]
v_cvt_pk_bf16_f32 v97, v50, v51
v_mfma_f32_32x32x16_bf16 a[32:47], a[88:91], v[92:95], a[32:47]
ds_read_b128 a[72:75], v2 offset:36608
ds_read_b128 a[76:79], v6 offset:34560
v_fma_mix_f32 v48, v98, v20, v20 op_sel:[0,0,1] op_sel_hi:[1,1,1]
v_fma_mix_f32 v49, v98, v21, v21 op_sel:[1,0,1] op_sel_hi:[1,1,1]
v_cvt_pk_bf16_f32 v98, v48, v49
buffer_load_dwordx4 v[124:127], v2, s[44:47], s12 offen offset:3072 sc1
v_mfma_f32_32x32x16_bf16 a[48:63], a[92:95], v[92:95], a[48:63]
v_fma_mix_f32 v50, v99, v22, v22 op_sel:[0,0,1] op_sel_hi:[1,1,1]
v_fma_mix_f32 v51, v99, v23, v23 op_sel:[1,0,1] op_sel_hi:[1,1,1]
v_cvt_pk_bf16_f32 v99, v50, v51
s_waitcnt vmcnt(17) lgkmcnt(4)
s_nop 0
v_mfma_f32_32x32x16_bf16 a[0:15], a[96:99], v[96:99], a[0:15]
ds_read_b128 v[16:19], v3 offset:640
ds_read_b128 v[20:23], v3 offset:656
v_fma_mix_f32 v48, v100, v24, v24 op_sel:[0,0,1] op_sel_hi:[1,1,1]
v_fma_mix_f32 v49, v100, v25, v25 op_sel:[1,0,1] op_sel_hi:[1,1,1]
v_cvt_pk_bf16_f32 v100, v48, v49
s_add_u32 m0, s77, 92160
s_add_u32 s79, s76, 92160
buffer_load_dwordx4 v2, s[44:47], s79 offen sc1 lds
v_mfma_f32_32x32x16_bf16 a[16:31], a[100:103], v[96:99], a[16:31]
ds_read_b128 a[80:83], v2 offset:38400
ds_read_b128 a[84:87], v2 offset:39424
v_fma_mix_f32 v50, v101, v26, v26 op_sel:[0,0,1] op_sel_hi:[1,1,1]
v_fma_mix_f32 v51, v101, v27, v27 op_sel:[1,0,1] op_sel_hi:[1,1,1]
v_cvt_pk_bf16_f32 v101, v50, v51
v_mfma_f32_32x32x16_bf16 a[32:47], a[104:107], v[96:99], a[32:47]
ds_read_b128 a[88:91], v2 offset:40448
ds_read_b128 a[92:95], v6 offset:38400
v_fma_mix_f32 v48, v102, v28, v28 op_sel:[0,0,1] op_sel_hi:[1,1,1]
v_fma_mix_f32 v49, v102, v29, v29 op_sel:[1,0,1] op_sel_hi:[1,1,1]
v_cvt_pk_bf16_f32 v102, v48, v49
s_add_u32 s12, s12, 4096
buffer_load_dwordx4 v[128:131], v2, s[44:47], s12 offen offset:0 sc1
v_mfma_f32_32x32x16_bf16 a[48:63], a[108:111], v[96:99], a[48:63]
v_fma_mix_f32 v50, v103, v30, v30 op_sel:[0,0,1] op_sel_hi:[1,1,1]
v_fma_mix_f32 v51, v103, v31, v31 op_sel:[1,0,1] op_sel_hi:[1,1,1]
v_cvt_pk_bf16_f32 v103, v50, v51
s_waitcnt vmcnt(17) lgkmcnt(4)
s_nop 0
v_mfma_f32_32x32x16_bf16 a[0:15], a[64:67], v[100:103], a[0:15]
ds_read_b128 v[24:27], v3 offset:704
ds_read_b128 v[28:31], v3 offset:720
v_fma_mix_f32 v48, v104, v16, v16 op_sel:[0,0,1] op_sel_hi:[1,1,1]
v_fma_mix_f32 v49, v104, v17, v17 op_sel:[1,0,1] op_sel_hi:[1,1,1]
v_cvt_pk_bf16_f32 v104, v48, v49
s_add_u32 m0, s77, 96256
s_add_u32 s79, s76, 96256
buffer_load_dwordx4 v2, s[44:47], s79 offen sc1 lds
v_mfma_f32_32x32x16_bf16 a[16:31], a[68:71], v[100:103], a[16:31]
ds_read_b128 a[96:99], v2 offset:42240
ds_read_b128 a[100:103], v2 offset:43264
v_fma_mix_f32 v50, v105, v18, v18 op_sel:[0,0,1] op_sel_hi:[1,1,1]
v_fma_mix_f32 v51, v105, v19, v19 op_sel:[1,0,1] op_sel_hi:[1,1,1]
v_cvt_pk_bf16_f32 v105, v50, v51
v_mfma_f32_32x32x16_bf16 a[32:47], a[72:75], v[100:103], a[32:47]
ds_read_b128 a[104:107], v2 offset:44288
ds_read_b128 a[108:111], v6 offset:42240
v_fma_mix_f32 v48, v106, v20, v20 op_sel:[0,0,1] op_sel_hi:[1,1,1]
v_fma_mix_f32 v49, v106, v21, v21 op_sel:[1,0,1] op_sel_hi:[1,1,1]
v_cvt_pk_bf16_f32 v106, v48, v49
buffer_load_dwordx4 v[132:135], v2, s[44:47], s12 offen offset:1024 sc1
v_mfma_f32_32x32x16_bf16 a[48:63], a[76:79], v[100:103], a[48:63]
v_fma_mix_f32 v50, v107, v22, v22 op_sel:[0,0,1] op_sel_hi:[1,1,1]
v_fma_mix_f32 v51, v107, v23, v23 op_sel:[1,0,1] op_sel_hi:[1,1,1]
v_cvt_pk_bf16_f32 v107, v50, v51
s_barrier
s_waitcnt vmcnt(12) lgkmcnt(4)
v_mfma_f32_32x32x16_bf16 a[0:15], a[80:83], v[104:107], a[0:15]
ds_read_b128 v[16:19], v3 offset:768
ds_read_b128 v[20:23], v3 offset:784
v_fma_mix_f32 v48, v108, v24, v24 op_sel:[0,0,1] op_sel_hi:[1,1,1]
v_fma_mix_f32 v49, v108, v25, v25 op_sel:[1,0,1] op_sel_hi:[1,1,1]
v_cvt_pk_bf16_f32 v108, v48, v49
s_add_u32 m0, s77, 100352
s_add_u32 s79, s76, 100352
buffer_load_dwordx4 v2, s[44:47], s79 offen sc1 lds
v_mfma_f32_32x32x16_bf16 a[16:31], a[84:87], v[104:107], a[16:31]
ds_read_b128 a[64:67], v2 offset:46080
ds_read_b128 a[68:71], v2 offset:47104
v_fma_mix_f32 v50, v109, v26, v26 op_sel:[0,0,1] op_sel_hi:[1,1,1]
v_fma_mix_f32 v51, v109, v27, v27 op_sel:[1,0,1] op_sel_hi:[1,1,1]
v_cvt_pk_bf16_f32 v109, v50, v51
v_mfma_f32_32x32x16_bf16 a[32:47], a[88:91], v[104:107], a[32:47]
ds_read_b128 a[72:75], v2 offset:48128
ds_read_b128 a[76:79], v6 offset:46080
v_fma_mix_f32 v48, v110, v28, v28 op_sel:[0,0,1] op_sel_hi:[1,1,1]
v_fma_mix_f32 v49, v110, v29, v29 op_sel:[1,0,1] op_sel_hi:[1,1,1]
v_cvt_pk_bf16_f32 v110, v48, v49
buffer_load_dwordx4 v[136:139], v2, s[44:47], s12 offen offset:2048 sc1
v_mfma_f32_32x32x16_bf16 a[48:63], a[92:95], v[104:107], a[48:63]
v_fma_mix_f32 v50, v111, v30, v30 op_sel:[0,0,1] op_sel_hi:[1,1,1]
v_fma_mix_f32 v51, v111, v31, v31 op_sel:[1,0,1] op_sel_hi:[1,1,1]
v_cvt_pk_bf16_f32 v111, v50, v51
s_waitcnt vmcnt(12) lgkmcnt(4)
s_nop 0
v_mfma_f32_32x32x16_bf16 a[0:15], a[96:99], v[108:111], a[0:15]
ds_read_b128 v[24:27], v3 offset:832
ds_read_b128 v[28:31], v3 offset:848
v_fma_mix_f32 v48, v112, v16, v16 op_sel:[0,0,1] op_sel_hi:[1,1,1]
v_fma_mix_f32 v49, v112, v17, v17 op_sel:[1,0,1] op_sel_hi:[1,1,1]
v_cvt_pk_bf16_f32 v112, v48, v49
s_add_u32 s79, s78, 92160
s_add_u32 m0, s77, s79
s_add_u32 s79, s76, s79
buffer_load_dwordx4 v2, s[44:47], s79 offen sc1 lds
v_mfma_f32_32x32x16_bf16 a[16:31], a[100:103], v[108:111], a[16:31]
ds_read_b128 a[80:83], v2 offset:49920
ds_read_b128 a[84:87], v2 offset:50944
v_fma_mix_f32 v50, v113, v18, v18 op_sel:[0,0,1] op_sel_hi:[1,1,1]
v_fma_mix_f32 v51, v113, v19, v19 op_sel:[1,0,1] op_sel_hi:[1,1,1]
v_cvt_pk_bf16_f32 v113, v50, v51
v_mfma_f32_32x32x16_bf16 a[32:47], a[104:107], v[108:111], a[32:47]
ds_read_b128 a[88:91], v2 offset:51968
ds_read_b128 a[92:95], v6 offset:49920
v_fma_mix_f32 v48, v114, v20, v20 op_sel:[0,0,1] op_sel_hi:[1,1,1]
v_fma_mix_f32 v49, v114, v21, v21 op_sel:[1,0,1] op_sel_hi:[1,1,1]
v_cvt_pk_bf16_f32 v114, v48, v49
buffer_load_dwordx4 v[140:143], v2, s[44:47], s12 offen offset:3072 sc1
v_mfma_f32_32x32x16_bf16 a[48:63], a[108:111], v[108:111], a[48:63]
v_fma_mix_f32 v50, v115, v22, v22 op_sel:[0,0,1] op_sel_hi:[1,1,1]
v_fma_mix_f32 v51, v115, v23, v23 op_sel:[1,0,1] op_sel_hi:[1,1,1]
v_cvt_pk_bf16_f32 v115, v50, v51
s_waitcnt vmcnt(12) lgkmcnt(4)
s_nop 0
v_mfma_f32_32x32x16_bf16 a[0:15], a[64:67], v[112:115], a[0:15]
ds_read_b128 v[16:19], v3 offset:896
ds_read_b128 v[20:23], v3 offset:912
v_fma_mix_f32 v48, v116, v24, v24 op_sel:[0,0,1] op_sel_hi:[1,1,1]
v_fma_mix_f32 v49, v116, v25, v25 op_sel:[1,0,1] op_sel_hi:[1,1,1]
v_cvt_pk_bf16_f32 v116, v48, v49
s_add_u32 m0, s77, 107520
s_add_u32 s79, s76, 107520
buffer_load_dwordx4 v2, s[44:47], s79 offen sc1 lds
v_mfma_f32_32x32x16_bf16 a[16:31], a[68:71], v[112:115], a[16:31]
ds_read_b128 a[96:99], v2 offset:53760
ds_read_b128 a[100:103], v2 offset:54784
v_fma_mix_f32 v50, v117, v26, v26 op_sel:[0,0,1] op_sel_hi:[1,1,1]
v_fma_mix_f32 v51, v117, v27, v27 op_sel:[1,0,1] op_sel_hi:[1,1,1]
v_cvt_pk_bf16_f32 v117, v50, v51
v_mfma_f32_32x32x16_bf16 a[32:47], a[72:75], v[112:115], a[32:47]
ds_read_b128 a[104:107], v2 offset:55808
ds_read_b128 a[108:111], v6 offset:53760
v_fma_mix_f32 v48, v118, v28, v28 op_sel:[0,0,1] op_sel_hi:[1,1,1]
v_fma_mix_f32 v49, v118, v29, v29 op_sel:[1,0,1] op_sel_hi:[1,1,1]
v_cvt_pk_bf16_f32 v118, v48, v49
s_add_u32 s12, s12, 4096
buffer_load_dwordx4 v[144:147], v2, s[44:47], s12 offen offset:0 sc1
v_mfma_f32_32x32x16_bf16 a[48:63], a[76:79], v[112:115], a[48:63]
v_fma_mix_f32 v50, v119, v30, v30 op_sel:[0,0,1] op_sel_hi:[1,1,1]
v_fma_mix_f32 v51, v119, v31, v31 op_sel:[1,0,1] op_sel_hi:[1,1,1]
v_cvt_pk_bf16_f32 v119, v50, v51
s_waitcnt vmcnt(12) lgkmcnt(4)
s_nop 0
v_mfma_f32_32x32x16_bf16 a[0:15], a[80:83], v[116:119], a[0:15]
ds_read_b128 v[24:27], v3 offset:960
ds_read_b128 v[28:31], v3 offset:976
v_fma_mix_f32 v48, v120, v16, v16 op_sel:[0,0,1] op_sel_hi:[1,1,1]
v_fma_mix_f32 v49, v120, v17, v17 op_sel:[1,0,1] op_sel_hi:[1,1,1]
v_cvt_pk_bf16_f32 v120, v48, v49
s_add_u32 m0, s77, 111616
s_add_u32 s79, s76, 111616
buffer_load_dwordx4 v2, s[44:47], s79 offen sc1 lds
v_mfma_f32_32x32x16_bf16 a[16:31], a[84:87], v[116:119], a[16:31]
ds_read_b128 a[64:67], v2 offset:57600
ds_read_b128 a[68:71], v2 offset:58624
v_fma_mix_f32 v50, v121, v18, v18 op_sel:[0,0,1] op_sel_hi:[1,1,1]
v_fma_mix_f32 v51, v121, v19, v19 op_sel:[1,0,1] op_sel_hi:[1,1,1]
v_cvt_pk_bf16_f32 v121, v50, v51
v_mfma_f32_32x32x16_bf16 a[32:47], a[88:91], v[116:119], a[32:47]
ds_read_b128 a[72:75], v2 offset:59648
ds_read_b128 a[76:79], v6 offset:57600
v_fma_mix_f32 v48, v122, v20, v20 op_sel:[0,0,1] op_sel_hi:[1,1,1]
v_fma_mix_f32 v49, v122, v21, v21 op_sel:[1,0,1] op_sel_hi:[1,1,1]
v_cvt_pk_bf16_f32 v122, v48, v49
buffer_load_dwordx4 v[148:151], v2, s[44:47], s12 offen offset:1024 sc1
v_mfma_f32_32x32x16_bf16 a[48:63], a[92:95], v[116:119], a[48:63]
v_fma_mix_f32 v50, v123, v22, v22 op_sel:[0,0,1] op_sel_hi:[1,1,1]
v_fma_mix_f32 v51, v123, v23, v23 op_sel:[1,0,1] op_sel_hi:[1,1,1]
v_cvt_pk_bf16_f32 v123, v50, v51
s_barrier
s_waitcnt vmcnt(12) lgkmcnt(4)
v_mfma_f32_32x32x16_bf16 a[0:15], a[96:99], v[120:123], a[0:15]
ds_read_b128 v[16:19], v3 offset:1024
ds_read_b128 v[20:23], v3 offset:1040
v_fma_mix_f32 v48, v124, v24, v24 op_sel:[0,0,1] op_sel_hi:[1,1,1]
v_fma_mix_f32 v49, v124, v25, v25 op_sel:[1,0,1] op_sel_hi:[1,1,1]
v_cvt_pk_bf16_f32 v124, v48, v49
s_add_u32 m0, s77, 115712
s_add_u32 s79, s76, 115712
buffer_load_dwordx4 v2, s[44:47], s79 offen sc1 lds
v_mfma_f32_32x32x16_bf16 a[16:31], a[100:103], v[120:123], a[16:31]
ds_read_b128 a[80:83], v4 offset:0
ds_read_b128 a[84:87], v4 offset:1024
v_fma_mix_f32 v50, v125, v26, v26 op_sel:[0,0,1] op_sel_hi:[1,1,1]
v_fma_mix_f32 v51, v125, v27, v27 op_sel:[1,0,1] op_sel_hi:[1,1,1]
v_cvt_pk_bf16_f32 v125, v50, v51
v_mfma_f32_32x32x16_bf16 a[32:47], a[104:107], v[120:123], a[32:47]
ds_read_b128 a[88:91], v4 offset:2048
ds_read_b128 a[92:95], v7 offset:0
v_fma_mix_f32 v48, v126, v28, v28 op_sel:[0,0,1] op_sel_hi:[1,1,1]
v_fma_mix_f32 v49, v126, v29, v29 op_sel:[1,0,1] op_sel_hi:[1,1,1]
v_cvt_pk_bf16_f32 v126, v48, v49
buffer_load_dwordx4 v[152:155], v2, s[44:47], s12 offen offset:2048 sc1
v_mfma_f32_32x32x16_bf16 a[48:63], a[108:111], v[120:123], a[48:63]
v_fma_mix_f32 v50, v127, v30, v30 op_sel:[0,0,1] op_sel_hi:[1,1,1]
v_fma_mix_f32 v51, v127, v31, v31 op_sel:[1,0,1] op_sel_hi:[1,1,1]
v_cvt_pk_bf16_f32 v127, v50, v51
s_waitcnt vmcnt(12) lgkmcnt(4)
s_nop 0
v_mfma_f32_32x32x16_bf16 a[0:15], a[64:67], v[124:127], a[0:15]
ds_read_b128 v[24:27], v3 offset:1088
ds_read_b128 v[28:31], v3 offset:1104
v_fma_mix_f32 v48, v128, v16, v16 op_sel:[0,0,1] op_sel_hi:[1,1,1]
v_fma_mix_f32 v49, v128, v17, v17 op_sel:[1,0,1] op_sel_hi:[1,1,1]
v_cvt_pk_bf16_f32 v128, v48, v49
s_add_u32 s79, s78, 107520
s_add_u32 m0, s77, s79
s_add_u32 s79, s76, s79
buffer_load_dwordx4 v2, s[44:47], s79 offen sc1 lds
v_mfma_f32_32x32x16_bf16 a[16:31], a[68:71], v[124:127], a[16:31]
ds_read_b128 a[96:99], v4 offset:3840
ds_read_b128 a[100:103], v4 offset:4864
v_fma_mix_f32 v50, v129, v18, v18 op_sel:[0,0,1] op_sel_hi:[1,1,1]
v_fma_mix_f32 v51, v129, v19, v19 op_sel:[1,0,1] op_sel_hi:[1,1,1]
v_cvt_pk_bf16_f32 v129, v50, v51
v_mfma_f32_32x32x16_bf16 a[32:47], a[72:75], v[124:127], a[32:47]
ds_read_b128 a[104:107], v4 offset:5888
ds_read_b128 a[108:111], v7 offset:3840
v_fma_mix_f32 v48, v130, v20, v20 op_sel:[0,0,1] op_sel_hi:[1,1,1]
v_fma_mix_f32 v49, v130, v21, v21 op_sel:[1,0,1] op_sel_hi:[1,1,1]
v_cvt_pk_bf16_f32 v130, v48, v49
buffer_load_dwordx4 v[156:159], v2, s[44:47], s12 offen offset:3072 sc1
v_mfma_f32_32x32x16_bf16 a[48:63], a[76:79], v[124:127], a[48:63]
v_fma_mix_f32 v50, v131, v22, v22 op_sel:[0,0,1] op_sel_hi:[1,1,1]
v_fma_mix_f32 v51, v131, v23, v23 op_sel:[1,0,1] op_sel_hi:[1,1,1]
v_cvt_pk_bf16_f32 v131, v50, v51
s_waitcnt vmcnt(12) lgkmcnt(4)
s_nop 0
v_mfma_f32_32x32x16_bf16 a[0:15], a[80:83], v[128:131], a[0:15]
ds_read_b128 v[16:19], v3 offset:1152
ds_read_b128 v[20:23], v3 offset:1168
v_fma_mix_f32 v48, v132, v24, v24 op_sel:[0,0,1] op_sel_hi:[1,1,1]
v_fma_mix_f32 v49, v132, v25, v25 op_sel:[1,0,1] op_sel_hi:[1,1,1]
v_cvt_pk_bf16_f32 v132, v48, v49
s_add_u32 m0, s77, 122880
s_add_u32 s79, s76, 122880
buffer_load_dwordx4 v2, s[44:47], s79 offen sc1 lds
v_mfma_f32_32x32x16_bf16 a[16:31], a[84:87], v[128:131], a[16:31]
ds_read_b128 a[64:67], v4 offset:7680
ds_read_b128 a[68:71], v4 offset:8704
v_fma_mix_f32 v50, v133, v26, v26 op_sel:[0,0,1] op_sel_hi:[1,1,1]
v_fma_mix_f32 v51, v133, v27, v27 op_sel:[1,0,1] op_sel_hi:[1,1,1]
v_cvt_pk_bf16_f32 v133, v50, v51
v_mfma_f32_32x32x16_bf16 a[32:47], a[88:91], v[128:131], a[32:47]
ds_read_b128 a[72:75], v4 offset:9728
ds_read_b128 a[76:79], v7 offset:7680
v_fma_mix_f32 v48, v134, v28, v28 op_sel:[0,0,1] op_sel_hi:[1,1,1]
v_fma_mix_f32 v49, v134, v29, v29 op_sel:[1,0,1] op_sel_hi:[1,1,1]
v_cvt_pk_bf16_f32 v134, v48, v49
s_add_u32 s12, s12, 4096
buffer_load_dwordx4 v[160:163], v2, s[44:47], s12 offen offset:0 sc1
v_mfma_f32_32x32x16_bf16 a[48:63], a[92:95], v[128:131], a[48:63]
v_fma_mix_f32 v50, v135, v30, v30 op_sel:[0,0,1] op_sel_hi:[1,1,1]
v_fma_mix_f32 v51, v135, v31, v31 op_sel:[1,0,1] op_sel_hi:[1,1,1]
v_cvt_pk_bf16_f32 v135, v50, v51
s_waitcnt vmcnt(12) lgkmcnt(4)
s_nop 0
v_mfma_f32_32x32x16_bf16 a[0:15], a[96:99], v[132:135], a[0:15]
ds_read_b128 v[24:27], v3 offset:1216
ds_read_b128 v[28:31], v3 offset:1232
v_fma_mix_f32 v48, v136, v16, v16 op_sel:[0,0,1] op_sel_hi:[1,1,1]
v_fma_mix_f32 v49, v136, v17, v17 op_sel:[1,0,1] op_sel_hi:[1,1,1]
v_cvt_pk_bf16_f32 v136, v48, v49
s_add_u32 m0, s77, 126976
s_add_u32 s79, s76, 126976
buffer_load_dwordx4 v2, s[44:47], s79 offen sc1 lds
v_mfma_f32_32x32x16_bf16 a[16:31], a[100:103], v[132:135], a[16:31]
ds_read_b128 a[80:83], v4 offset:11520
ds_read_b128 a[84:87], v4 offset:12544
v_fma_mix_f32 v50, v137, v18, v18 op_sel:[0,0,1] op_sel_hi:[1,1,1]
v_fma_mix_f32 v51, v137, v19, v19 op_sel:[1,0,1] op_sel_hi:[1,1,1]
v_cvt_pk_bf16_f32 v137, v50, v51
v_mfma_f32_32x32x16_bf16 a[32:47], a[104:107], v[132:135], a[32:47]
ds_read_b128 a[88:91], v4 offset:13568
ds_read_b128 a[92:95], v7 offset:11520
v_fma_mix_f32 v48, v138, v20, v20 op_sel:[0,0,1] op_sel_hi:[1,1,1]
v_fma_mix_f32 v49, v138, v21, v21 op_sel:[1,0,1] op_sel_hi:[1,1,1]
v_cvt_pk_bf16_f32 v138, v48, v49
buffer_load_dwordx4 v[164:167], v2, s[44:47], s12 offen offset:1024 sc1
v_mfma_f32_32x32x16_bf16 a[48:63], a[108:111], v[132:135], a[48:63]
v_fma_mix_f32 v50, v139, v22, v22 op_sel:[0,0,1] op_sel_hi:[1,1,1]
v_fma_mix_f32 v51, v139, v23, v23 op_sel:[1,0,1] op_sel_hi:[1,1,1]
v_cvt_pk_bf16_f32 v139, v50, v51
s_barrier
s_waitcnt vmcnt(12) lgkmcnt(4)
v_mfma_f32_32x32x16_bf16 a[0:15], a[64:67], v[136:139], a[0:15]
ds_read_b128 v[16:19], v3 offset:1280
ds_read_b128 v[20:23], v3 offset:1296
v_fma_mix_f32 v48, v140, v24, v24 op_sel:[0,0,1] op_sel_hi:[1,1,1]
v_fma_mix_f32 v49, v140, v25, v25 op_sel:[1,0,1] op_sel_hi:[1,1,1]
v_cvt_pk_bf16_f32 v140, v48, v49
s_add_u32 m0, s77, 131072
s_add_u32 s79, s76, 131072
buffer_load_dwordx4 v2, s[44:47], s79 offen sc1 lds
v_mfma_f32_32x32x16_bf16 a[16:31], a[68:71], v[136:139], a[16:31]
ds_read_b128 a[96:99], v4 offset:15360
ds_read_b128 a[100:103], v4 offset:16384
v_fma_mix_f32 v50, v141, v26, v26 op_sel:[0,0,1] op_sel_hi:[1,1,1]
v_fma_mix_f32 v51, v141, v27, v27 op_sel:[1,0,1] op_sel_hi:[1,1,1]
v_cvt_pk_bf16_f32 v141, v50, v51
v_mfma_f32_32x32x16_bf16 a[32:47], a[72:75], v[136:139], a[32:47]
ds_read_b128 a[104:107], v4 offset:17408
ds_read_b128 a[108:111], v7 offset:15360
v_fma_mix_f32 v48, v142, v28, v28 op_sel:[0,0,1] op_sel_hi:[1,1,1]
v_fma_mix_f32 v49, v142, v29, v29 op_sel:[1,0,1] op_sel_hi:[1,1,1]
v_cvt_pk_bf16_f32 v142, v48, v49
buffer_load_dwordx4 v[168:171], v2, s[44:47], s12 offen offset:2048 sc1
v_mfma_f32_32x32x16_bf16 a[48:63], a[76:79], v[136:139], a[48:63]
v_fma_mix_f32 v50, v143, v30, v30 op_sel:[0,0,1] op_sel_hi:[1,1,1]
v_fma_mix_f32 v51, v143, v31, v31 op_sel:[1,0,1] op_sel_hi:[1,1,1]
v_cvt_pk_bf16_f32 v143, v50, v51
s_waitcnt vmcnt(12) lgkmcnt(4)
s_nop 0
v_mfma_f32_32x32x16_bf16 a[0:15], a[80:83], v[140:143], a[0:15]
ds_read_b128 v[24:27], v3 offset:1344
ds_read_b128 v[28:31], v3 offset:1360
v_fma_mix_f32 v48, v144, v16, v16 op_sel:[0,0,1] op_sel_hi:[1,1,1]
v_fma_mix_f32 v49, v144, v17, v17 op_sel:[1,0,1] op_sel_hi:[1,1,1]
v_cvt_pk_bf16_f32 v144, v48, v49
s_add_u32 s79, s78, 122880
s_add_u32 m0, s77, s79
s_add_u32 s79, s76, s79
buffer_load_dwordx4 v2, s[44:47], s79 offen sc1 lds
v_mfma_f32_32x32x16_bf16 a[16:31], a[84:87], v[140:143], a[16:31]
ds_read_b128 a[64:67], v4 offset:19200
ds_read_b128 a[68:71], v4 offset:20224
v_fma_mix_f32 v50, v145, v18, v18 op_sel:[0,0,1] op_sel_hi:[1,1,1]
v_fma_mix_f32 v51, v145, v19, v19 op_sel:[1,0,1] op_sel_hi:[1,1,1]
v_cvt_pk_bf16_f32 v145, v50, v51
v_mfma_f32_32x32x16_bf16 a[32:47], a[88:91], v[140:143], a[32:47]
ds_read_b128 a[72:75], v4 offset:21248
ds_read_b128 a[76:79], v7 offset:19200
v_fma_mix_f32 v48, v146, v20, v20 op_sel:[0,0,1] op_sel_hi:[1,1,1]
v_fma_mix_f32 v49, v146, v21, v21 op_sel:[1,0,1] op_sel_hi:[1,1,1]
v_cvt_pk_bf16_f32 v146, v48, v49
buffer_load_dwordx4 v[172:175], v2, s[44:47], s12 offen offset:3072 sc1
v_mfma_f32_32x32x16_bf16 a[48:63], a[92:95], v[140:143], a[48:63]
v_fma_mix_f32 v50, v147, v22, v22 op_sel:[0,0,1] op_sel_hi:[1,1,1]
v_fma_mix_f32 v51, v147, v23, v23 op_sel:[1,0,1] op_sel_hi:[1,1,1]
v_cvt_pk_bf16_f32 v147, v50, v51
s_waitcnt vmcnt(12) lgkmcnt(4)
s_nop 0
v_mfma_f32_32x32x16_bf16 a[0:15], a[96:99], v[144:147], a[0:15]
ds_read_b128 v[16:19], v3 offset:1408
ds_read_b128 v[20:23], v3 offset:1424
v_fma_mix_f32 v48, v148, v24, v24 op_sel:[0,0,1] op_sel_hi:[1,1,1]
v_fma_mix_f32 v49, v148, v25, v25 op_sel:[1,0,1] op_sel_hi:[1,1,1]
v_cvt_pk_bf16_f32 v148, v48, v49
s_add_u32 m0, s77, 138240
s_add_u32 s79, s76, 138240
buffer_load_dwordx4 v2, s[44:47], s79 offen sc1 lds
v_mfma_f32_32x32x16_bf16 a[16:31], a[100:103], v[144:147], a[16:31]
ds_read_b128 a[80:83], v4 offset:23040
ds_read_b128 a[84:87], v4 offset:24064
v_fma_mix_f32 v50, v149, v26, v26 op_sel:[0,0,1] op_sel_hi:[1,1,1]
v_fma_mix_f32 v51, v149, v27, v27 op_sel:[1,0,1] op_sel_hi:[1,1,1]
v_cvt_pk_bf16_f32 v149, v50, v51
v_mfma_f32_32x32x16_bf16 a[32:47], a[104:107], v[144:147], a[32:47]
ds_read_b128 a[88:91], v4 offset:25088
ds_read_b128 a[92:95], v7 offset:23040
v_fma_mix_f32 v48, v150, v28, v28 op_sel:[0,0,1] op_sel_hi:[1,1,1]
v_fma_mix_f32 v49, v150, v29, v29 op_sel:[1,0,1] op_sel_hi:[1,1,1]
v_cvt_pk_bf16_f32 v150, v48, v49
s_add_u32 s12, s12, 4096
buffer_load_dwordx4 v[176:179], v2, s[44:47], s12 offen offset:0 sc1
v_mfma_f32_32x32x16_bf16 a[48:63], a[108:111], v[144:147], a[48:63]
v_fma_mix_f32 v50, v151, v30, v30 op_sel:[0,0,1] op_sel_hi:[1,1,1]
v_fma_mix_f32 v51, v151, v31, v31 op_sel:[1,0,1] op_sel_hi:[1,1,1]
v_cvt_pk_bf16_f32 v151, v50, v51
s_waitcnt vmcnt(12) lgkmcnt(4)
s_nop 0
v_mfma_f32_32x32x16_bf16 a[0:15], a[64:67], v[148:151], a[0:15]
ds_read_b128 v[24:27], v3 offset:1472
ds_read_b128 v[28:31], v3 offset:1488
v_fma_mix_f32 v48, v152, v16, v16 op_sel:[0,0,1] op_sel_hi:[1,1,1]
v_fma_mix_f32 v49, v152, v17, v17 op_sel:[1,0,1] op_sel_hi:[1,1,1]
v_cvt_pk_bf16_f32 v152, v48, v49
s_add_u32 m0, s77, 142336
s_add_u32 s79, s76, 142336
buffer_load_dwordx4 v2, s[44:47], s79 offen sc1 lds
v_mfma_f32_32x32x16_bf16 a[16:31], a[68:71], v[148:151], a[16:31]
ds_read_b128 a[96:99], v4 offset:26880
ds_read_b128 a[100:103], v4 offset:27904
v_fma_mix_f32 v50, v153, v18, v18 op_sel:[0,0,1] op_sel_hi:[1,1,1]
v_fma_mix_f32 v51, v153, v19, v19 op_sel:[1,0,1] op_sel_hi:[1,1,1]
v_cvt_pk_bf16_f32 v153, v50, v51
v_mfma_f32_32x32x16_bf16 a[32:47], a[72:75], v[148:151], a[32:47]
ds_read_b128 a[104:107], v4 offset:28928
ds_read_b128 a[108:111], v7 offset:26880
v_fma_mix_f32 v48, v154, v20, v20 op_sel:[0,0,1] op_sel_hi:[1,1,1]
v_fma_mix_f32 v49, v154, v21, v21 op_sel:[1,0,1] op_sel_hi:[1,1,1]
v_cvt_pk_bf16_f32 v154, v48, v49
buffer_load_dwordx4 v[180:183], v2, s[44:47], s12 offen offset:1024 sc1
v_mfma_f32_32x32x16_bf16 a[48:63], a[76:79], v[148:151], a[48:63]
v_fma_mix_f32 v50, v155, v22, v22 op_sel:[0,0,1] op_sel_hi:[1,1,1]
v_fma_mix_f32 v51, v155, v23, v23 op_sel:[1,0,1] op_sel_hi:[1,1,1]
v_cvt_pk_bf16_f32 v155, v50, v51
s_barrier
s_cmp_lg_u32 s4, 0
s_cbranch_scc1 L_fs_18
s_lshl_b32 s64, s2, 7
s_add_u32 s64, s64, 0x28000
v_mov_b32 v252, s5
v_mov_b32 v253, 0
s_mov_b64 exec, 1
buffer_store_dword v252, v253, s[44:47], s64 offen sc1
s_mov_b64 exec, -1
L_fs_18:
s_waitcnt vmcnt(12) lgkmcnt(4)
v_mfma_f32_32x32x16_bf16 a[0:15], a[80:83], v[152:155], a[0:15]
ds_read_b128 v[16:19], v3 offset:1536
ds_read_b128 v[20:23], v3 offset:1552
v_fma_mix_f32 v48, v156, v24, v24 op_sel:[0,0,1] op_sel_hi:[1,1,1]
v_fma_mix_f32 v49, v156, v25, v25 op_sel:[1,0,1] op_sel_hi:[1,1,1]
v_cvt_pk_bf16_f32 v156, v48, v49
s_add_u32 m0, s77, 146432
s_add_u32 s79, s76, 146432
buffer_load_dwordx4 v2, s[44:47], s79 offen sc1 lds
v_mfma_f32_32x32x16_bf16 a[16:31], a[84:87], v[152:155], a[16:31]
ds_read_b128 a[64:67], v4 offset:30720
ds_read_b128 a[68:71], v4 offset:31744
v_fma_mix_f32 v50, v157, v26, v26 op_sel:[0,0,1] op_sel_hi:[1,1,1]
v_fma_mix_f32 v51, v157, v27, v27 op_sel:[1,0,1] op_sel_hi:[1,1,1]
v_cvt_pk_bf16_f32 v157, v50, v51
v_mfma_f32_32x32x16_bf16 a[32:47], a[88:91], v[152:155], a[32:47]
ds_read_b128 a[72:75], v4 offset:32768
ds_read_b128 a[76:79], v7 offset:30720
v_fma_mix_f32 v48, v158, v28, v28 op_sel:[0,0,1] op_sel_hi:[1,1,1]
v_fma_mix_f32 v49, v158, v29, v29 op_sel:[1,0,1] op_sel_hi:[1,1,1]
v_cvt_pk_bf16_f32 v158, v48, v49
buffer_load_dwordx4 v[184:187], v2, s[44:47], s12 offen offset:2048 sc1
v_mfma_f32_32x32x16_bf16 a[48:63], a[92:95], v[152:155], a[48:63]
v_fma_mix_f32 v50, v159, v30, v30 op_sel:[0,0,1] op_sel_hi:[1,1,1]
v_fma_mix_f32 v51, v159, v31, v31 op_sel:[1,0,1] op_sel_hi:[1,1,1]
v_cvt_pk_bf16_f32 v159, v50, v51
s_waitcnt vmcnt(12) lgkmcnt(4)
s_nop 0
v_mfma_f32_32x32x16_bf16 a[0:15], a[96:99], v[156:159], a[0:15]
ds_read_b128 v[24:27], v3 offset:1600
ds_read_b128 v[28:31], v3 offset:1616
v_fma_mix_f32 v48, v160, v16, v16 op_sel:[0,0,1] op_sel_hi:[1,1,1]
v_fma_mix_f32 v49, v160, v17, v17 op_sel:[1,0,1] op_sel_hi:[1,1,1]
v_cvt_pk_bf16_f32 v160, v48, v49
s_add_u32 s79, s78, 138240
s_add_u32 m0, s77, s79
s_add_u32 s79, s76, s79
buffer_load_dwordx4 v2, s[44:47], s79 offen sc1 lds
v_mfma_f32_32x32x16_bf16 a[16:31], a[100:103], v[156:159], a[16:31]
ds_read_b128 a[80:83], v4 offset:34560
ds_read_b128 a[84:87], v4 offset:35584
v_fma_mix_f32 v50, v161, v18, v18 op_sel:[0,0,1] op_sel_hi:[1,1,1]
v_fma_mix_f32 v51, v161, v19, v19 op_sel:[1,0,1] op_sel_hi:[1,1,1]
v_cvt_pk_bf16_f32 v161, v50, v51
v_mfma_f32_32x32x16_bf16 a[32:47], a[104:107], v[156:159], a[32:47]
ds_read_b128 a[88:91], v4 offset:36608
ds_read_b128 a[92:95], v7 offset:34560
v_fma_mix_f32 v48, v162, v20, v20 op_sel:[0,0,1] op_sel_hi:[1,1,1]
v_fma_mix_f32 v49, v162, v21, v21 op_sel:[1,0,1] op_sel_hi:[1,1,1]
v_cvt_pk_bf16_f32 v162, v48, v49
buffer_load_dwordx4 v[188:191], v2, s[44:47], s12 offen offset:3072 sc1
v_mfma_f32_32x32x16_bf16 a[48:63], a[108:111], v[156:159], a[48:63]
v_fma_mix_f32 v50, v163, v22, v22 op_sel:[0,0,1] op_sel_hi:[1,1,1]
v_fma_mix_f32 v51, v163, v23, v23 op_sel:[1,0,1] op_sel_hi:[1,1,1]
v_cvt_pk_bf16_f32 v163, v50, v51
s_waitcnt vmcnt(12) lgkmcnt(4)
s_nop 0
v_mfma_f32_32x32x16_bf16 a[0:15], a[64:67], v[160:163], a[0:15]
ds_read_b128 v[16:19], v3 offset:1664
ds_read_b128 v[20:23], v3 offset:1680
v_fma_mix_f32 v48, v164, v24, v24 op_sel:[0,0,1] op_sel_hi:[1,1,1]
v_fma_mix_f32 v49, v164, v25, v25 op_sel:[1,0,1] op_sel_hi:[1,1,1]
v_cvt_pk_bf16_f32 v164, v48, v49
v_mfma_f32_32x32x16_bf16 a[16:31], a[68:71], v[160:163], a[16:31]
ds_read_b128 a[96:99], v4 offset:38400
ds_read_b128 a[100:103], v4 offset:39424
v_fma_mix_f32 v50, v165, v26, v26 op_sel:[0,0,1] op_sel_hi:[1,1,1]
v_fma_mix_f32 v51, v165, v27, v27 op_sel:[1,0,1] op_sel_hi:[1,1,1]
v_cvt_pk_bf16_f32 v165, v50, v51
v_mfma_f32_32x32x16_bf16 a[32:47], a[72:75], v[160:163], a[32:47]
ds_read_b128 a[104:107], v4 offset:40448
ds_read_b128 a[108:111], v7 offset:38400
v_fma_mix_f32 v48, v166, v28, v28 op_sel:[0,0,1] op_sel_hi:[1,1,1]
v_fma_mix_f32 v49, v166, v29, v29 op_sel:[1,0,1] op_sel_hi:[1,1,1]
v_cvt_pk_bf16_f32 v166, v48, v49
s_add_u32 s12, s12, 4096
buffer_load_dwordx4 v[192:195], v2, s[44:47], s12 offen offset:0 sc1
v_mfma_f32_32x32x16_bf16 a[48:63], a[76:79], v[160:163], a[48:63]
v_fma_mix_f32 v50, v167, v30, v30 op_sel:[0,0,1] op_sel_hi:[1,1,1]
v_fma_mix_f32 v51, v167, v31, v31 op_sel:[1,0,1] op_sel_hi:[1,1,1]
v_cvt_pk_bf16_f32 v167, v50, v51
s_waitcnt vmcnt(11) lgkmcnt(4)
s_nop 0
v_mfma_f32_32x32x16_bf16 a[0:15], a[80:83], v[164:167], a[0:15]
ds_read_b128 v[24:27], v3 offset:1728
ds_read_b128 v[28:31], v3 offset:1744
v_fma_mix_f32 v48, v168, v16, v16 op_sel:[0,0,1] op_sel_hi:[1,1,1]
v_fma_mix_f32 v49, v168, v17, v17 op_sel:[1,0,1] op_sel_hi:[1,1,1]
v_cvt_pk_bf16_f32 v168, v48, v49
v_mfma_f32_32x32x16_bf16 a[16:31], a[84:87], v[164:167], a[16:31]
ds_read_b128 a[64:67], v4 offset:42240
ds_read_b128 a[68:71], v4 offset:43264
v_fma_mix_f32 v50, v169, v18, v18 op_sel:[0,0,1] op_sel_hi:[1,1,1]
v_fma_mix_f32 v51, v169, v19, v19 op_sel:[1,0,1] op_sel_hi:[1,1,1]
v_cvt_pk_bf16_f32 v169, v50, v51
v_mfma_f32_32x32x16_bf16 a[32:47], a[88:91], v[164:167], a[32:47]
ds_read_b128 a[72:75], v4 offset:44288
ds_read_b128 a[76:79], v7 offset:42240
v_fma_mix_f32 v48, v170, v20, v20 op_sel:[0,0,1] op_sel_hi:[1,1,1]
v_fma_mix_f32 v49, v170, v21, v21 op_sel:[1,0,1] op_sel_hi:[1,1,1]
v_cvt_pk_bf16_f32 v170, v48, v49
buffer_load_dwordx4 v[196:199], v2, s[44:47], s12 offen offset:1024 sc1
v_mfma_f32_32x32x16_bf16 a[48:63], a[92:95], v[164:167], a[48:63]
v_fma_mix_f32 v50, v171, v22, v22 op_sel:[0,0,1] op_sel_hi:[1,1,1]
v_fma_mix_f32 v51, v171, v23, v23 op_sel:[1,0,1] op_sel_hi:[1,1,1]
v_cvt_pk_bf16_f32 v171, v50, v51
s_barrier
s_waitcnt vmcnt(10) lgkmcnt(4)
v_mfma_f32_32x32x16_bf16 a[0:15], a[96:99], v[168:171], a[0:15]
ds_read_b128 v[16:19], v3 offset:1792
ds_read_b128 v[20:23], v3 offset:1808
v_fma_mix_f32 v48, v172, v24, v24 op_sel:[0,0,1] op_sel_hi:[1,1,1]
v_fma_mix_f32 v49, v172, v25, v25 op_sel:[1,0,1] op_sel_hi:[1,1,1]
v_cvt_pk_bf16_f32 v172, v48, v49
v_mfma_f32_32x32x16_bf16 a[16:31], a[100:103], v[168:171], a[16:31]
ds_read_b128 a[80:83], v4 offset:46080
ds_read_b128 a[84:87], v4 offset:47104
v_fma_mix_f32 v50, v173, v26, v26 op_sel:[0,0,1] op_sel_hi:[1,1,1]
v_fma_mix_f32 v51, v173, v27, v27 op_sel:[1,0,1] op_sel_hi:[1,1,1]
v_cvt_pk_bf16_f32 v173, v50, v51
v_mfma_f32_32x32x16_bf16 a[32:47], a[104:107], v[168:171], a[32:47]
ds_read_b128 a[88:91], v4 offset:48128
ds_read_b128 a[92:95], v7 offset:46080
v_fma_mix_f32 v48, v174, v28, v28 op_sel:[0,0,1] op_sel_hi:[1,1,1]
v_fma_mix_f32 v49, v174, v29, v29 op_sel:[1,0,1] op_sel_hi:[1,1,1]
v_cvt_pk_bf16_f32 v174, v48, v49
buffer_load_dwordx4 v[200:203], v2, s[44:47], s12 offen offset:2048 sc1
v_mfma_f32_32x32x16_bf16 a[48:63], a[108:111], v[168:171], a[48:63]
v_fma_mix_f32 v50, v175, v30, v30 op_sel:[0,0,1] op_sel_hi:[1,1,1]
v_fma_mix_f32 v51, v175, v31, v31 op_sel:[1,0,1] op_sel_hi:[1,1,1]
v_cvt_pk_bf16_f32 v175, v50, v51
s_waitcnt vmcnt(9) lgkmcnt(4)
s_nop 0
v_mfma_f32_32x32x16_bf16 a[0:15], a[64:67], v[172:175], a[0:15]
ds_read_b128 v[24:27], v3 offset:1856
ds_read_b128 v[28:31], v3 offset:1872
v_fma_mix_f32 v48, v176, v16, v16 op_sel:[0,0,1] op_sel_hi:[1,1,1]
v_fma_mix_f32 v49, v176, v17, v17 op_sel:[1,0,1] op_sel_hi:[1,1,1]
v_cvt_pk_bf16_f32 v176, v48, v49
v_mfma_f32_32x32x16_bf16 a[16:31], a[68:71], v[172:175], a[16:31]
ds_read_b128 a[96:99], v4 offset:49920
ds_read_b128 a[100:103], v4 offset:50944
v_fma_mix_f32 v50, v177, v18, v18 op_sel:[0,0,1] op_sel_hi:[1,1,1]
v_fma_mix_f32 v51, v177, v19, v19 op_sel:[1,0,1] op_sel_hi:[1,1,1]
v_cvt_pk_bf16_f32 v177, v50, v51
v_mfma_f32_32x32x16_bf16 a[32:47], a[72:75], v[172:175], a[32:47]
ds_read_b128 a[104:107], v4 offset:51968
ds_read_b128 a[108:111], v7 offset:49920
v_fma_mix_f32 v48, v178, v20, v20 op_sel:[0,0,1] op_sel_hi:[1,1,1]
v_fma_mix_f32 v49, v178, v21, v21 op_sel:[1,0,1] op_sel_hi:[1,1,1]
v_cvt_pk_bf16_f32 v178, v48, v49
buffer_load_dwordx4 v[204:207], v2, s[44:47], s12 offen offset:3072 sc1
v_mfma_f32_32x32x16_bf16 a[48:63], a[76:79], v[172:175], a[48:63]
v_fma_mix_f32 v50, v179, v22, v22 op_sel:[0,0,1] op_sel_hi:[1,1,1]
v_fma_mix_f32 v51, v179, v23, v23 op_sel:[1,0,1] op_sel_hi:[1,1,1]
v_cvt_pk_bf16_f32 v179, v50, v51
s_waitcnt vmcnt(8) lgkmcnt(4)
s_nop 0
v_mfma_f32_32x32x16_bf16 a[0:15], a[80:83], v[176:179], a[0:15]
ds_read_b128 v[16:19], v3 offset:1920
ds_read_b128 v[20:23], v3 offset:1936
v_fma_mix_f32 v48, v180, v24, v24 op_sel:[0,0,1] op_sel_hi:[1,1,1]
v_fma_mix_f32 v49, v180, v25, v25 op_sel:[1,0,1] op_sel_hi:[1,1,1]
v_cvt_pk_bf16_f32 v180, v48, v49
v_mfma_f32_32x32x16_bf16 a[16:31], a[84:87], v[176:179], a[16:31]
ds_read_b128 a[64:67], v4 offset:53760
ds_read_b128 a[68:71], v4 offset:54784
v_fma_mix_f32 v50, v181, v26, v26 op_sel:[0,0,1] op_sel_hi:[1,1,1]
v_fma_mix_f32 v51, v181, v27, v27 op_sel:[1,0,1] op_sel_hi:[1,1,1]
v_cvt_pk_bf16_f32 v181, v50, v51
v_mfma_f32_32x32x16_bf16 a[32:47], a[88:91], v[176:179], a[32:47]
ds_read_b128 a[72:75], v4 offset:55808
ds_read_b128 a[76:79], v7 offset:53760
v_fma_mix_f32 v48, v182, v28, v28 op_sel:[0,0,1] op_sel_hi:[1,1,1]
v_fma_mix_f32 v49, v182, v29, v29 op_sel:[1,0,1] op_sel_hi:[1,1,1]
v_cvt_pk_bf16_f32 v182, v48, v49
s_add_u32 s12, s12, 4096
buffer_load_dwordx4 v[208:211], v2, s[44:47], s12 offen offset:0 sc1
v_mfma_f32_32x32x16_bf16 a[48:63], a[92:95], v[176:179], a[48:63]
v_fma_mix_f32 v50, v183, v30, v30 op_sel:[0,0,1] op_sel_hi:[1,1,1]
v_fma_mix_f32 v51, v183, v31, v31 op_sel:[1,0,1] op_sel_hi:[1,1,1]
v_cvt_pk_bf16_f32 v183, v50, v51
s_waitcnt vmcnt(7) lgkmcnt(4)
s_nop 0
v_mfma_f32_32x32x16_bf16 a[0:15], a[96:99], v[180:183], a[0:15]
ds_read_b128 v[24:27], v3 offset:1984
ds_read_b128 v[28:31], v3 offset:2000
v_fma_mix_f32 v48, v184, v16, v16 op_sel:[0,0,1] op_sel_hi:[1,1,1]
v_fma_mix_f32 v49, v184, v17, v17 op_sel:[1,0,1] op_sel_hi:[1,1,1]
v_cvt_pk_bf16_f32 v184, v48, v49
v_mfma_f32_32x32x16_bf16 a[16:31], a[100:103], v[180:183], a[16:31]
ds_read_b128 a[80:83], v4 offset:57600
ds_read_b128 a[84:87], v4 offset:58624
v_fma_mix_f32 v50, v185, v18, v18 op_sel:[0,0,1] op_sel_hi:[1,1,1]
v_fma_mix_f32 v51, v185, v19, v19 op_sel:[1,0,1] op_sel_hi:[1,1,1]
v_cvt_pk_bf16_f32 v185, v50, v51
v_mfma_f32_32x32x16_bf16 a[32:47], a[104:107], v[180:183], a[32:47]
ds_read_b128 a[88:91], v4 offset:59648
ds_read_b128 a[92:95], v7 offset:57600
v_fma_mix_f32 v48, v186, v20, v20 op_sel:[0,0,1] op_sel_hi:[1,1,1]
v_fma_mix_f32 v49, v186, v21, v21 op_sel:[1,0,1] op_sel_hi:[1,1,1]
v_cvt_pk_bf16_f32 v186, v48, v49
buffer_load_dwordx4 v[212:215], v2, s[44:47], s12 offen offset:1024 sc1
v_mfma_f32_32x32x16_bf16 a[48:63], a[108:111], v[180:183], a[48:63]
v_fma_mix_f32 v50, v187, v22, v22 op_sel:[0,0,1] op_sel_hi:[1,1,1]
v_fma_mix_f32 v51, v187, v23, v23 op_sel:[1,0,1] op_sel_hi:[1,1,1]
v_cvt_pk_bf16_f32 v187, v50, v51
s_barrier
s_waitcnt vmcnt(6) lgkmcnt(4)
v_mfma_f32_32x32x16_bf16 a[0:15], a[64:67], v[184:187], a[0:15]
ds_read_b128 v[16:19], v3 offset:2048
ds_read_b128 v[20:23], v3 offset:2064
v_fma_mix_f32 v48, v188, v24, v24 op_sel:[0,0,1] op_sel_hi:[1,1,1]
v_fma_mix_f32 v49, v188, v25, v25 op_sel:[1,0,1] op_sel_hi:[1,1,1]
v_cvt_pk_bf16_f32 v188, v48, v49
v_mfma_f32_32x32x16_bf16 a[16:31], a[68:71], v[184:187], a[16:31]
ds_read_b128 a[96:99], v5 offset:0
ds_read_b128 a[100:103], v5 offset:1024
v_fma_mix_f32 v50, v189, v26, v26 op_sel:[0,0,1] op_sel_hi:[1,1,1]
v_fma_mix_f32 v51, v189, v27, v27 op_sel:[1,0,1] op_sel_hi:[1,1,1]
v_cvt_pk_bf16_f32 v189, v50, v51
v_mfma_f32_32x32x16_bf16 a[32:47], a[72:75], v[184:187], a[32:47]
ds_read_b128 a[104:107], v5 offset:2048
ds_read_b128 a[108:111], v15 offset:0
v_fma_mix_f32 v48, v190, v28, v28 op_sel:[0,0,1] op_sel_hi:[1,1,1]
v_fma_mix_f32 v49, v190, v29, v29 op_sel:[1,0,1] op_sel_hi:[1,1,1]
v_cvt_pk_bf16_f32 v190, v48, v49
buffer_load_dwordx4 v[216:219], v2, s[44:47], s12 offen offset:2048 sc1
v_mfma_f32_32x32x16_bf16 a[48:63], a[76:79], v[184:187], a[48:63]
v_fma_mix_f32 v50, v191, v30, v30 op_sel:[0,0,1] op_sel_hi:[1,1,1]
v_fma_mix_f32 v51, v191, v31, v31 op_sel:[1,0,1] op_sel_hi:[1,1,1]
v_cvt_pk_bf16_f32 v191, v50, v51
s_waitcnt vmcnt(6) lgkmcnt(4)
s_nop 0
v_mfma_f32_32x32x16_bf16 a[0:15], a[80:83], v[188:191], a[0:15]
ds_read_b128 v[24:27], v3 offset:2112
ds_read_b128 v[28:31], v3 offset:2128
v_fma_mix_f32 v48, v192, v16, v16 op_sel:[0,0,1] op_sel_hi:[1,1,1]
v_fma_mix_f32 v49, v192, v17, v17 op_sel:[1,0,1] op_sel_hi:[1,1,1]
v_cvt_pk_bf16_f32 v192, v48, v49
v_mfma_f32_32x32x16_bf16 a[16:31], a[84:87], v[188:191], a[16:31]
ds_read_b128 a[64:67], v5 offset:3840
ds_read_b128 a[68:71], v5 offset:4864
v_fma_mix_f32 v50, v193, v18, v18 op_sel:[0,0,1] op_sel_hi:[1,1,1]
v_fma_mix_f32 v51, v193, v19, v19 op_sel:[1,0,1] op_sel_hi:[1,1,1]
v_cvt_pk_bf16_f32 v193, v50, v51
v_mfma_f32_32x32x16_bf16 a[32:47], a[88:91], v[188:191], a[32:47]
ds_read_b128 a[72:75], v5 offset:5888
ds_read_b128 a[76:79], v15 offset:3840
v_fma_mix_f32 v48, v194, v20, v20 op_sel:[0,0,1] op_sel_hi:[1,1,1]
v_fma_mix_f32 v49, v194, v21, v21 op_sel:[1,0,1] op_sel_hi:[1,1,1]
v_cvt_pk_bf16_f32 v194, v48, v49
buffer_load_dwordx4 v[220:223], v2, s[44:47], s12 offen offset:3072 sc1
v_mfma_f32_32x32x16_bf16 a[48:63], a[92:95], v[188:191], a[48:63]
v_fma_mix_f32 v50, v195, v22, v22 op_sel:[0,0,1] op_sel_hi:[1,1,1]
v_fma_mix_f32 v51, v195, v23, v23 op_sel:[1,0,1] op_sel_hi:[1,1,1]
v_cvt_pk_bf16_f32 v195, v50, v51
s_waitcnt vmcnt(6) lgkmcnt(4)
s_nop 0
v_mfma_f32_32x32x16_bf16 a[0:15], a[96:99], v[192:195], a[0:15]
ds_read_b128 v[16:19], v3 offset:2176
ds_read_b128 v[20:23], v3 offset:2192
v_fma_mix_f32 v48, v196, v24, v24 op_sel:[0,0,1] op_sel_hi:[1,1,1]
v_fma_mix_f32 v49, v196, v25, v25 op_sel:[1,0,1] op_sel_hi:[1,1,1]
v_cvt_pk_bf16_f32 v196, v48, v49
v_mfma_f32_32x32x16_bf16 a[16:31], a[100:103], v[192:195], a[16:31]
ds_read_b128 a[80:83], v5 offset:7680
ds_read_b128 a[84:87], v5 offset:8704
v_fma_mix_f32 v50, v197, v26, v26 op_sel:[0,0,1] op_sel_hi:[1,1,1]
v_fma_mix_f32 v51, v197, v27, v27 op_sel:[1,0,1] op_sel_hi:[1,1,1]
v_cvt_pk_bf16_f32 v197, v50, v51
v_mfma_f32_32x32x16_bf16 a[32:47], a[104:107], v[192:195], a[32:47]
ds_read_b128 a[88:91], v5 offset:9728
ds_read_b128 a[92:95], v15 offset:7680
v_fma_mix_f32 v48, v198, v28, v28 op_sel:[0,0,1] op_sel_hi:[1,1,1]
v_fma_mix_f32 v49, v198, v29, v29 op_sel:[1,0,1] op_sel_hi:[1,1,1]
v_cvt_pk_bf16_f32 v198, v48, v49
v_mfma_f32_32x32x16_bf16 a[48:63], a[108:111], v[192:195], a[48:63]
v_fma_mix_f32 v50, v199, v30, v30 op_sel:[0,0,1] op_sel_hi:[1,1,1]
v_fma_mix_f32 v51, v199, v31, v31 op_sel:[1,0,1] op_sel_hi:[1,1,1]
v_cvt_pk_bf16_f32 v199, v50, v51
s_waitcnt vmcnt(5) lgkmcnt(4)
s_nop 0
v_mfma_f32_32x32x16_bf16 a[0:15], a[64:67], v[196:199], a[0:15]
ds_read_b128 v[24:27], v3 offset:2240
ds_read_b128 v[28:31], v3 offset:2256
v_fma_mix_f32 v48, v200, v16, v16 op_sel:[0,0,1] op_sel_hi:[1,1,1]
v_fma_mix_f32 v49, v200, v17, v17 op_sel:[1,0,1] op_sel_hi:[1,1,1]
v_cvt_pk_bf16_f32 v200, v48, v49
v_mfma_f32_32x32x16_bf16 a[16:31], a[68:71], v[196:199], a[16:31]
ds_read_b128 a[96:99], v5 offset:11520
ds_read_b128 a[100:103], v5 offset:12544
v_fma_mix_f32 v50, v201, v18, v18 op_sel:[0,0,1] op_sel_hi:[1,1,1]
v_fma_mix_f32 v51, v201, v19, v19 op_sel:[1,0,1] op_sel_hi:[1,1,1]
v_cvt_pk_bf16_f32 v201, v50, v51
v_mfma_f32_32x32x16_bf16 a[32:47], a[72:75], v[196:199], a[32:47]
ds_read_b128 a[104:107], v5 offset:13568
ds_read_b128 a[108:111], v15 offset:11520
v_fma_mix_f32 v48, v202, v20, v20 op_sel:[0,0,1] op_sel_hi:[1,1,1]
v_fma_mix_f32 v49, v202, v21, v21 op_sel:[1,0,1] op_sel_hi:[1,1,1]
v_cvt_pk_bf16_f32 v202, v48, v49
v_mfma_f32_32x32x16_bf16 a[48:63], a[76:79], v[196:199], a[48:63]
v_fma_mix_f32 v50, v203, v22, v22 op_sel:[0,0,1] op_sel_hi:[1,1,1]
v_fma_mix_f32 v51, v203, v23, v23 op_sel:[1,0,1] op_sel_hi:[1,1,1]
v_cvt_pk_bf16_f32 v203, v50, v51
s_barrier
s_waitcnt vmcnt(4) lgkmcnt(4)
v_mfma_f32_32x32x16_bf16 a[0:15], a[80:83], v[200:203], a[0:15]
ds_read_b128 v[16:19], v3 offset:2304
ds_read_b128 v[20:23], v3 offset:2320
v_fma_mix_f32 v48, v204, v24, v24 op_sel:[0,0,1] op_sel_hi:[1,1,1]
v_fma_mix_f32 v49, v204, v25, v25 op_sel:[1,0,1] op_sel_hi:[1,1,1]
v_cvt_pk_bf16_f32 v204, v48, v49
v_mfma_f32_32x32x16_bf16 a[16:31], a[84:87], v[200:203], a[16:31]
ds_read_b128 a[64:67], v5 offset:15360
ds_read_b128 a[68:71], v5 offset:16384
v_fma_mix_f32 v50, v205, v26, v26 op_sel:[0,0,1] op_sel_hi:[1,1,1]
v_fma_mix_f32 v51, v205, v27, v27 op_sel:[1,0,1] op_sel_hi:[1,1,1]
v_cvt_pk_bf16_f32 v205, v50, v51
v_mfma_f32_32x32x16_bf16 a[32:47], a[88:91], v[200:203], a[32:47]
ds_read_b128 a[72:75], v5 offset:17408
ds_read_b128 a[76:79], v15 offset:15360
v_fma_mix_f32 v48, v206, v28, v28 op_sel:[0,0,1] op_sel_hi:[1,1,1]
v_fma_mix_f32 v49, v206, v29, v29 op_sel:[1,0,1] op_sel_hi:[1,1,1]
v_cvt_pk_bf16_f32 v206, v48, v49
v_mfma_f32_32x32x16_bf16 a[48:63], a[92:95], v[200:203], a[48:63]
v_fma_mix_f32 v50, v207, v30, v30 op_sel:[0,0,1] op_sel_hi:[1,1,1]
v_fma_mix_f32 v51, v207, v31, v31 op_sel:[1,0,1] op_sel_hi:[1,1,1]
v_cvt_pk_bf16_f32 v207, v50, v51
s_waitcnt vmcnt(3) lgkmcnt(4)
s_nop 0
v_mfma_f32_32x32x16_bf16 a[0:15], a[96:99], v[204:207], a[0:15]
ds_read_b128 v[24:27], v3 offset:2368
ds_read_b128 v[28:31], v3 offset:2384
v_fma_mix_f32 v48, v208, v16, v16 op_sel:[0,0,1] op_sel_hi:[1,1,1]
v_fma_mix_f32 v49, v208, v17, v17 op_sel:[1,0,1] op_sel_hi:[1,1,1]
v_cvt_pk_bf16_f32 v208, v48, v49
v_mfma_f32_32x32x16_bf16 a[16:31], a[100:103], v[204:207], a[16:31]
ds_read_b128 a[80:83], v5 offset:19200
ds_read_b128 a[84:87], v5 offset:20224
v_fma_mix_f32 v50, v209, v18, v18 op_sel:[0,0,1] op_sel_hi:[1,1,1]
v_fma_mix_f32 v51, v209, v19, v19 op_sel:[1,0,1] op_sel_hi:[1,1,1]
v_cvt_pk_bf16_f32 v209, v50, v51
v_mfma_f32_32x32x16_bf16 a[32:47], a[104:107], v[204:207], a[32:47]
ds_read_b128 a[88:91], v5 offset:21248
ds_read_b128 a[92:95], v15 offset:19200
v_fma_mix_f32 v48, v210, v20, v20 op_sel:[0,0,1] op_sel_hi:[1,1,1]
v_fma_mix_f32 v49, v210, v21, v21 op_sel:[1,0,1] op_sel_hi:[1,1,1]
v_cvt_pk_bf16_f32 v210, v48, v49
v_mfma_f32_32x32x16_bf16 a[48:63], a[108:111], v[204:207], a[48:63]
v_fma_mix_f32 v50, v211, v22, v22 op_sel:[0,0,1] op_sel_hi:[1,1,1]
v_fma_mix_f32 v51, v211, v23, v23 op_sel:[1,0,1] op_sel_hi:[1,1,1]
v_cvt_pk_bf16_f32 v211, v50, v51
s_waitcnt vmcnt(2) lgkmcnt(4)
s_nop 0
v_mfma_f32_32x32x16_bf16 a[0:15], a[64:67], v[208:211], a[0:15]
ds_read_b128 v[16:19], v3 offset:2432
ds_read_b128 v[20:23], v3 offset:2448
v_fma_mix_f32 v48, v212, v24, v24 op_sel:[0,0,1] op_sel_hi:[1,1,1]
v_fma_mix_f32 v49, v212, v25, v25 op_sel:[1,0,1] op_sel_hi:[1,1,1]
v_cvt_pk_bf16_f32 v212, v48, v49
v_mfma_f32_32x32x16_bf16 a[16:31], a[68:71], v[208:211], a[16:31]
ds_read_b128 a[96:99], v5 offset:23040
ds_read_b128 a[100:103], v5 offset:24064
v_fma_mix_f32 v50, v213, v26, v26 op_sel:[0,0,1] op_sel_hi:[1,1,1]
v_fma_mix_f32 v51, v213, v27, v27 op_sel:[1,0,1] op_sel_hi:[1,1,1]
v_cvt_pk_bf16_f32 v213, v50, v51
v_mfma_f32_32x32x16_bf16 a[32:47], a[72:75], v[208:211], a[32:47]
ds_read_b128 a[104:107], v5 offset:25088
ds_read_b128 a[108:111], v15 offset:23040
v_fma_mix_f32 v48, v214, v28, v28 op_sel:[0,0,1] op_sel_hi:[1,1,1]
v_fma_mix_f32 v49, v214, v29, v29 op_sel:[1,0,1] op_sel_hi:[1,1,1]
v_cvt_pk_bf16_f32 v214, v48, v49
v_mfma_f32_32x32x16_bf16 a[48:63], a[76:79], v[208:211], a[48:63]
v_fma_mix_f32 v50, v215, v30, v30 op_sel:[0,0,1] op_sel_hi:[1,1,1]
v_fma_mix_f32 v51, v215, v31, v31 op_sel:[1,0,1] op_sel_hi:[1,1,1]
v_cvt_pk_bf16_f32 v215, v50, v51
s_waitcnt vmcnt(1) lgkmcnt(4)
s_nop 0
v_mfma_f32_32x32x16_bf16 a[0:15], a[80:83], v[212:215], a[0:15]
ds_read_b128 v[24:27], v3 offset:2496
ds_read_b128 v[28:31], v3 offset:2512
v_fma_mix_f32 v48, v216, v16, v16 op_sel:[0,0,1] op_sel_hi:[1,1,1]
v_fma_mix_f32 v49, v216, v17, v17 op_sel:[1,0,1] op_sel_hi:[1,1,1]
v_cvt_pk_bf16_f32 v216, v48, v49
v_mfma_f32_32x32x16_bf16 a[16:31], a[84:87], v[212:215], a[16:31]
ds_read_b128 a[64:67], v5 offset:26880
ds_read_b128 a[68:71], v5 offset:27904
v_fma_mix_f32 v50, v217, v18, v18 op_sel:[0,0,1] op_sel_hi:[1,1,1]
v_fma_mix_f32 v51, v217, v19, v19 op_sel:[1,0,1] op_sel_hi:[1,1,1]
v_cvt_pk_bf16_f32 v217, v50, v51
v_mfma_f32_32x32x16_bf16 a[32:47], a[88:91], v[212:215], a[32:47]
ds_read_b128 a[72:75], v5 offset:28928
ds_read_b128 a[76:79], v15 offset:26880
v_fma_mix_f32 v48, v218, v20, v20 op_sel:[0,0,1] op_sel_hi:[1,1,1]
v_fma_mix_f32 v49, v218, v21, v21 op_sel:[1,0,1] op_sel_hi:[1,1,1]
v_cvt_pk_bf16_f32 v218, v48, v49
v_mfma_f32_32x32x16_bf16 a[48:63], a[92:95], v[212:215], a[48:63]
v_fma_mix_f32 v50, v219, v22, v22 op_sel:[0,0,1] op_sel_hi:[1,1,1]
v_fma_mix_f32 v51, v219, v23, v23 op_sel:[1,0,1] op_sel_hi:[1,1,1]
v_cvt_pk_bf16_f32 v219, v50, v51
s_waitcnt vmcnt(0) lgkmcnt(4)
s_nop 0
v_mfma_f32_32x32x16_bf16 a[0:15], a[96:99], v[216:219], a[0:15]
v_fma_mix_f32 v48, v220, v24, v24 op_sel:[0,0,1] op_sel_hi:[1,1,1]
v_fma_mix_f32 v49, v220, v25, v25 op_sel:[1,0,1] op_sel_hi:[1,1,1]
v_cvt_pk_bf16_f32 v220, v48, v49
v_mfma_f32_32x32x16_bf16 a[16:31], a[100:103], v[216:219], a[16:31]
v_fma_mix_f32 v50, v221, v26, v26 op_sel:[0,0,1] op_sel_hi:[1,1,1]
v_fma_mix_f32 v51, v221, v27, v27 op_sel:[1,0,1] op_sel_hi:[1,1,1]
v_cvt_pk_bf16_f32 v221, v50, v51
v_mfma_f32_32x32x16_bf16 a[32:47], a[104:107], v[216:219], a[32:47]
v_fma_mix_f32 v48, v222, v28, v28 op_sel:[0,0,1] op_sel_hi:[1,1,1]
v_fma_mix_f32 v49, v222, v29, v29 op_sel:[1,0,1] op_sel_hi:[1,1,1]
v_cvt_pk_bf16_f32 v222, v48, v49
v_mfma_f32_32x32x16_bf16 a[48:63], a[108:111], v[216:219], a[48:63]
v_fma_mix_f32 v50, v223, v30, v30 op_sel:[0,0,1] op_sel_hi:[1,1,1]
v_fma_mix_f32 v51, v223, v31, v31 op_sel:[1,0,1] op_sel_hi:[1,1,1]
v_cvt_pk_bf16_f32 v223, v50, v51
s_waitcnt lgkmcnt(0)
s_nop 0
v_mfma_f32_32x32x16_bf16 a[0:15], a[64:67], v[220:223], a[0:15]
v_mfma_f32_32x32x16_bf16 a[16:31], a[68:71], v[220:223], a[16:31]
v_mfma_f32_32x32x16_bf16 a[32:47], a[72:75], v[220:223], a[32:47]
v_mfma_f32_32x32x16_bf16 a[48:63], a[76:79], v[220:223], a[48:63]
v_lshlrev_b32 v56, 7, v1
v_add_u32 v56, 0x28000, v56
v_add_u32 v57, 64*128, v56
v_add_u32 v58, 128*128, v56
v_add_u32 v59, 192*128, v56
s_cmp_lg_u32 s4, 0
s_cbranch_scc1 L_f5_19
buffer_load_dword v60, v56, s[44:47], 0 offen sc1
buffer_load_dword v61, v57, s[44:47], 0 offen sc1
buffer_load_dword v62, v58, s[44:47], 0 offen sc1
buffer_load_dword v63, v59, s[44:47], 0 offen sc1
L_f5_19:
v_accvgpr_read_b32 v48, a0
v_accvgpr_read_b32 v49, a1
v_accvgpr_read_b32 v50, a2
v_accvgpr_read_b32 v51, a3
v_cvt_pk_bf16_f32 v16, v48, v49
v_cvt_pk_bf16_f32 v17, v50, v51
v_accvgpr_read_b32 v48, a4
v_accvgpr_read_b32 v49, a5
v_accvgpr_read_b32 v50, a6
v_accvgpr_read_b32 v51, a7
v_cvt_pk_bf16_f32 v18, v48, v49
v_cvt_pk_bf16_f32 v19, v50, v51
v_accvgpr_read_b32 v48, a12
v_accvgpr_read_b32 v49, a13
v_accvgpr_read_b32 v50, a14
v_accvgpr_read_b32 v51, a15
v_cvt_pk_bf16_f32 v20, v48, v49
v_cvt_pk_bf16_f32 v21, v50, v51
v_accvgpr_read_b32 v48, a16
v_accvgpr_read_b32 v49, a17
v_accvgpr_read_b32 v50, a18
v_accvgpr_read_b32 v51, a19
v_cvt_pk_bf16_f32 v22, v48, v49
v_cvt_pk_bf16_f32 v23, v50, v51
v_accvgpr_read_b32 v48, a8
v_accvgpr_read_b32 v49, a9
v_accvgpr_read_b32 v50, a10
v_accvgpr_read_b32 v51, a11
v_cvt_pk_bf16_f32 v24, v48, v49
v_cvt_pk_bf16_f32 v25, v50, v51
s_lshl_b32 s12, s7, 2
s_add_u32 s12, s12, s4
s_lshl_b32 s13, s6, 6
s_add_u32 s12, s12, s13
s_mul_i32 s13, s12, 2560
s_add_u32 s13, s13, 0x400000
v_lshlrev_b32 v9, 3, v1
buffer_store_dwordx4 v[16:19], v2, s[44:47], s13 offen sc1
buffer_store_dwordx4 v[20:23], v2, s[44:47], s13 offen offset:1024 sc1
buffer_store_dwordx2 v[24:25], v9, s[44:47], s13 offen offset:2048 sc1
v_accvgpr_read_b32 v48, a20
v_accvgpr_read_b32 v49, a21
v_accvgpr_read_b32 v50, a22
v_accvgpr_read_b32 v51, a23
v_cvt_pk_bf16_f32 v28, v48, v49
v_cvt_pk_bf16_f32 v29, v50, v51
v_accvgpr_read_b32 v48, a24
v_accvgpr_read_b32 v49, a25
v_accvgpr_read_b32 v50, a26
v_accvgpr_read_b32 v51, a27
v_cvt_pk_bf16_f32 v30, v48, v49
v_cvt_pk_bf16_f32 v31, v50, v51
v_accvgpr_read_b32 v48, a28
v_accvgpr_read_b32 v49, a29
v_accvgpr_read_b32 v50, a30
v_accvgpr_read_b32 v51, a31
v_cvt_pk_bf16_f32 v32, v48, v49
v_cvt_pk_bf16_f32 v33, v50, v51
v_accvgpr_read_b32 v48, a32
v_accvgpr_read_b32 v49, a33
v_accvgpr_read_b32 v50, a34
v_accvgpr_read_b32 v51, a35
v_cvt_pk_bf16_f32 v36, v48, v49
v_cvt_pk_bf16_f32 v37, v50, v51
v_accvgpr_read_b32 v48, a36
v_accvgpr_read_b32 v49, a37
v_accvgpr_read_b32 v50, a38
v_accvgpr_read_b32 v51, a39
v_cvt_pk_bf16_f32 v38, v48, v49
v_cvt_pk_bf16_f32 v39, v50, v51
v_bfe_u32 v10, v1, 2, 3
v_and_b32 v11, 3, v1
v_lshrrev_b32 v12, 5, v1
v_lshlrev_b32 v13, 7, v10
v_lshl_add_u32 v13, v12, 6, v13
v_lshl_add_u32 v13, v11, 4, v13
v_lshrrev_b32 v14, 1, v10
v_lshlrev_b32 v14, 8, v14
v_and_b32 v10, 1, v10
v_xor_b32 v10, 1, v10
v_lshl_add_u32 v14, v10, 7, v14
v_lshl_add_u32 v14, v12, 5, v14
v_lshl_add_u32 v14, v11, 3, v14
s_mul_i32 s13, s12, 3072
s_add_u32 s13, s13, 0x700000
buffer_store_dwordx4 v[28:31], v13, s[44:47], s13 offen sc1
buffer_store_dwordx4 v[36:39], v13, s[44:47], s13 offen offset:1024 sc1
buffer_store_dwordx2 v[32:33], v14, s[44:47], s13 offen offset:2048 sc1
v_accvgpr_read_b32 v48, a40
v_accvgpr_read_b32 v49, a41
v_accvgpr_read_b32 v50, a42
v_accvgpr_read_b32 v51, a43
v_mul_f32 v48, 0x3ea52b5c, v48
v_mul_f32 v49, 0x3ea52b5c, v49
v_mul_f32 v50, 0x3ea52b5c, v50
v_mul_f32 v51, 0x3ea52b5c, v51
v_cvt_pk_bf16_f32 v224, v48, v49
v_cvt_pk_bf16_f32 v225, v50, v51
v_accvgpr_read_b32 v48, a44
v_accvgpr_read_b32 v49, a45
v_accvgpr_read_b32 v50, a46
v_accvgpr_read_b32 v51, a47
v_mul_f32 v48, 0x3ea52b5c, v48
v_mul_f32 v49, 0x3ea52b5c, v49
v_mul_f32 v50, 0x3ea52b5c, v50
v_mul_f32 v51, 0x3ea52b5c, v51
v_cvt_pk_bf16_f32 v226, v48, v49
v_cvt_pk_bf16_f32 v227, v50, v51
v_accvgpr_read_b32 v48, a48
v_accvgpr_read_b32 v49, a49
v_accvgpr_read_b32 v50, a50
v_accvgpr_read_b32 v51, a51
v_mul_f32 v48, 0x3ea52b5c, v48
v_mul_f32 v49, 0x3ea52b5c, v49
v_mul_f32 v50, 0x3ea52b5c, v50
v_mul_f32 v51, 0x3ea52b5c, v51
v_cvt_pk_bf16_f32 v228, v48, v49
v_cvt_pk_bf16_f32 v229, v50, v51
v_accvgpr_read_b32 v48, a52
v_accvgpr_read_b32 v49, a53
v_accvgpr_read_b32 v50, a54
v_accvgpr_read_b32 v51, a55
v_mul_f32 v48, 0x3ea52b5c, v48
v_mul_f32 v49, 0x3ea52b5c, v49
v_mul_f32 v50, 0x3ea52b5c, v50
v_mul_f32 v51, 0x3ea52b5c, v51
v_cvt_pk_bf16_f32 v232, v48, v49
v_cvt_pk_bf16_f32 v233, v50, v51
v_accvgpr_read_b32 v48, a56
v_accvgpr_read_b32 v49, a57
v_accvgpr_read_b32 v50, a58
v_accvgpr_read_b32 v51, a59
v_mul_f32 v48, 0x3ea52b5c, v48
v_mul_f32 v49, 0x3ea52b5c, v49
v_mul_f32 v50, 0x3ea52b5c, v50
v_mul_f32 v51, 0x3ea52b5c, v51
v_cvt_pk_bf16_f32 v234, v48, v49
v_cvt_pk_bf16_f32 v235, v50, v51
s_waitcnt vmcnt(0)
s_cmp_lg_u32 s4, 0
s_cbranch_scc1 L_c5_20
s_mov_b32 s64, 0
L_c5l_21:
v_xor_b32 v60, s5, v60
v_xor_b32 v61, s5, v61
v_xor_b32 v62, s5, v62
v_xor_b32 v63, s5, v63
v_or3_b32 v60, v60, v61, v62
v_or_b32 v60, v60, v63
v_cmp_ne_u32 vcc, 0, v60
s_nop 3
s_cmp_eq_u64 vcc, 0
s_cbranch_scc1 L_c5_20
s_add_u32 s64, s64, 1
s_cmp_gt_u32 s64, 1048576
s_cbranch_scc1 L_c5_20
buffer_load_dword v60, v56, s[44:47], 0 offen sc1
buffer_load_dword v61, v57, s[44:47], 0 offen sc1
buffer_load_dword v62, v58, s[44:47], 0 offen sc1
buffer_load_dword v63, v59, s[44:47], 0 offen sc1
s_waitcnt vmcnt(0)
s_branch L_c5l_21
L_c5_20:
s_barrier
s_lshl_b32 s12, s6, 4
s_add_u32 s12, s12, s7
s_cmp_lg_u32 s4, 0
s_cbranch_scc1 L_fs_22
s_lshl_b32 s64, s12, 7
s_add_u32 s64, s64, 0x8000
v_mov_b32 v252, s5
v_mov_b32 v253, 0
s_mov_b64 exec, 1
buffer_store_dword v252, v253, s[44:47], s64 offen sc1
s_mov_b64 exec, -1
L_fs_22:
s_cmp_lg_u32 s4, 3
s_cbranch_scc1 L_ct_23
s_lshl_b32 s64, s3, 4
v_and_b32 v249, 15, v1
v_add_u32 v249, s64, v249
v_lshlrev_b32 v249, 7, v249
v_min_u32 v249, L_code_end-L_code_begin-4, v249
global_load_dword v249, v249, s[22:23]
L_ct_23:
v_and_b32 v8, 1, v1
v_add_u32 v8, 1, v8
v_sub_u32 v8, s7, v8
v_max_i32 v8, 0, v8
s_lshl_b32 s12, s6, 4
v_add_u32 v8, s12, v8
v_lshlrev_b32 v8, 7, v8
v_add_u32 v14, 0x8000, v8
v_lshlrev_b32 v2, 4, v1
s_mov_b32 s48, s30
s_mov_b32 s49, s31
s_mov_b32 s50, 0x500
s_mov_b32 s51, 0x00020000
s_mov_b32 s56, s26
s_mov_b32 s57, s27
s_mov_b32 s58, 0xc00
s_mov_b32 s59, 0x00020000
v_lshlrev_b32 v8, 4, v0
v_mov_b32 v9, 0x7f000000
v_cmp_gt_u32 vcc, 160, v0
s_nop 1
v_cndmask_b32 v8, v9, v8, vcc
s_mov_b32 s14, 267264
buffer_load_dwordx4 v[16:19], v8, s[44:47], s14 offen sc1
s_mov_b32 s14, 282624
buffer_load_dwordx4 v[20:23], v8, s[44:47], s14 offen sc1
s_mov_b32 s14, 297984
buffer_load_dwordx4 v[24:27], v8, s[44:47], s14 offen sc1
s_mov_b32 s14, 313344
buffer_load_dwordx4 v[28:31], v8, s[44:47], s14 offen sc1
s_mov_b32 s14, 269824
buffer_load_dwordx4 v[32:35], v8, s[44:47], s14 offen sc1
s_mov_b32 s14, 285184
buffer_load_dwordx4 v[36:39], v8, s[44:47], s14 offen sc1
s_mov_b32 s14, 300544
buffer_load_dwordx4 v[40:43], v8, s[44:47], s14 offen sc1
s_mov_b32 s14, 315904
buffer_load_dwordx4 v[44:47], v8, s[44:47], s14 offen sc1
s_mov_b32 s14, 272384
buffer_load_dwordx4 v[48:51], v8, s[44:47], s14 offen sc1
s_mov_b32 s14, 287744
buffer_load_dwordx4 v[52:55], v8, s[44:47], s14 offen sc1
s_mov_b32 s14, 303104
buffer_load_dwordx4 v[56:59], v8, s[44:47], s14 offen sc1
s_mov_b32 s14, 318464
buffer_load_dwordx4 v[60:63], v8, s[44:47], s14 offen sc1
s_mov_b32 s14, 274944
buffer_load_dwordx4 v[64:67], v8, s[44:47], s14 offen sc1
s_mov_b32 s14, 290304
buffer_load_dwordx4 v[68:71], v8, s[44:47], s14 offen sc1
s_mov_b32 s14, 305664
buffer_load_dwordx4 v[72:75], v8, s[44:47], s14 offen sc1
s_mov_b32 s14, 321024
buffer_load_dwordx4 v[76:79], v8, s[44:47], s14 offen sc1
v_lshlrev_b32 v8, 3, v0
v_cmp_gt_u32 vcc, 20, v0
s_mul_i32 s14, s9, 160
s_nop 0
v_cndmask_b32 v10, v9, v8, vcc
buffer_load_dwordx2 v[80:81], v10, s[48:51], s14 offen
v_cmp_gt_u32 vcc, 24, v0
s_mul_i32 s14, s11, 192
s_nop 0
v_cndmask_b32 v10, v9, v8, vcc
buffer_load_dwordx2 v[82:83], v10, s[56:59], s14 offen
v_and_b32 v8, 31, v1
v_lshrrev_b32 v9, 5, v1
v_lshlrev_b32 v10, 2, v9
v_sub_u32 v8, v8, v10
v_cmp_le_i32 s[68:69], 0, v8
v_cmp_le_i32 s[70:71], 1, v8
v_cmp_le_i32 s[72:73], 2, v8
v_cmp_le_i32 s[74:75], 3, v8
v_cmp_le_i32 s[76:77], 8, v8
v_cmp_le_i32 s[78:79], 9, v8
v_cmp_le_i32 s[80:81], 10, v8
v_cmp_le_i32 s[82:83], 11, v8
v_cmp_le_i32 s[84:85], 16, v8
v_cmp_le_i32 s[86:87], 17, v8
v_cmp_le_i32 s[88:89], 18, v8
v_cmp_le_i32 s[90:91], 19, v8
v_cmp_le_i32 s[92:93], 24, v8
v_cmp_le_i32 s[94:95], 25, v8
v_cmp_le_i32 s[96:97], 26, v8
v_cmp_le_i32 s[98:99], 27, v8
v_mov_b32 v10, 0xffff
v_mov_b32 v11, 0xffff0000
v_cndmask_b32 v12, 0, v10, s[68:69]
v_cndmask_b32 v13, 0, v11, s[70:71]
v_or_b32 v112, v12, v13
v_cndmask_b32 v12, 0, v10, s[72:73]
v_cndmask_b32 v13, 0, v11, s[74:75]
v_or_b32 v113, v12, v13
v_cndmask_b32 v12, 0, v10, s[76:77]
v_cndmask_b32 v13, 0, v11, s[78:79]
v_or_b32 v114, v12, v13
v_cndmask_b32 v12, 0, v10, s[80:81]
v_cndmask_b32 v13, 0, v11, s[82:83]
v_or_b32 v115, v12, v13
v_cndmask_b32 v12, 0, v10, s[84:85]
v_cndmask_b32 v13, 0, v11, s[86:87]
v_or_b32 v116, v12, v13
v_cndmask_b32 v12, 0, v10, s[88:89]
v_cndmask_b32 v13, 0, v11, s[90:91]
v_or_b32 v117, v12, v13
v_cndmask_b32 v12, 0, v10, s[92:93]
v_cndmask_b32 v13, 0, v11, s[94:95]
v_or_b32 v118, v12, v13
v_cndmask_b32 v12, 0, v10, s[96:97]
v_cndmask_b32 v13, 0, v11, s[98:99]
v_or_b32 v119, v12, v13
v_cmp_eq_u32 vcc, 0, v9
v_mov_b32 v12, 0
s_nop 0
v_cndmask_b32 v236, v12, v228, vcc
v_cndmask_b32 v237, v12, v229, vcc
v_cndmask_b32 v238, v228, v12, vcc
v_cndmask_b32 v239, v229, v12, vcc
v_lshrrev_b32 v8, 5, v1
v_bfe_u32 v9, v1, 2, 2
v_bfe_u32 v10, v1, 4, 1
v_and_b32 v11, 3, v1
v_lshl_add_u32 v10, v10, 2, v11
v_lshlrev_b32 v12, 7, v8
v_lshl_add_u32 v12, v9, 4, v12
v_xor_b32 v13, 1, v8
v_lshlrev_b32 v13, 7, v13
v_lshl_add_u32 v13, v9, 3, v13
v_add_u32 v13, 2048, v13
v_xor_b32 v15, 1, v8
v_lshlrev_b32 v15, 7, v15
v_add_u32 v15, 2112, v15
v_and_b32 v95, 1, v10
v_lshl_add_u32 v6, v95, 6, v12
v_lshrrev_b32 v95, 1, v10
v_lshl_add_u32 v6, v95, 3, v6
v_cmp_eq_u32 vcc, 4, v10
s_nop 1
v_cndmask_b32 v6, v6, v13, vcc
v_cmp_lt_u32 vcc, 4, v10
s_nop 1
v_cndmask_b32 v6, v6, v15, vcc
v_subrev_u32 v95, 2, v10
v_and_b32 v7, 1, v95
v_lshl_add_u32 v7, v7, 6, v12
v_lshrrev_b32 v95, 1, v95
v_and_b32 v95, 1, v95
v_lshl_add_u32 v7, v95, 3, v7
v_add_u32 v7, 1024, v7
v_add_u32 v13, 32, v13
v_cmp_eq_u32 vcc, 1, v10
s_nop 1
v_cndmask_b32 v7, v7, v13, vcc
v_cmp_eq_u32 vcc, 0, v10
s_nop 1
v_cndmask_b32 v7, v7, v15, vcc
v_cmp_lt_u32 vcc, 5, v10
s_nop 1
v_cndmask_b32 v7, v7, v15, vcc
s_mul_i32 s15, s4, 3072
s_add_u32 s15, s15, 112640
v_add_u32 v4, s15, v6
v_add_u32 v5, s15, v7
s_mul_i32 s15, s4, 2560
s_add_u32 s15, s15, 81920
v_lshl_add_u32 v6, v1, 4, s15
s_add_u32 s15, s15, 2048
v_lshl_add_u32 v7, v1, 3, s15
v_lshrrev_b32 v8, 3, v1
s_mul_i32 s15, s4, 3
v_add_u32 v8, s15, v8
v_mul_u32_u24 v8, 3072, v8
v_bfe_u32 v9, v1, 1, 2
v_lshl_add_u32 v8, v9, 8, v8
v_and_b32 v9, 1, v1
v_lshl_add_u32 v8, v9, 7, v8
v_add_u32 v8, 114752, v8
v_mov_b32 v10, 0x3f80
v_mov_b32 v11, 0
v_cmp_gt_u32 vcc, 24, v1
s_nop 3
s_and_saveexec_b64 s[66:67], vcc
ds_write_b64 v8, v[10:11]
s_mov_b64 exec, s[66:67]
v_lshlrev_b32 v2, 4, v1
s_cmp_lg_u32 s4, 0
s_cbranch_scc1 L_pd_25
s_mov_b32 s64, 0
L_pl_24:
buffer_load_dword v250, v14, s[44:47], 0 offen sc1
s_add_u32 s64, s64, 1
s_cmp_gt_u32 s64, 1048576
s_cbranch_scc1 L_pd_25
s_waitcnt vmcnt(0)
v_cmp_ne_u32 vcc, s5, v250
s_nop 3
s_cmp_eq_u64 vcc, 0
s_cbranch_scc1 L_pd_25
s_branch L_pl_24
L_pd_25:
s_barrier
s_lshl_b32 s12, s7, 2
s_add_u32 s12, s12, s4
s_sub_i32 s13, 8, s12
s_max_i32 s13, s13, 0
s_mul_i32 s14, s4, 3
s_add_u32 s14, s14, 0
s_lshl_b32 s15, s7, 2
s_add_u32 s15, s15, s14
s_sub_i32 s15, s15, 8
s_max_i32 s15, s15, 0
s_lshl_b32 s64, s6, 6
s_add_u32 s15, s15, s64
s_mul_i32 s15, s15, 2560
s_add_u32 s15, s15, 0x400000
s_mul_i32 s14, s14, 2560
s_add_u32 m0, s14, 81920
s_nop 0
buffer_load_dwordx4 v2, s[44:47], s15 offen sc1 lds
s_add_u32 m0, s14, 82944
s_add_u32 s15, s15, 1024
buffer_load_dwordx4 v2, s[44:47], s15 offen sc1 lds
s_add_u32 m0, s14, 83968
s_add_u32 s15, s15, 1024
s_mov_b32 exec_lo, 0xffffffff
s_mov_b32 exec_hi, 0x0
buffer_load_dwordx4 v2, s[44:47], s15 offen sc1 lds
s_mov_b64 exec, -1
s_mul_i32 s14, s4, 3
s_add_u32 s14, s14, 1
s_lshl_b32 s15, s7, 2
s_add_u32 s15, s15, s14
s_sub_i32 s15, s15, 8
s_max_i32 s15, s15, 0
s_lshl_b32 s64, s6, 6
s_add_u32 s15, s15, s64
s_mul_i32 s15, s15, 2560
s_add_u32 s15, s15, 0x400000
s_mul_i32 s14, s14, 2560
s_add_u32 m0, s14, 81920
s_nop 0
buffer_load_dwordx4 v2, s[44:47], s15 offen sc1 lds
s_add_u32 m0, s14, 82944
s_add_u32 s15, s15, 1024
buffer_load_dwordx4 v2, s[44:47], s15 offen sc1 lds
s_add_u32 m0, s14, 83968
s_add_u32 s15, s15, 1024
s_mov_b32 exec_lo, 0xffffffff
s_mov_b32 exec_hi, 0x0
buffer_load_dwordx4 v2, s[44:47], s15 offen sc1 lds
s_mov_b64 exec, -1
s_mul_i32 s14, s4, 3
s_add_u32 s14, s14, 2
s_lshl_b32 s15, s7, 2
s_add_u32 s15, s15, s14
s_sub_i32 s15, s15, 8
s_max_i32 s15, s15, 0
s_lshl_b32 s64, s6, 6
s_add_u32 s15, s15, s64
s_mul_i32 s15, s15, 2560
s_add_u32 s15, s15, 0x400000
s_mul_i32 s14, s14, 2560
s_add_u32 m0, s14, 81920
s_nop 0
buffer_load_dwordx4 v2, s[44:47], s15 offen sc1 lds
s_add_u32 m0, s14, 82944
s_add_u32 s15, s15, 1024
buffer_load_dwordx4 v2, s[44:47], s15 offen sc1 lds
s_add_u32 m0, s14, 83968
s_add_u32 s15, s15, 1024
s_mov_b32 exec_lo, 0xffffffff
s_mov_b32 exec_hi, 0x0
buffer_load_dwordx4 v2, s[44:47], s15 offen sc1 lds
s_mov_b64 exec, -1
s_mul_i32 s14, s4, 3
s_add_u32 s14, s14, 0
s_lshl_b32 s15, s7, 2
s_add_u32 s15, s15, s14
s_sub_i32 s15, s15, 8
s_max_i32 s15, s15, 0
s_lshl_b32 s64, s6, 6
s_add_u32 s15, s15, s64
s_mul_i32 s15, s15, 3072
s_add_u32 s15, s15, 0x700000
s_mul_i32 s14, s14, 3072
s_add_u32 m0, s14, 112640
s_nop 0
buffer_load_dwordx4 v2, s[44:47], s15 offen sc1 lds
s_add_u32 m0, s14, 113664
s_add_u32 s15, s15, 1024
buffer_load_dwordx4 v2, s[44:47], s15 offen sc1 lds
s_add_u32 m0, s14, 114688
s_add_u32 s15, s15, 1024
s_mov_b32 exec_lo, 0xf0f0f0f
s_mov_b32 exec_hi, 0xf0f0f0f
buffer_load_dwordx4 v2, s[44:47], s15 offen sc1 lds
s_mov_b64 exec, -1
s_mul_i32 s14, s4, 3
s_add_u32 s14, s14, 1
s_lshl_b32 s15, s7, 2
s_add_u32 s15, s15, s14
s_sub_i32 s15, s15, 8
s_max_i32 s15, s15, 0
s_lshl_b32 s64, s6, 6
s_add_u32 s15, s15, s64
s_mul_i32 s15, s15, 3072
s_add_u32 s15, s15, 0x700000
s_mul_i32 s14, s14, 3072
s_add_u32 m0, s14, 112640
s_nop 0
buffer_load_dwordx4 v2, s[44:47], s15 offen sc1 lds
s_add_u32 m0, s14, 113664
s_add_u32 s15, s15, 1024
buffer_load_dwordx4 v2, s[44:47], s15 offen sc1 lds
s_add_u32 m0, s14, 114688
s_add_u32 s15, s15, 1024
s_mov_b32 exec_lo, 0xf0f0f0f
s_mov_b32 exec_hi, 0xf0f0f0f
buffer_load_dwordx4 v2, s[44:47], s15 offen sc1 lds
s_mov_b64 exec, -1
s_mul_i32 s14, s4, 3
s_add_u32 s14, s14, 2
s_lshl_b32 s15, s7, 2
s_add_u32 s15, s15, s14
s_sub_i32 s15, s15, 8
s_max_i32 s15, s15, 0
s_lshl_b32 s64, s6, 6
s_add_u32 s15, s15, s64
s_mul_i32 s15, s15, 3072
s_add_u32 s15, s15, 0x700000
s_mul_i32 s14, s14, 3072
s_add_u32 m0, s14, 112640
s_nop 0
buffer_load_dwordx4 v2, s[44:47], s15 offen sc1 lds
s_add_u32 m0, s14, 113664
s_add_u32 s15, s15, 1024
buffer_load_dwordx4 v2, s[44:47], s15 offen sc1 lds
s_add_u32 m0, s14, 114688
s_add_u32 s15, s15, 1024
s_mov_b32 exec_lo, 0xf0f0f0f
s_mov_b32 exec_hi, 0xf0f0f0f
buffer_load_dwordx4 v2, s[44:47], s15 offen sc1 lds
s_mov_b64 exec, -1
s_lshl_b32 s42, s4, 10
s_mul_i32 s43, s9, 102400
s_add_u32 s43, s43, 0x2400000
s_add_u32 s43, s43, s42
s_add_u32 s65, s42, 81920
s_waitcnt vmcnt(18)
v_add_f32 v16, v16, v20
v_add_f32 v24, v24, v28
v_add_f32 v16, v16, v24
v_add_f32 v17, v17, v21
v_add_f32 v25, v25, v29
v_add_f32 v17, v17, v25
v_add_f32 v18, v18, v22
v_add_f32 v26, v26, v30
v_add_f32 v18, v18, v26
v_add_f32 v19, v19, v23
v_add_f32 v27, v27, v31
v_add_f32 v19, v19, v27
v_cvt_pk_bf16_f32 v20, v16, v17
v_cvt_pk_bf16_f32 v21, v18, v19
v_lshlrev_b32 v16, 16, v20
v_and_b32 v17, 0xffff0000, v20
v_lshlrev_b32 v18, 16, v21
v_and_b32 v19, 0xffff0000, v21
v_add_f32 v32, v32, v36
v_add_f32 v40, v40, v44
v_add_f32 v32, v32, v40
v_add_f32 v33, v33, v37
v_add_f32 v41, v41, v45
v_add_f32 v33, v33, v41
v_add_f32 v34, v34, v38
v_add_f32 v42, v42, v46
v_add_f32 v34, v34, v42
v_add_f32 v35, v35, v39
v_add_f32 v43, v43, v47
v_add_f32 v35, v35, v43
v_cvt_pk_bf16_f32 v36, v32, v33
v_cvt_pk_bf16_f32 v37, v34, v35
v_add_f32 v48, v48, v52
v_add_f32 v56, v56, v60
v_add_f32 v48, v48, v56
v_add_f32 v49, v49, v53
v_add_f32 v57, v57, v61
v_add_f32 v49, v49, v57
v_add_f32 v50, v50, v54
v_add_f32 v58, v58, v62
v_add_f32 v50, v50, v58
v_add_f32 v51, v51, v55
v_add_f32 v59, v59, v63
v_add_f32 v51, v51, v59
v_cvt_pk_bf16_f32 v52, v48, v49
v_cvt_pk_bf16_f32 v53, v50, v51
v_lshlrev_b32 v48, 16, v52
v_and_b32 v49, 0xffff0000, v52
v_lshlrev_b32 v50, 16, v53
v_and_b32 v51, 0xffff0000, v53
v_add_f32 v64, v64, v68
v_add_f32 v72, v72, v76
v_add_f32 v64, v64, v72
v_add_f32 v65, v65, v69
v_add_f32 v73, v73, v77
v_add_f32 v65, v65, v73
v_add_f32 v66, v66, v70
v_add_f32 v74, v74, v78
v_add_f32 v66, v66, v74
v_add_f32 v67, v67, v71
v_add_f32 v75, v75, v79
v_add_f32 v67, v67, v75
v_cvt_pk_bf16_f32 v68, v64, v65
v_cvt_pk_bf16_f32 v69, v66, v67
v_lshlrev_b32 v64, 16, v68
v_and_b32 v65, 0xffff0000, v68
v_lshlrev_b32 v66, 16, v69
v_and_b32 v67, 0xffff0000, v69
v_add_f32 v48, 1.0, v48
v_add_f32 v49, 1.0, v49
v_add_f32 v50, 1.0, v50
v_add_f32 v51, 1.0, v51
v_cvt_pk_bf16_f32 v52, v48, v49
v_cvt_pk_bf16_f32 v53, v50, v51
v_lshlrev_b32 v48, 16, v52
v_and_b32 v49, 0xffff0000, v52
v_lshlrev_b32 v50, 16, v53
v_and_b32 v51, 0xffff0000, v53
v_cmp_gt_u32 vcc, 160, v0
s_nop 3
s_and_saveexec_b64 s[66:67], vcc
v_lshlrev_b32 v8, 3, v0
v_add_u32 v9, 155264, v8
ds_write_b64 v9, v[52:53]
ds_write_b64 v9, v[36:37] offset:1280
s_mul_i32 s14, s9, 20
v_subrev_u32 v10, s14, v0
v_cmp_gt_u32 vcc, 20, v10
s_nop 3
s_and_b64 exec, exec, vcc
v_lshlrev_b32 v10, 4, v10
v_add_u32 v10, 153600, v10
ds_write_b128 v10, v[16:19]
ds_write_b128 v10, v[48:51] offset:320
ds_write_b128 v10, v[64:67] offset:640
s_mov_b64 exec, s[66:67]
v_lshlrev_b32 v84, 16, v80
v_and_b32 v85, 0xffff0000, v80
v_lshlrev_b32 v86, 16, v81
v_and_b32 v87, 0xffff0000, v81
v_lshlrev_b32 v88, 16, v82
v_and_b32 v89, 0xffff0000, v82
v_lshlrev_b32 v90, 16, v83
v_and_b32 v91, 0xffff0000, v83
v_lshlrev_b32 v8, 4, v0
v_cmp_gt_u32 vcc, 20, v0
s_nop 3
s_and_saveexec_b64 s[66:67], vcc
v_add_u32 v9, 154560, v8
ds_write_b128 v9, v[84:87]
s_mov_b64 exec, s[66:67]
v_cmp_gt_u32 vcc, 24, v0
s_nop 3
s_and_saveexec_b64 s[66:67], vcc
v_add_u32 v9, 154880, v8
ds_write_b128 v9, v[88:91]
s_mov_b64 exec, s[66:67]
s_waitcnt vmcnt(0) lgkmcnt(0)
s_barrier
v_mov_b32 v8, 0
v_mov_b32 v9, 0xff800000
v_cndmask_b32 v132, v9, v8, s[68:69]
v_cndmask_b32 v148, v8, v9, s[68:69]
v_cndmask_b32 v133, v9, v8, s[70:71]
v_cndmask_b32 v149, v8, v9, s[70:71]
v_cndmask_b32 v134, v9, v8, s[72:73]
v_cndmask_b32 v150, v8, v9, s[72:73]
v_cndmask_b32 v135, v9, v8, s[74:75]
v_cndmask_b32 v151, v8, v9, s[74:75]
v_cndmask_b32 v136, v9, v8, s[76:77]
v_cndmask_b32 v152, v8, v9, s[76:77]
v_cndmask_b32 v137, v9, v8, s[78:79]
v_cndmask_b32 v153, v8, v9, s[78:79]
v_cndmask_b32 v138, v9, v8, s[80:81]
v_cndmask_b32 v154, v8, v9, s[80:81]
v_cndmask_b32 v139, v9, v8, s[82:83]
v_cndmask_b32 v155, v8, v9, s[82:83]
v_cndmask_b32 v140, v9, v8, s[84:85]
v_cndmask_b32 v156, v8, v9, s[84:85]
v_cndmask_b32 v141, v9, v8, s[86:87]
v_cndmask_b32 v157, v8, v9, s[86:87]
v_cndmask_b32 v142, v9, v8, s[88:89]
v_cndmask_b32 v158, v8, v9, s[88:89]
v_cndmask_b32 v143, v9, v8, s[90:91]
v_cndmask_b32 v159, v8, v9, s[90:91]
v_cndmask_b32 v144, v9, v8, s[92:93]
v_cndmask_b32 v160, v8, v9, s[92:93]
v_cndmask_b32 v145, v9, v8, s[94:95]
v_cndmask_b32 v161, v8, v9, s[94:95]
v_cndmask_b32 v146, v9, v8, s[96:97]
v_cndmask_b32 v162, v8, v9, s[96:97]
v_cndmask_b32 v147, v9, v8, s[98:99]
v_cndmask_b32 v163, v8, v9, s[98:99]
ds_read_b128 a[16:19], v6 offset:20480
ds_read_b64 a[20:21], v7 offset:20480
ds_read_b128 a[8:11], v6 offset:17920
ds_read_b64 a[12:13], v7 offset:17920
s_waitcnt lgkmcnt(2)
v_mfma_f32_32x32x16_bf16 v[16:31], a[16:19], v[224:227], v[132:147]
v_mfma_f32_32x32x8bf16_1k v[16:31], a[20:21], v[236:237], v[16:31]
s_waitcnt lgkmcnt(0)
v_mfma_f32_32x32x16_bf16 v[32:47], a[8:11], v[224:227], 0
s_nop 9
v_exp_f32 v16, v16
v_exp_f32 v17, v17
v_exp_f32 v18, v18
v_mfma_f32_32x32x8bf16_1k v[32:47], a[12:13], v[236:237], v[32:47]
v_exp_f32 v19, v19
v_cvt_pk_bf16_f32 v80, v16, v17
v_exp_f32 v20, v20
ds_read_b64_tr_b16 a[96:97], v4 offset:24576
ds_read_b64_tr_b16 a[98:99], v4 offset:24832
ds_read_b64_tr_b16 a[100:101], v4 offset:25088
ds_read_b64_tr_b16 a[102:103], v4 offset:25344
ds_read_b128 a[0:3], v6 offset:15360
ds_read_b64 a[4:5], v7 offset:15360
s_mov_b32 m0, s42
s_add_u32 s42, s42, 4096
buffer_load_dwordx4 v2, s[44:47], s43 offen sc1 lds
s_add_u32 s43, s43, 4096
v_exp_f32 v21, v21
v_cvt_pk_bf16_f32 v81, v18, v19
v_exp_f32 v22, v22
v_exp_f32 v23, v23
v_cvt_pk_bf16_f32 v82, v20, v21
v_exp_f32 v24, v24
v_exp_f32 v25, v25
v_cvt_pk_bf16_f32 v83, v22, v23
v_exp_f32 v26, v26
v_exp_f32 v27, v27
v_cvt_pk_bf16_f32 v84, v24, v25
v_exp_f32 v28, v28
v_exp_f32 v29, v29
v_cvt_pk_bf16_f32 v85, v26, v27
v_exp_f32 v30, v30
v_exp_f32 v31, v31
v_cvt_pk_bf16_f32 v86, v28, v29
v_cvt_pk_bf16_f32 v87, v30, v31
s_cmp_gt_u32 s13, 7
s_cbranch_scc1 L_ffirst_31
s_waitcnt lgkmcnt(0)
v_mfma_f32_32x32x16_bf16 v[96:111], a[96:99], v[80:83], 0
v_exp_f32 v32, v32
v_exp_f32 v33, v33
v_exp_f32 v34, v34
v_mfma_f32_32x32x16_bf16 v[16:31], a[0:3], v[224:227], 0
v_exp_f32 v35, v35
v_cvt_pk_bf16_f32 v88, v32, v33
v_exp_f32 v36, v36
ds_read_b64_tr_b16 a[104:105], v4 offset:21504
ds_read_b64_tr_b16 a[106:107], v4 offset:21760
v_mfma_f32_32x32x16_bf16 v[96:111], a[100:103], v[84:87], v[96:111]
v_exp_f32 v37, v37
v_cvt_pk_bf16_f32 v89, v34, v35
v_exp_f32 v38, v38
ds_read_b64_tr_b16 a[108:109], v4 offset:22016
ds_read_b64_tr_b16 a[110:111], v4 offset:22272
v_mfma_f32_32x32x8bf16_1k v[16:31], a[4:5], v[236:237], v[16:31]
v_exp_f32 v39, v39
v_cvt_pk_bf16_f32 v90, v36, v37
v_exp_f32 v40, v40
ds_read_b128 a[16:19], v6 offset:12800
ds_read_b64 a[20:21], v7 offset:12800
s_mov_b32 m0, s42
s_add_u32 s42, s42, 4096
buffer_load_dwordx4 v2, s[44:47], s43 offen sc1 lds
s_add_u32 s43, s43, 4096
v_exp_f32 v41, v41
v_cvt_pk_bf16_f32 v91, v38, v39
v_exp_f32 v42, v42
v_exp_f32 v43, v43
v_cvt_pk_bf16_f32 v92, v40, v41
v_exp_f32 v44, v44
v_exp_f32 v45, v45
v_cvt_pk_bf16_f32 v93, v42, v43
v_exp_f32 v46, v46
v_exp_f32 v47, v47
v_cvt_pk_bf16_f32 v94, v44, v45
v_cvt_pk_bf16_f32 v95, v46, v47
s_cmp_gt_u32 s13, 6
s_cbranch_scc1 L_ff1_30
s_waitcnt lgkmcnt(0)
v_mfma_f32_32x32x16_bf16 v[96:111], a[104:107], v[88:91], v[96:111]
v_exp_f32 v16, v16
v_exp_f32 v17, v17
v_exp_f32 v18, v18
v_mfma_f32_32x32x16_bf16 v[32:47], a[16:19], v[224:227], 0
v_exp_f32 v19, v19
v_cvt_pk_bf16_f32 v80, v16, v17
v_exp_f32 v20, v20
ds_read_b64_tr_b16 a[96:97], v4 offset:18432
ds_read_b64_tr_b16 a[98:99], v4 offset:18688
v_mfma_f32_32x32x16_bf16 v[96:111], a[108:111], v[92:95], v[96:111]
v_exp_f32 v21, v21
v_cvt_pk_bf16_f32 v81, v18, v19
v_exp_f32 v22, v22
ds_read_b64_tr_b16 a[100:101], v4 offset:18944
ds_read_b64_tr_b16 a[102:103], v4 offset:19200
v_mfma_f32_32x32x8bf16_1k v[32:47], a[20:21], v[236:237], v[32:47]
v_exp_f32 v23, v23
v_cvt_pk_bf16_f32 v82, v20, v21
v_exp_f32 v24, v24
ds_read_b128 a[8:11], v6 offset:10240
ds_read_b64 a[12:13], v7 offset:10240
s_mov_b32 m0, s42
s_add_u32 s42, s42, 4096
buffer_load_dwordx4 v2, s[44:47], s43 offen sc1 lds
s_add_u32 s43, s43, 4096
v_exp_f32 v25, v25
v_cvt_pk_bf16_f32 v83, v22, v23
v_exp_f32 v26, v26
v_exp_f32 v27, v27
v_cvt_pk_bf16_f32 v84, v24, v25
v_exp_f32 v28, v28
v_exp_f32 v29, v29
v_cvt_pk_bf16_f32 v85, v26, v27
v_exp_f32 v30, v30
v_exp_f32 v31, v31
v_cvt_pk_bf16_f32 v86, v28, v29
v_cvt_pk_bf16_f32 v87, v30, v31
s_cmp_gt_u32 s13, 5
s_cbranch_scc1 L_ff0_29
s_waitcnt lgkmcnt(0)
v_mfma_f32_32x32x16_bf16 v[96:111], a[96:99], v[80:83], v[96:111]
v_exp_f32 v32, v32
v_exp_f32 v33, v33
v_exp_f32 v34, v34
v_mfma_f32_32x32x16_bf16 v[16:31], a[8:11], v[224:227], 0
v_exp_f32 v35, v35
v_cvt_pk_bf16_f32 v88, v32, v33
v_exp_f32 v36, v36
ds_read_b64_tr_b16 a[104:105], v4 offset:15360
ds_read_b64_tr_b16 a[106:107], v4 offset:15616
v_mfma_f32_32x32x16_bf16 v[96:111], a[100:103], v[84:87], v[96:111]
v_exp_f32 v37, v37
v_cvt_pk_bf16_f32 v89, v34, v35
v_exp_f32 v38, v38
ds_read_b64_tr_b16 a[108:109], v4 offset:15872
ds_read_b64_tr_b16 a[110:111], v4 offset:16128
v_mfma_f32_32x32x8bf16_1k v[16:31], a[12:13], v[236:237], v[16:31]
v_exp_f32 v39, v39
v_cvt_pk_bf16_f32 v90, v36, v37
v_exp_f32 v40, v40
ds_read_b128 a[0:3], v6 offset:7680
ds_read_b64 a[4:5], v7 offset:7680
s_mov_b32 m0, s42
s_add_u32 s42, s42, 4096
buffer_load_dwordx4 v2, s[44:47], s43 offen sc1 lds
s_add_u32 s43, s43, 4096
v_exp_f32 v41, v41
v_cvt_pk_bf16_f32 v91, v38, v39
v_exp_f32 v42, v42
v_exp_f32 v43, v43
v_cvt_pk_bf16_f32 v92, v40, v41
v_exp_f32 v44, v44
v_exp_f32 v45, v45
v_cvt_pk_bf16_f32 v93, v42, v43
v_exp_f32 v46, v46
v_exp_f32 v47, v47
v_cvt_pk_bf16_f32 v94, v44, v45
v_cvt_pk_bf16_f32 v95, v46, v47
s_cmp_gt_u32 s13, 4
s_cbranch_scc1 L_ff1_30
s_waitcnt lgkmcnt(0)
v_mfma_f32_32x32x16_bf16 v[96:111], a[104:107], v[88:91], v[96:111]
v_exp_f32 v16, v16
v_exp_f32 v17, v17
v_exp_f32 v18, v18
v_mfma_f32_32x32x16_bf16 v[32:47], a[0:3], v[224:227], 0
v_exp_f32 v19, v19
v_cvt_pk_bf16_f32 v80, v16, v17
v_exp_f32 v20, v20
ds_read_b64_tr_b16 a[96:97], v4 offset:12288
ds_read_b64_tr_b16 a[98:99], v4 offset:12544
v_mfma_f32_32x32x16_bf16 v[96:111], a[108:111], v[92:95], v[96:111]
v_exp_f32 v21, v21
v_cvt_pk_bf16_f32 v81, v18, v19
v_exp_f32 v22, v22
ds_read_b64_tr_b16 a[100:101], v4 offset:12800
ds_read_b64_tr_b16 a[102:103], v4 offset:13056
v_mfma_f32_32x32x8bf16_1k v[32:47], a[4:5], v[236:237], v[32:47]
v_exp_f32 v23, v23
v_cvt_pk_bf16_f32 v82, v20, v21
v_exp_f32 v24, v24
ds_read_b128 a[16:19], v6 offset:5120
ds_read_b64 a[20:21], v7 offset:5120
s_mov_b32 m0, s42
s_add_u32 s42, s42, 4096
buffer_load_dwordx4 v2, s[44:47], s43 offen sc1 lds
s_add_u32 s43, s43, 4096
v_exp_f32 v25, v25
v_cvt_pk_bf16_f32 v83, v22, v23
v_exp_f32 v26, v26
v_exp_f32 v27, v27
v_cvt_pk_bf16_f32 v84, v24, v25
v_exp_f32 v28, v28
v_exp_f32 v29, v29
v_cvt_pk_bf16_f32 v85, v26, v27
v_exp_f32 v30, v30
v_exp_f32 v31, v31
v_cvt_pk_bf16_f32 v86, v28, v29
v_cvt_pk_bf16_f32 v87, v30, v31
s_cmp_gt_u32 s13, 3
s_cbranch_scc1 L_ff0_29
s_waitcnt lgkmcnt(0)
v_mfma_f32_32x32x16_bf16 v[96:111], a[96:99], v[80:83], v[96:111]
v_exp_f32 v32, v32
v_exp_f32 v33, v33
v_exp_f32 v34, v34
v_mfma_f32_32x32x16_bf16 v[16:31], a[16:19], v[224:227], 0
v_exp_f32 v35, v35
v_cvt_pk_bf16_f32 v88, v32, v33
v_exp_f32 v36, v36
ds_read_b64_tr_b16 a[104:105], v4 offset:9216
ds_read_b64_tr_b16 a[106:107], v4 offset:9472
v_mfma_f32_32x32x16_bf16 v[96:111], a[100:103], v[84:87], v[96:111]
v_exp_f32 v37, v37
v_cvt_pk_bf16_f32 v89, v34, v35
v_exp_f32 v38, v38
ds_read_b64_tr_b16 a[108:109], v4 offset:9728
ds_read_b64_tr_b16 a[110:111], v4 offset:9984
v_mfma_f32_32x32x8bf16_1k v[16:31], a[20:21], v[236:237], v[16:31]
v_exp_f32 v39, v39
v_cvt_pk_bf16_f32 v90, v36, v37
v_exp_f32 v40, v40
ds_read_b128 a[8:11], v6 offset:2560
ds_read_b64 a[12:13], v7 offset:2560
s_mov_b32 m0, s42
s_add_u32 s42, s42, 4096
buffer_load_dwordx4 v2, s[44:47], s43 offen sc1 lds
s_add_u32 s43, s43, 4096
v_exp_f32 v41, v41
v_cvt_pk_bf16_f32 v91, v38, v39
v_exp_f32 v42, v42
v_exp_f32 v43, v43
v_cvt_pk_bf16_f32 v92, v40, v41
v_exp_f32 v44, v44
v_exp_f32 v45, v45
v_cvt_pk_bf16_f32 v93, v42, v43
v_exp_f32 v46, v46
v_exp_f32 v47, v47
v_cvt_pk_bf16_f32 v94, v44, v45
v_cvt_pk_bf16_f32 v95, v46, v47
s_cmp_gt_u32 s13, 2
s_cbranch_scc1 L_ff1_30
s_waitcnt lgkmcnt(0)
v_mfma_f32_32x32x16_bf16 v[96:111], a[104:107], v[88:91], v[96:111]
v_exp_f32 v16, v16
v_exp_f32 v17, v17
v_exp_f32 v18, v18
v_mfma_f32_32x32x16_bf16 v[32:47], a[8:11], v[224:227], 0
v_exp_f32 v19, v19
v_cvt_pk_bf16_f32 v80, v16, v17
v_exp_f32 v20, v20
ds_read_b64_tr_b16 a[96:97], v4 offset:6144
ds_read_b64_tr_b16 a[98:99], v4 offset:6400
v_mfma_f32_32x32x16_bf16 v[96:111], a[108:111], v[92:95], v[96:111]
v_exp_f32 v21, v21
v_cvt_pk_bf16_f32 v81, v18, v19
v_exp_f32 v22, v22
ds_read_b64_tr_b16 a[100:101], v4 offset:6656
ds_read_b64_tr_b16 a[102:103], v4 offset:6912
v_mfma_f32_32x32x8bf16_1k v[32:47], a[12:13], v[236:237], v[32:47]
v_exp_f32 v23, v23
v_cvt_pk_bf16_f32 v82, v20, v21
v_exp_f32 v24, v24
ds_read_b128 a[0:3], v6 offset:0
ds_read_b64 a[4:5], v7 offset:0
s_mov_b32 m0, s42
s_add_u32 s42, s42, 4096
buffer_load_dwordx4 v2, s[44:47], s43 offen sc1 lds
s_add_u32 s43, s43, 4096
v_exp_f32 v25, v25
v_cvt_pk_bf16_f32 v83, v22, v23
v_exp_f32 v26, v26
v_exp_f32 v27, v27
v_cvt_pk_bf16_f32 v84, v24, v25
v_exp_f32 v28, v28
v_exp_f32 v29, v29
v_cvt_pk_bf16_f32 v85, v26, v27
v_exp_f32 v30, v30
v_exp_f32 v31, v31
v_cvt_pk_bf16_f32 v86, v28, v29
v_cvt_pk_bf16_f32 v87, v30, v31
s_cmp_gt_u32 s13, 1
s_cbranch_scc1 L_ff0_29
s_waitcnt lgkmcnt(0)
v_mfma_f32_32x32x16_bf16 v[96:111], a[96:99], v[80:83], v[96:111]
v_exp_f32 v32, v32
v_exp_f32 v33, v33
v_exp_f32 v34, v34
v_mfma_f32_32x32x16_bf16 v[16:31], a[0:3], v[224:227], v[148:163]
v_exp_f32 v35, v35
v_cvt_pk_bf16_f32 v88, v32, v33
v_exp_f32 v36, v36
ds_read_b64_tr_b16 a[104:105], v4 offset:3072
ds_read_b64_tr_b16 a[106:107], v4 offset:3328
v_mfma_f32_32x32x16_bf16 v[96:111], a[100:103], v[84:87], v[96:111]
v_exp_f32 v37, v37
v_cvt_pk_bf16_f32 v89, v34, v35
v_exp_f32 v38, v38
ds_read_b64_tr_b16 a[108:109], v4 offset:3584
ds_read_b64_tr_b16 a[110:111], v4 offset:3840
v_mfma_f32_32x32x8bf16_1k v[16:31], a[4:5], v[236:237], v[16:31]
v_exp_f32 v39, v39
v_cvt_pk_bf16_f32 v90, v36, v37
v_exp_f32 v40, v40
s_mov_b32 m0, s42
s_add_u32 s42, s42, 4096
buffer_load_dwordx4 v2, s[44:47], s43 offen sc1 lds
s_add_u32 s43, s43, 4096
v_exp_f32 v41, v41
v_cvt_pk_bf16_f32 v91, v38, v39
v_exp_f32 v42, v42
v_exp_f32 v43, v43
v_cvt_pk_bf16_f32 v92, v40, v41
v_exp_f32 v44, v44
v_exp_f32 v45, v45
v_cvt_pk_bf16_f32 v93, v42, v43
v_exp_f32 v46, v46
v_exp_f32 v47, v47
v_cvt_pk_bf16_f32 v94, v44, v45
v_cvt_pk_bf16_f32 v95, v46, v47
s_cmp_gt_u32 s13, 0
s_cbranch_scc1 L_ff1_30
s_waitcnt lgkmcnt(0)
v_mfma_f32_32x32x16_bf16 v[96:111], a[104:107], v[88:91], v[96:111]
v_exp_f32 v16, v16
v_exp_f32 v17, v17
v_exp_f32 v18, v18
v_mfma_f32_32x32x16_bf16 v[96:111], a[108:111], v[92:95], v[96:111]
v_exp_f32 v19, v19
v_cvt_pk_bf16_f32 v80, v16, v17
v_exp_f32 v20, v20
ds_read_b64_tr_b16 a[96:97], v4 offset:0
ds_read_b64_tr_b16 a[98:99], v4 offset:256
ds_read_b64_tr_b16 a[100:101], v4 offset:512
ds_read_b64_tr_b16 a[102:103], v4 offset:768
s_mov_b32 m0, s42
s_add_u32 s42, s42, 4096
buffer_load_dwordx4 v2, s[44:47], s43 offen sc1 lds
s_add_u32 s43, s43, 4096
v_exp_f32 v21, v21
v_cvt_pk_bf16_f32 v81, v18, v19
v_exp_f32 v22, v22
v_exp_f32 v23, v23
v_cvt_pk_bf16_f32 v82, v20, v21
v_exp_f32 v24, v24
v_exp_f32 v25, v25
v_cvt_pk_bf16_f32 v83, v22, v23
v_exp_f32 v26, v26
v_exp_f32 v27, v27
v_cvt_pk_bf16_f32 v84, v24, v25
v_exp_f32 v28, v28
v_exp_f32 v29, v29
v_cvt_pk_bf16_f32 v85, v26, v27
v_exp_f32 v30, v30
v_exp_f32 v31, v31
v_cvt_pk_bf16_f32 v86, v28, v29
v_cvt_pk_bf16_f32 v87, v30, v31
L_ff0_29:
s_waitcnt lgkmcnt(0)
v_mfma_f32_32x32x16_bf16 v[96:111], a[96:99], v[80:83], v[96:111]
v_mfma_f32_32x32x16_bf16 v[96:111], a[100:103], v[84:87], v[96:111]
s_branch L_fe_28
L_ff1_30:
s_waitcnt lgkmcnt(0)
v_mfma_f32_32x32x16_bf16 v[96:111], a[104:107], v[88:91], v[96:111]
v_mfma_f32_32x32x16_bf16 v[96:111], a[108:111], v[92:95], v[96:111]
s_branch L_fe_28
L_ffirst_31:
s_waitcnt lgkmcnt(0)
s_nop 7
v_mfma_f32_32x32x16_bf16 v[96:111], a[96:99], v[80:83], 0
v_mfma_f32_32x32x16_bf16 v[96:111], a[100:103], v[84:87], v[96:111]
L_fe_28:
s_nop 7
s_nop 7
v_mov_b32 v8, v104
v_mov_b32 v9, v104
s_nop 1
v_permlane32_swap_b32 v8, v9
v_mov_b32 v10, 0x2b800000
v_mov_b32 v11, 0x53800000
v_cmp_nle_f32 vcc, v10, v9
v_cmp_nle_f32 s[66:67], v9, v11
s_nop 3
s_or_b64 vcc, vcc, s[66:67]
s_cmp_eq_u64 vcc, 0
s_cbranch_scc0 L_slow_26
L_norm_27:
v_rcp_f32 v8, v9
s_nop 0
v_mul_f32 v96, v8, v96
v_mul_f32 v97, v8, v97
v_mul_f32 v98, v8, v98
v_mul_f32 v99, v8, v99
v_mul_f32 v100, v8, v100
v_mul_f32 v101, v8, v101
v_mul_f32 v102, v8, v102
v_mul_f32 v103, v8, v103
v_mul_f32 v104, v8, v104
v_mul_f32 v105, v8, v105
v_mul_f32 v106, v8, v106
v_mul_f32 v107, v8, v107
v_cvt_pk_bf16_f32 v120, v96, v97
v_cvt_pk_bf16_f32 v121, v98, v99
s_mov_b32 m0, s42
s_add_u32 s42, s42, 4096
buffer_load_dwordx4 v2, s[44:47], s43 offen sc1 lds
s_add_u32 s43, s43, 4096
v_cvt_pk_bf16_f32 v122, v100, v101
v_cvt_pk_bf16_f32 v123, v102, v103
v_cvt_pk_bf16_f32 v124, v104, v105
s_mov_b32 m0, s42
s_add_u32 s42, s42, 4096
buffer_load_dwordx4 v2, s[44:47], s43 offen sc1 lds
s_add_u32 s43, s43, 4096
v_cvt_pk_bf16_f32 v125, v106, v107
ds_read_b128 a[16:19], v6 offset:21504
ds_read_b64 a[20:21], v7 offset:20480
ds_read_b128 a[8:11], v6 offset:18944
ds_read_b64 a[12:13], v7 offset:17920
s_waitcnt lgkmcnt(2)
v_mfma_f32_32x32x16_bf16 v[16:31], a[16:19], v[232:235], v[132:147]
v_mfma_f32_32x32x8bf16_1k v[16:31], a[20:21], v[238:239], v[16:31]
s_waitcnt lgkmcnt(0)
v_mfma_f32_32x32x16_bf16 v[32:47], a[8:11], v[232:235], 0
s_nop 9
v_exp_f32 v16, v16
v_exp_f32 v17, v17
v_exp_f32 v18, v18
v_mfma_f32_32x32x8bf16_1k v[32:47], a[12:13], v[238:239], v[32:47]
v_exp_f32 v19, v19
v_cvt_pk_bf16_f32 v80, v16, v17
v_exp_f32 v20, v20
ds_read_b64_tr_b16 a[96:97], v5 offset:24576
ds_read_b64_tr_b16 a[98:99], v5 offset:24832
ds_read_b64_tr_b16 a[100:101], v5 offset:25088
ds_read_b64_tr_b16 a[102:103], v5 offset:25344
ds_read_b128 a[0:3], v6 offset:16384
ds_read_b64 a[4:5], v7 offset:15360
s_mov_b32 m0, s42
s_add_u32 s42, s42, 4096
buffer_load_dwordx4 v2, s[44:47], s43 offen sc1 lds
s_add_u32 s43, s43, 4096
v_exp_f32 v21, v21
v_cvt_pk_bf16_f32 v81, v18, v19
v_exp_f32 v22, v22
v_exp_f32 v23, v23
v_cvt_pk_bf16_f32 v82, v20, v21
v_exp_f32 v24, v24
v_exp_f32 v25, v25
v_cvt_pk_bf16_f32 v83, v22, v23
v_exp_f32 v26, v26
v_exp_f32 v27, v27
v_cvt_pk_bf16_f32 v84, v24, v25
v_exp_f32 v28, v28
v_exp_f32 v29, v29
v_cvt_pk_bf16_f32 v85, v26, v27
v_exp_f32 v30, v30
v_exp_f32 v31, v31
v_cvt_pk_bf16_f32 v86, v28, v29
v_cvt_pk_bf16_f32 v87, v30, v31
s_cmp_gt_u32 s13, 7
s_cbranch_scc1 L_ffirst_37
s_waitcnt lgkmcnt(0)
v_mfma_f32_32x32x16_bf16 v[96:111], a[96:99], v[80:83], 0
v_exp_f32 v32, v32
v_exp_f32 v33, v33
v_exp_f32 v34, v34
v_mfma_f32_32x32x16_bf16 v[16:31], a[0:3], v[232:235], 0
v_exp_f32 v35, v35
v_cvt_pk_bf16_f32 v88, v32, v33
v_exp_f32 v36, v36
ds_read_b64_tr_b16 a[104:105], v5 offset:21504
ds_read_b64_tr_b16 a[106:107], v5 offset:21760
v_mfma_f32_32x32x16_bf16 v[96:111], a[100:103], v[84:87], v[96:111]
v_exp_f32 v37, v37
v_cvt_pk_bf16_f32 v89, v34, v35
v_exp_f32 v38, v38
ds_read_b64_tr_b16 a[108:109], v5 offset:22016
ds_read_b64_tr_b16 a[110:111], v5 offset:22272
v_mfma_f32_32x32x8bf16_1k v[16:31], a[4:5], v[238:239], v[16:31]
v_exp_f32 v39, v39
v_cvt_pk_bf16_f32 v90, v36, v37
v_exp_f32 v40, v40
ds_read_b128 a[16:19], v6 offset:13824
ds_read_b64 a[20:21], v7 offset:12800
s_mov_b32 m0, s42
s_add_u32 s42, s42, 4096
buffer_load_dwordx4 v2, s[44:47], s43 offen sc1 lds
s_add_u32 s43, s43, 4096
v_exp_f32 v41, v41
v_cvt_pk_bf16_f32 v91, v38, v39
v_exp_f32 v42, v42
v_exp_f32 v43, v43
v_cvt_pk_bf16_f32 v92, v40, v41
v_exp_f32 v44, v44
v_exp_f32 v45, v45
v_cvt_pk_bf16_f32 v93, v42, v43
v_exp_f32 v46, v46
v_exp_f32 v47, v47
v_cvt_pk_bf16_f32 v94, v44, v45
v_cvt_pk_bf16_f32 v95, v46, v47
s_cmp_gt_u32 s13, 6
s_cbranch_scc1 L_ff1_36
s_waitcnt lgkmcnt(0)
v_mfma_f32_32x32x16_bf16 v[96:111], a[104:107], v[88:91], v[96:111]
v_exp_f32 v16, v16
v_exp_f32 v17, v17
v_exp_f32 v18, v18
v_mfma_f32_32x32x16_bf16 v[32:47], a[16:19], v[232:235], 0
v_exp_f32 v19, v19
v_cvt_pk_bf16_f32 v80, v16, v17
v_exp_f32 v20, v20
ds_read_b64_tr_b16 a[96:97], v5 offset:18432
ds_read_b64_tr_b16 a[98:99], v5 offset:18688
v_mfma_f32_32x32x16_bf16 v[96:111], a[108:111], v[92:95], v[96:111]
v_exp_f32 v21, v21
v_cvt_pk_bf16_f32 v81, v18, v19
v_exp_f32 v22, v22
ds_read_b64_tr_b16 a[100:101], v5 offset:18944
ds_read_b64_tr_b16 a[102:103], v5 offset:19200
v_mfma_f32_32x32x8bf16_1k v[32:47], a[20:21], v[238:239], v[32:47]
v_exp_f32 v23, v23
v_cvt_pk_bf16_f32 v82, v20, v21
v_exp_f32 v24, v24
ds_read_b128 a[8:11], v6 offset:11264
ds_read_b64 a[12:13], v7 offset:10240
s_mov_b32 m0, s42
s_add_u32 s42, s42, 4096
buffer_load_dwordx4 v2, s[44:47], s43 offen sc1 lds
s_add_u32 s43, s43, 4096
v_exp_f32 v25, v25
v_cvt_pk_bf16_f32 v83, v22, v23
v_exp_f32 v26, v26
v_exp_f32 v27, v27
v_cvt_pk_bf16_f32 v84, v24, v25
v_exp_f32 v28, v28
v_exp_f32 v29, v29
v_cvt_pk_bf16_f32 v85, v26, v27
v_exp_f32 v30, v30
v_exp_f32 v31, v31
v_cvt_pk_bf16_f32 v86, v28, v29
v_cvt_pk_bf16_f32 v87, v30, v31
s_cmp_gt_u32 s13, 5
s_cbranch_scc1 L_ff0_35
s_waitcnt lgkmcnt(0)
v_mfma_f32_32x32x16_bf16 v[96:111], a[96:99], v[80:83], v[96:111]
v_exp_f32 v32, v32
v_exp_f32 v33, v33
v_exp_f32 v34, v34
v_mfma_f32_32x32x16_bf16 v[16:31], a[8:11], v[232:235], 0
v_exp_f32 v35, v35
v_cvt_pk_bf16_f32 v88, v32, v33
v_exp_f32 v36, v36
ds_read_b64_tr_b16 a[104:105], v5 offset:15360
ds_read_b64_tr_b16 a[106:107], v5 offset:15616
v_mfma_f32_32x32x16_bf16 v[96:111], a[100:103], v[84:87], v[96:111]
v_exp_f32 v37, v37
v_cvt_pk_bf16_f32 v89, v34, v35
v_exp_f32 v38, v38
ds_read_b64_tr_b16 a[108:109], v5 offset:15872
ds_read_b64_tr_b16 a[110:111], v5 offset:16128
v_mfma_f32_32x32x8bf16_1k v[16:31], a[12:13], v[238:239], v[16:31]
v_exp_f32 v39, v39
v_cvt_pk_bf16_f32 v90, v36, v37
v_exp_f32 v40, v40
ds_read_b128 a[0:3], v6 offset:8704
ds_read_b64 a[4:5], v7 offset:7680
s_mov_b32 m0, s42
s_add_u32 s42, s42, 4096
buffer_load_dwordx4 v2, s[44:47], s43 offen sc1 lds
s_add_u32 s43, s43, 4096
v_exp_f32 v41, v41
v_cvt_pk_bf16_f32 v91, v38, v39
v_exp_f32 v42, v42
v_exp_f32 v43, v43
v_cvt_pk_bf16_f32 v92, v40, v41
v_exp_f32 v44, v44
v_exp_f32 v45, v45
v_cvt_pk_bf16_f32 v93, v42, v43
v_exp_f32 v46, v46
v_exp_f32 v47, v47
v_cvt_pk_bf16_f32 v94, v44, v45
v_cvt_pk_bf16_f32 v95, v46, v47
s_cmp_gt_u32 s13, 4
s_cbranch_scc1 L_ff1_36
s_waitcnt lgkmcnt(0)
v_mfma_f32_32x32x16_bf16 v[96:111], a[104:107], v[88:91], v[96:111]
v_exp_f32 v16, v16
v_exp_f32 v17, v17
v_exp_f32 v18, v18
v_mfma_f32_32x32x16_bf16 v[32:47], a[0:3], v[232:235], 0
v_exp_f32 v19, v19
v_cvt_pk_bf16_f32 v80, v16, v17
v_exp_f32 v20, v20
ds_read_b64_tr_b16 a[96:97], v5 offset:12288
ds_read_b64_tr_b16 a[98:99], v5 offset:12544
v_mfma_f32_32x32x16_bf16 v[96:111], a[108:111], v[92:95], v[96:111]
v_exp_f32 v21, v21
v_cvt_pk_bf16_f32 v81, v18, v19
v_exp_f32 v22, v22
ds_read_b64_tr_b16 a[100:101], v5 offset:12800
ds_read_b64_tr_b16 a[102:103], v5 offset:13056
v_mfma_f32_32x32x8bf16_1k v[32:47], a[4:5], v[238:239], v[32:47]
v_exp_f32 v23, v23
v_cvt_pk_bf16_f32 v82, v20, v21
v_exp_f32 v24, v24
ds_read_b128 a[16:19], v6 offset:6144
ds_read_b64 a[20:21], v7 offset:5120
s_mov_b32 m0, s42
s_add_u32 s42, s42, 4096
buffer_load_dwordx4 v2, s[44:47], s43 offen sc1 lds
s_add_u32 s43, s43, 4096
v_exp_f32 v25, v25
v_cvt_pk_bf16_f32 v83, v22, v23
v_exp_f32 v26, v26
v_exp_f32 v27, v27
v_cvt_pk_bf16_f32 v84, v24, v25
v_exp_f32 v28, v28
v_exp_f32 v29, v29
v_cvt_pk_bf16_f32 v85, v26, v27
v_exp_f32 v30, v30
v_exp_f32 v31, v31
v_cvt_pk_bf16_f32 v86, v28, v29
v_cvt_pk_bf16_f32 v87, v30, v31
s_cmp_gt_u32 s13, 3
s_cbranch_scc1 L_ff0_35
s_waitcnt lgkmcnt(0)
v_mfma_f32_32x32x16_bf16 v[96:111], a[96:99], v[80:83], v[96:111]
v_exp_f32 v32, v32
v_exp_f32 v33, v33
v_exp_f32 v34, v34
v_mfma_f32_32x32x16_bf16 v[16:31], a[16:19], v[232:235], 0
v_exp_f32 v35, v35
v_cvt_pk_bf16_f32 v88, v32, v33
v_exp_f32 v36, v36
ds_read_b64_tr_b16 a[104:105], v5 offset:9216
ds_read_b64_tr_b16 a[106:107], v5 offset:9472
v_mfma_f32_32x32x16_bf16 v[96:111], a[100:103], v[84:87], v[96:111]
v_exp_f32 v37, v37
v_cvt_pk_bf16_f32 v89, v34, v35
v_exp_f32 v38, v38
ds_read_b64_tr_b16 a[108:109], v5 offset:9728
ds_read_b64_tr_b16 a[110:111], v5 offset:9984
v_mfma_f32_32x32x8bf16_1k v[16:31], a[20:21], v[238:239], v[16:31]
v_exp_f32 v39, v39
v_cvt_pk_bf16_f32 v90, v36, v37
v_exp_f32 v40, v40
ds_read_b128 a[8:11], v6 offset:3584
ds_read_b64 a[12:13], v7 offset:2560
s_mov_b32 m0, s42
s_add_u32 s42, s42, 4096
buffer_load_dwordx4 v2, s[44:47], s43 offen sc1 lds
s_add_u32 s43, s43, 4096
v_exp_f32 v41, v41
v_cvt_pk_bf16_f32 v91, v38, v39
v_exp_f32 v42, v42
v_exp_f32 v43, v43
v_cvt_pk_bf16_f32 v92, v40, v41
v_exp_f32 v44, v44
v_exp_f32 v45, v45
v_cvt_pk_bf16_f32 v93, v42, v43
v_exp_f32 v46, v46
v_exp_f32 v47, v47
v_cvt_pk_bf16_f32 v94, v44, v45
v_cvt_pk_bf16_f32 v95, v46, v47
s_cmp_gt_u32 s13, 2
s_cbranch_scc1 L_ff1_36
s_waitcnt lgkmcnt(0)
v_mfma_f32_32x32x16_bf16 v[96:111], a[104:107], v[88:91], v[96:111]
v_exp_f32 v16, v16
v_exp_f32 v17, v17
v_exp_f32 v18, v18
v_mfma_f32_32x32x16_bf16 v[32:47], a[8:11], v[232:235], 0
v_exp_f32 v19, v19
v_cvt_pk_bf16_f32 v80, v16, v17
v_exp_f32 v20, v20
ds_read_b64_tr_b16 a[96:97], v5 offset:6144
ds_read_b64_tr_b16 a[98:99], v5 offset:6400
v_mfma_f32_32x32x16_bf16 v[96:111], a[108:111], v[92:95], v[96:111]
v_exp_f32 v21, v21
v_cvt_pk_bf16_f32 v81, v18, v19
v_exp_f32 v22, v22
ds_read_b64_tr_b16 a[100:101], v5 offset:6656
ds_read_b64_tr_b16 a[102:103], v5 offset:6912
v_mfma_f32_32x32x8bf16_1k v[32:47], a[12:13], v[238:239], v[32:47]
v_exp_f32 v23, v23
v_cvt_pk_bf16_f32 v82, v20, v21
v_exp_f32 v24, v24
ds_read_b128 a[0:3], v6 offset:1024
ds_read_b64 a[4:5], v7 offset:0
s_mov_b32 m0, s42
s_add_u32 s42, s42, 4096
buffer_load_dwordx4 v2, s[44:47], s43 offen sc1 lds
s_add_u32 s43, s43, 4096
v_exp_f32 v25, v25
v_cvt_pk_bf16_f32 v83, v22, v23
v_exp_f32 v26, v26
v_exp_f32 v27, v27
v_cvt_pk_bf16_f32 v84, v24, v25
v_exp_f32 v28, v28
v_exp_f32 v29, v29
v_cvt_pk_bf16_f32 v85, v26, v27
v_exp_f32 v30, v30
v_exp_f32 v31, v31
v_cvt_pk_bf16_f32 v86, v28, v29
v_cvt_pk_bf16_f32 v87, v30, v31
s_cmp_gt_u32 s13, 1
s_cbranch_scc1 L_ff0_35
s_waitcnt lgkmcnt(0)
v_mfma_f32_32x32x16_bf16 v[96:111], a[96:99], v[80:83], v[96:111]
v_exp_f32 v32, v32
v_exp_f32 v33, v33
v_exp_f32 v34, v34
v_mfma_f32_32x32x16_bf16 v[16:31], a[0:3], v[232:235], v[148:163]
v_exp_f32 v35, v35
v_cvt_pk_bf16_f32 v88, v32, v33
v_exp_f32 v36, v36
ds_read_b64_tr_b16 a[104:105], v5 offset:3072
ds_read_b64_tr_b16 a[106:107], v5 offset:3328
v_mfma_f32_32x32x16_bf16 v[96:111], a[100:103], v[84:87], v[96:111]
v_exp_f32 v37, v37
v_cvt_pk_bf16_f32 v89, v34, v35
v_exp_f32 v38, v38
ds_read_b64_tr_b16 a[108:109], v5 offset:3584
ds_read_b64_tr_b16 a[110:111], v5 offset:3840
v_mfma_f32_32x32x8bf16_1k v[16:31], a[4:5], v[238:239], v[16:31]
v_exp_f32 v39, v39
v_cvt_pk_bf16_f32 v90, v36, v37
v_exp_f32 v40, v40
s_mov_b32 m0, s42
s_add_u32 s42, s42, 4096
buffer_load_dwordx4 v2, s[44:47], s43 offen sc1 lds
s_add_u32 s43, s43, 4096
v_exp_f32 v41, v41
v_cvt_pk_bf16_f32 v91, v38, v39
v_exp_f32 v42, v42
v_exp_f32 v43, v43
v_cvt_pk_bf16_f32 v92, v40, v41
v_exp_f32 v44, v44
v_exp_f32 v45, v45
v_cvt_pk_bf16_f32 v93, v42, v43
v_exp_f32 v46, v46
v_exp_f32 v47, v47
v_cvt_pk_bf16_f32 v94, v44, v45
v_cvt_pk_bf16_f32 v95, v46, v47
s_cmp_gt_u32 s13, 0
s_cbranch_scc1 L_ff1_36
s_waitcnt lgkmcnt(0)
v_mfma_f32_32x32x16_bf16 v[96:111], a[104:107], v[88:91], v[96:111]
v_exp_f32 v16, v16
v_exp_f32 v17, v17
v_exp_f32 v18, v18
v_mfma_f32_32x32x16_bf16 v[96:111], a[108:111], v[92:95], v[96:111]
v_exp_f32 v19, v19
v_cvt_pk_bf16_f32 v80, v16, v17
v_exp_f32 v20, v20
ds_read_b64_tr_b16 a[96:97], v5 offset:0
ds_read_b64_tr_b16 a[98:99], v5 offset:256
ds_read_b64_tr_b16 a[100:101], v5 offset:512
ds_read_b64_tr_b16 a[102:103], v5 offset:768
s_mov_b32 m0, s42
s_add_u32 s42, s42, 4096
buffer_load_dwordx4 v2, s[44:47], s43 offen sc1 lds
s_add_u32 s43, s43, 4096
v_exp_f32 v21, v21
v_cvt_pk_bf16_f32 v81, v18, v19
v_exp_f32 v22, v22
v_exp_f32 v23, v23
v_cvt_pk_bf16_f32 v82, v20, v21
v_exp_f32 v24, v24
v_exp_f32 v25, v25
v_cvt_pk_bf16_f32 v83, v22, v23
v_exp_f32 v26, v26
v_exp_f32 v27, v27
v_cvt_pk_bf16_f32 v84, v24, v25
v_exp_f32 v28, v28
v_exp_f32 v29, v29
v_cvt_pk_bf16_f32 v85, v26, v27
v_exp_f32 v30, v30
v_exp_f32 v31, v31
v_cvt_pk_bf16_f32 v86, v28, v29
v_cvt_pk_bf16_f32 v87, v30, v31
L_ff0_35:
s_waitcnt lgkmcnt(0)
v_mfma_f32_32x32x16_bf16 v[96:111], a[96:99], v[80:83], v[96:111]
v_mfma_f32_32x32x16_bf16 v[96:111], a[100:103], v[84:87], v[96:111]
s_branch L_fe_34
L_ff1_36:
s_waitcnt lgkmcnt(0)
v_mfma_f32_32x32x16_bf16 v[96:111], a[104:107], v[88:91], v[96:111]
v_mfma_f32_32x32x16_bf16 v[96:111], a[108:111], v[92:95], v[96:111]
s_branch L_fe_34
L_ffirst_37:
s_waitcnt lgkmcnt(0)
s_nop 7
v_mfma_f32_32x32x16_bf16 v[96:111], a[96:99], v[80:83], 0
v_mfma_f32_32x32x16_bf16 v[96:111], a[100:103], v[84:87], v[96:111]
L_fe_34:
s_nop 7
s_nop 7
v_mov_b32 v8, v96
v_mov_b32 v9, v96
s_nop 1
v_permlane32_swap_b32 v8, v9
v_mov_b32 v10, 0x2b800000
v_mov_b32 v11, 0x53800000
v_cmp_nle_f32 vcc, v10, v8
v_cmp_nle_f32 s[66:67], v8, v11
s_nop 3
s_or_b64 vcc, vcc, s[66:67]
s_cmp_eq_u64 vcc, 0
s_cbranch_scc0 L_slow_32
L_norm_33:
v_rcp_f32 v8, v8
s_nop 0
v_mul_f32 v96, v8, v96
v_mul_f32 v97, v8, v97
v_mul_f32 v98, v8, v98
v_mul_f32 v99, v8, v99
v_mul_f32 v100, v8, v100
v_mul_f32 v101, v8, v101
v_mul_f32 v102, v8, v102
v_mul_f32 v103, v8, v103
v_mul_f32 v104, v8, v104
v_mul_f32 v105, v8, v105
v_mul_f32 v106, v8, v106
v_mul_f32 v107, v8, v107
v_cvt_pk_bf16_f32 v126, v96, v97
v_cvt_pk_bf16_f32 v127, v98, v99
v_cvt_pk_bf16_f32 v128, v100, v101
v_cvt_pk_bf16_f32 v129, v102, v103
v_cvt_pk_bf16_f32 v130, v104, v105
v_cvt_pk_bf16_f32 v131, v106, v107
L_wo1c_38:
s_cmp_ge_u32 s42, s65
s_cbranch_scc1 L_wo1d_39
s_mov_b32 m0, s42
s_add_u32 s42, s42, 4096
buffer_load_dwordx4 v2, s[44:47], s43 offen sc1 lds
s_add_u32 s43, s43, 4096
s_branch L_wo1c_38
L_wo1d_39:
v_lshrrev_b32 v9, 5, v1
v_cmp_eq_u32 vcc, 1, v9
v_and_b32 v10, 15, v1
v_bfe_u32 v11, v1, 4, 1
v_cndmask_b32 v124, v124, v126, vcc
v_cndmask_b32 v125, v125, v127, vcc
s_lshl_b32 s14, s12, 1
v_add_u32 v11, s14, v11
v_mul_u32_u24 v11, 20480, v11
v_lshl_add_u32 v11, v10, 4, v11
v_lshl_add_u32 v12, v9, 8, v11
s_lshl_b32 s14, s6, 10
s_add_u32 s14, s14, 0xa00000
buffer_store_dwordx4 v[120:123], v12, s[44:47], s14 offen sc1
buffer_store_dwordx4 v[128:131], v12, s[44:47], s14 offen offset:512 sc1
s_and_b32 s15, s6, 1
v_xor_b32 v9, s15, v9
v_lshl_add_u32 v11, v9, 3, v11
s_lshr_b32 s14, s6, 2
s_add_u32 s14, s14, 16
s_lshl_b32 s14, s14, 10
s_and_b32 s15, s6, 3
s_lshl_b32 s15, s15, 8
s_add_u32 s14, s14, s15
s_add_u32 s14, s14, 0xa00000
buffer_store_dwordx2 v[124:125], v11, s[44:47], s14 offen sc1
s_waitcnt vmcnt(0)
s_barrier
s_lshl_b32 s12, s6, 4
s_add_u32 s12, s12, s7
s_cmp_lg_u32 s4, 0
s_cbranch_scc1 L_fs_40
s_lshl_b32 s64, s12, 7
s_add_u32 s64, s64, 0x10000
v_mov_b32 v252, s5
v_mov_b32 v253, 0
s_mov_b64 exec, 1
buffer_store_dword v252, v253, s[44:47], s64 offen sc1
s_mov_b64 exec, -1
L_fs_40:
s_cmp_lg_u32 s4, 3
s_cbranch_scc1 L_ct_41
s_lshl_b32 s64, s3, 4
v_and_b32 v249, 15, v1
v_add_u32 v249, s64, v249
v_lshlrev_b32 v249, 7, v249
v_min_u32 v249, L_code_end-L_code_begin-4, v249
global_load_dword v249, v249, s[22:23]
L_ct_41:
v_lshlrev_b32 v2, 4, v1
s_lshl_b32 s77, s4, 10
s_mul_i32 s76, s9, 102400
s_add_u32 s76, s76, 0x2400000
s_add_u32 s76, s76, s77
s_mul_i32 s78, s11, 122880
s_add_u32 s78, s78, 0x2600000
s_add_u32 s78, s78, s77
s_add_u32 m0, s77, 81920
s_add_u32 s79, s76, 81920
buffer_load_dwordx4 v2, s[44:47], s79 offen sc1 lds
s_add_u32 m0, s77, 86016
s_add_u32 s79, s76, 86016
buffer_load_dwordx4 v2, s[44:47], s79 offen sc1 lds
s_add_u32 m0, s77, 90112
s_add_u32 s79, s76, 90112
buffer_load_dwordx4 v2, s[44:47], s79 offen sc1 lds
s_add_u32 m0, s77, 94208
s_add_u32 s79, s76, 94208
buffer_load_dwordx4 v2, s[44:47], s79 offen sc1 lds
s_add_u32 m0, s77, 98304
s_add_u32 s79, s76, 98304
buffer_load_dwordx4 v2, s[44:47], s79 offen sc1 lds
v_and_b32 v8, 15, v1
v_lshlrev_b32 v8, 4, v8
s_lshr_b32 s12, s8, 1
v_add_u32 v8, s12, v8
v_lshlrev_b32 v8, 7, v8
v_add_u32 v14, 0x10000, v8
s_and_b32 s12, s4, 1
s_lshl_b32 s12, s12, 1
s_lshl_b32 s13, s8, 2
s_add_u32 s12, s12, s13
s_lshr_b32 s13, s4, 1
s_add_u32 s42, s12, s13
s_xor_b32 s13, s13, 1
s_add_u32 s43, s12, s13
s_mov_b32 s48, s16
s_mov_b32 s49, s17
s_mov_b32 s50, 0x280000
s_mov_b32 s51, 0x00020000
v_and_b32 v8, 15, v1
s_lshl_b32 s12, s42, 4
v_add_u32 v8, s12, v8
v_mul_u32_u24 v8, 1280, v8
v_lshrrev_b32 v9, 4, v1
v_lshl_add_u32 v15, v9, 3, v8
s_mul_i32 s12, s9, 160
buffer_load_dwordx2 v[104:105], v15, s[48:51], s12 offen offset:0
buffer_load_dwordx2 v[106:107], v15, s[48:51], s12 offen offset:32
buffer_load_dwordx2 v[108:109], v15, s[48:51], s12 offen offset:64
buffer_load_dwordx2 v[110:111], v15, s[48:51], s12 offen offset:96
buffer_load_dwordx2 v[112:113], v15, s[48:51], s12 offen offset:128
s_add_u32 m0, s77, 104448
s_add_u32 s79, s78, 73728
buffer_load_dwordx4 v2, s[44:47], s79 offen sc1 lds
s_add_u32 m0, s77, 108544
s_add_u32 s79, s78, 77824
buffer_load_dwordx4 v2, s[44:47], s79 offen sc1 lds
s_add_u32 m0, s77, 112640
s_add_u32 s79, s78, 81920
buffer_load_dwordx4 v2, s[44:47], s79 offen sc1 lds
s_add_u32 m0, s77, 116736
s_add_u32 s79, s78, 86016
buffer_load_dwordx4 v2, s[44:47], s79 offen sc1 lds
s_add_u32 m0, s77, 120832
s_add_u32 s79, s78, 90112
buffer_load_dwordx4 v2, s[44:47], s79 offen sc1 lds
s_add_u32 m0, s77, 124928
s_add_u32 s79, s78, 94208
buffer_load_dwordx4 v2, s[44:47], s79 offen sc1 lds
s_add_u32 m0, s77, 129024
s_add_u32 s79, s78, 98304
buffer_load_dwordx4 v2, s[44:47], s79 offen sc1 lds
s_add_u32 m0, s77, 133120
s_add_u32 s79, s78, 102400
buffer_load_dwordx4 v2, s[44:47], s79 offen sc1 lds
s_add_u32 m0, s77, 137216
s_add_u32 s79, s78, 106496
buffer_load_dwordx4 v2, s[44:47], s79 offen sc1 lds
s_add_u32 m0, s77, 141312
s_add_u32 s79, s78, 110592
buffer_load_dwordx4 v2, s[44:47], s79 offen sc1 lds
s_add_u32 m0, s77, 145408
s_add_u32 s79, s78, 114688
buffer_load_dwordx4 v2, s[44:47], s79 offen sc1 lds
s_add_u32 m0, s77, 149504
s_add_u32 s79, s78, 118784
buffer_load_dwordx4 v2, s[44:47], s79 offen sc1 lds
s_lshr_b32 s13, s4, 1
s_mul_i32 s13, s13, 51200
v_add_u32 v4, s13, v2
s_cmp_lg_u32 s4, 0
s_cbranch_scc1 L_pd_43
s_mov_b32 s64, 0
L_pl_42:
buffer_load_dword v250, v14, s[44:47], 0 offen sc1
s_add_u32 s64, s64, 1
s_cmp_gt_u32 s64, 1048576
s_cbranch_scc1 L_pd_43
s_waitcnt vmcnt(0)
v_cmp_ne_u32 vcc, s5, v250
s_nop 3
s_cmp_eq_u64 vcc, 0
s_cbranch_scc1 L_pd_43
s_branch L_pl_42
L_pd_43:
s_waitcnt vmcnt(17) lgkmcnt(0)
s_barrier
s_lshr_b32 s13, s4, 1
s_mul_i32 s12, s42, 20480
s_add_u32 s12, s12, 0xa00000
s_mul_i32 s14, s43, 20480
s_add_u32 s14, s14, 0xa00000
s_lshl_b32 s15, s13, 13
s_add_u32 s64, s12, s15
s_add_u32 s65, s14, s15
s_lshl_b32 s15, s13, 11
s_add_u32 s15, s15, 16384
s_add_u32 s12, s12, s15
s_add_u32 s14, s14, s15
buffer_load_dwordx4 a[0:3], v2, s[44:47], s64 offen offset:0 sc1
buffer_load_dwordx4 a[40:43], v2, s[44:47], s65 offen offset:0 sc1
buffer_load_dwordx4 a[4:7], v2, s[44:47], s64 offen offset:1024 sc1
buffer_load_dwordx4 a[44:47], v2, s[44:47], s65 offen offset:1024 sc1
buffer_load_dwordx4 a[8:11], v2, s[44:47], s64 offen offset:2048 sc1
buffer_load_dwordx4 a[48:51], v2, s[44:47], s65 offen offset:2048 sc1
buffer_load_dwordx4 a[12:15], v2, s[44:47], s64 offen offset:3072 sc1
buffer_load_dwordx4 a[52:55], v2, s[44:47], s65 offen offset:3072 sc1
s_add_u32 s64, s64, 4096
buffer_load_dwordx4 a[16:19], v2, s[44:47], s64 offen offset:0 sc1
s_add_u32 s65, s65, 4096
buffer_load_dwordx4 a[56:59], v2, s[44:47], s65 offen offset:0 sc1
buffer_load_dwordx4 a[20:23], v2, s[44:47], s64 offen offset:1024 sc1
buffer_load_dwordx4 a[60:63], v2, s[44:47], s65 offen offset:1024 sc1
buffer_load_dwordx4 a[24:27], v2, s[44:47], s64 offen offset:2048 sc1
buffer_load_dwordx4 a[64:67], v2, s[44:47], s65 offen offset:2048 sc1
buffer_load_dwordx4 a[28:31], v2, s[44:47], s64 offen offset:3072 sc1
buffer_load_dwordx4 a[68:71], v2, s[44:47], s65 offen offset:3072 sc1
buffer_load_dwordx4 a[32:35], v2, s[44:47], s12 offen offset:0 sc1
buffer_load_dwordx4 a[72:75], v2, s[44:47], s14 offen offset:0 sc1
buffer_load_dwordx4 a[36:39], v2, s[44:47], s12 offen offset:1024 sc1
buffer_load_dwordx4 a[76:79], v2, s[44:47], s14 offen offset:1024 sc1
ds_read_b128 v[16:19], v4 offset:0
ds_read_b128 v[20:23], v4 offset:1024
ds_read_b128 v[24:27], v4 offset:2048
ds_read_b128 v[28:31], v4 offset:3072
ds_read_b128 v[32:35], v4 offset:4096
s_waitcnt vmcnt(18) lgkmcnt(0)
v_mfma_f32_16x16x32_bf16 v[64:67], v[16:19], a[0:3], 0
ds_read_b128 v[36:39], v4 offset:5120
v_mfma_f32_16x16x32_bf16 v[84:87], v[16:19], a[40:43], 0
ds_read_b128 v[40:43], v4 offset:6144
v_mfma_f32_16x16x32_bf16 v[68:71], v[20:23], a[0:3], 0
ds_read_b128 v[44:47], v4 offset:7168
v_mfma_f32_16x16x32_bf16 v[88:91], v[20:23], a[40:43], 0
ds_read_b128 v[48:51], v4 offset:8192
v_mfma_f32_16x16x32_bf16 v[72:75], v[24:27], a[0:3], 0
ds_read_b128 v[52:55], v4 offset:9216
v_mfma_f32_16x16x32_bf16 v[92:95], v[24:27], a[40:43], 0
v_mfma_f32_16x16x32_bf16 v[76:79], v[28:31], a[0:3], 0
v_mfma_f32_16x16x32_bf16 v[96:99], v[28:31], a[40:43], 0
v_mfma_f32_16x16x32_bf16 v[80:83], v[32:35], a[0:3], 0
v_mfma_f32_16x16x32_bf16 v[100:103], v[32:35], a[40:43], 0
s_waitcnt vmcnt(16) lgkmcnt(0)
v_mfma_f32_16x16x32_bf16 v[64:67], v[36:39], a[4:7], v[64:67]
ds_read_b128 v[16:19], v4 offset:10240
v_mfma_f32_16x16x32_bf16 v[84:87], v[36:39], a[44:47], v[84:87]
ds_read_b128 v[20:23], v4 offset:11264
v_mfma_f32_16x16x32_bf16 v[68:71], v[40:43], a[4:7], v[68:71]
ds_read_b128 v[24:27], v4 offset:12288
v_mfma_f32_16x16x32_bf16 v[88:91], v[40:43], a[44:47], v[88:91]
ds_read_b128 v[28:31], v4 offset:13312
v_mfma_f32_16x16x32_bf16 v[72:75], v[44:47], a[4:7], v[72:75]
ds_read_b128 v[32:35], v4 offset:14336
v_mfma_f32_16x16x32_bf16 v[92:95], v[44:47], a[44:47], v[92:95]
v_mfma_f32_16x16x32_bf16 v[76:79], v[48:51], a[4:7], v[76:79]
v_mfma_f32_16x16x32_bf16 v[96:99], v[48:51], a[44:47], v[96:99]
v_mfma_f32_16x16x32_bf16 v[80:83], v[52:55], a[4:7], v[80:83]
v_mfma_f32_16x16x32_bf16 v[100:103], v[52:55], a[44:47], v[100:103]
s_waitcnt vmcnt(14) lgkmcnt(0)
v_mfma_f32_16x16x32_bf16 v[64:67], v[16:19], a[8:11], v[64:67]
ds_read_b128 v[36:39], v4 offset:15360
v_mfma_f32_16x16x32_bf16 v[84:87], v[16:19], a[48:51], v[84:87]
ds_read_b128 v[40:43], v4 offset:16384
v_mfma_f32_16x16x32_bf16 v[68:71], v[20:23], a[8:11], v[68:71]
ds_read_b128 v[44:47], v4 offset:17408
v_mfma_f32_16x16x32_bf16 v[88:91], v[20:23], a[48:51], v[88:91]
ds_read_b128 v[48:51], v4 offset:18432
v_mfma_f32_16x16x32_bf16 v[72:75], v[24:27], a[8:11], v[72:75]
ds_read_b128 v[52:55], v4 offset:19456
v_mfma_f32_16x16x32_bf16 v[92:95], v[24:27], a[48:51], v[92:95]
v_mfma_f32_16x16x32_bf16 v[76:79], v[28:31], a[8:11], v[76:79]
v_mfma_f32_16x16x32_bf16 v[96:99], v[28:31], a[48:51], v[96:99]
v_mfma_f32_16x16x32_bf16 v[80:83], v[32:35], a[8:11], v[80:83]
v_mfma_f32_16x16x32_bf16 v[100:103], v[32:35], a[48:51], v[100:103]
s_waitcnt vmcnt(12) lgkmcnt(0)
v_mfma_f32_16x16x32_bf16 v[64:67], v[36:39], a[12:15], v[64:67]
ds_read_b128 v[16:19], v4 offset:20480
v_mfma_f32_16x16x32_bf16 v[84:87], v[36:39], a[52:55], v[84:87]
ds_read_b128 v[20:23], v4 offset:21504
v_mfma_f32_16x16x32_bf16 v[68:71], v[40:43], a[12:15], v[68:71]
ds_read_b128 v[24:27], v4 offset:22528
v_mfma_f32_16x16x32_bf16 v[88:91], v[40:43], a[52:55], v[88:91]
ds_read_b128 v[28:31], v4 offset:23552
v_mfma_f32_16x16x32_bf16 v[72:75], v[44:47], a[12:15], v[72:75]
ds_read_b128 v[32:35], v4 offset:24576
v_mfma_f32_16x16x32_bf16 v[92:95], v[44:47], a[52:55], v[92:95]
v_mfma_f32_16x16x32_bf16 v[76:79], v[48:51], a[12:15], v[76:79]
v_mfma_f32_16x16x32_bf16 v[96:99], v[48:51], a[52:55], v[96:99]
v_mfma_f32_16x16x32_bf16 v[80:83], v[52:55], a[12:15], v[80:83]
v_mfma_f32_16x16x32_bf16 v[100:103], v[52:55], a[52:55], v[100:103]
s_waitcnt vmcnt(10) lgkmcnt(0)
v_mfma_f32_16x16x32_bf16 v[64:67], v[16:19], a[16:19], v[64:67]
ds_read_b128 v[36:39], v4 offset:25600
v_mfma_f32_16x16x32_bf16 v[84:87], v[16:19], a[56:59], v[84:87]
ds_read_b128 v[40:43], v4 offset:26624
v_mfma_f32_16x16x32_bf16 v[68:71], v[20:23], a[16:19], v[68:71]
ds_read_b128 v[44:47], v4 offset:27648
v_mfma_f32_16x16x32_bf16 v[88:91], v[20:23], a[56:59], v[88:91]
ds_read_b128 v[48:51], v4 offset:28672
v_mfma_f32_16x16x32_bf16 v[72:75], v[24:27], a[16:19], v[72:75]
ds_read_b128 v[52:55], v4 offset:29696
v_mfma_f32_16x16x32_bf16 v[92:95], v[24:27], a[56:59], v[92:95]
v_mfma_f32_16x16x32_bf16 v[76:79], v[28:31], a[16:19], v[76:79]
v_mfma_f32_16x16x32_bf16 v[96:99], v[28:31], a[56:59], v[96:99]
v_mfma_f32_16x16x32_bf16 v[80:83], v[32:35], a[16:19], v[80:83]
v_mfma_f32_16x16x32_bf16 v[100:103], v[32:35], a[56:59], v[100:103]
s_waitcnt vmcnt(8) lgkmcnt(0)
v_mfma_f32_16x16x32_bf16 v[64:67], v[36:39], a[20:23], v[64:67]
ds_read_b128 v[16:19], v4 offset:30720
v_mfma_f32_16x16x32_bf16 v[84:87], v[36:39], a[60:63], v[84:87]
ds_read_b128 v[20:23], v4 offset:31744
v_mfma_f32_16x16x32_bf16 v[68:71], v[40:43], a[20:23], v[68:71]
ds_read_b128 v[24:27], v4 offset:32768
v_mfma_f32_16x16x32_bf16 v[88:91], v[40:43], a[60:63], v[88:91]
ds_read_b128 v[28:31], v4 offset:33792
v_mfma_f32_16x16x32_bf16 v[72:75], v[44:47], a[20:23], v[72:75]
ds_read_b128 v[32:35], v4 offset:34816
v_mfma_f32_16x16x32_bf16 v[92:95], v[44:47], a[60:63], v[92:95]
v_mfma_f32_16x16x32_bf16 v[76:79], v[48:51], a[20:23], v[76:79]
v_mfma_f32_16x16x32_bf16 v[96:99], v[48:51], a[60:63], v[96:99]
v_mfma_f32_16x16x32_bf16 v[80:83], v[52:55], a[20:23], v[80:83]
v_mfma_f32_16x16x32_bf16 v[100:103], v[52:55], a[60:63], v[100:103]
s_waitcnt vmcnt(6) lgkmcnt(0)
v_mfma_f32_16x16x32_bf16 v[64:67], v[16:19], a[24:27], v[64:67]
ds_read_b128 v[36:39], v4 offset:35840
v_mfma_f32_16x16x32_bf16 v[84:87], v[16:19], a[64:67], v[84:87]
ds_read_b128 v[40:43], v4 offset:36864
v_mfma_f32_16x16x32_bf16 v[68:71], v[20:23], a[24:27], v[68:71]
ds_read_b128 v[44:47], v4 offset:37888
v_mfma_f32_16x16x32_bf16 v[88:91], v[20:23], a[64:67], v[88:91]
ds_read_b128 v[48:51], v4 offset:38912
v_mfma_f32_16x16x32_bf16 v[72:75], v[24:27], a[24:27], v[72:75]
ds_read_b128 v[52:55], v4 offset:39936
v_mfma_f32_16x16x32_bf16 v[92:95], v[24:27], a[64:67], v[92:95]
v_mfma_f32_16x16x32_bf16 v[76:79], v[28:31], a[24:27], v[76:79]
v_mfma_f32_16x16x32_bf16 v[96:99], v[28:31], a[64:67], v[96:99]
v_mfma_f32_16x16x32_bf16 v[80:83], v[32:35], a[24:27], v[80:83]
v_mfma_f32_16x16x32_bf16 v[100:103], v[32:35], a[64:67], v[100:103]
s_waitcnt vmcnt(4) lgkmcnt(0)
v_mfma_f32_16x16x32_bf16 v[64:67], v[36:39], a[28:31], v[64:67]
ds_read_b128 v[16:19], v4 offset:40960
v_mfma_f32_16x16x32_bf16 v[84:87], v[36:39], a[68:71], v[84:87]
ds_read_b128 v[20:23], v4 offset:41984
v_mfma_f32_16x16x32_bf16 v[68:71], v[40:43], a[28:31], v[68:71]
ds_read_b128 v[24:27], v4 offset:43008
v_mfma_f32_16x16x32_bf16 v[88:91], v[40:43], a[68:71], v[88:91]
ds_read_b128 v[28:31], v4 offset:44032
v_mfma_f32_16x16x32_bf16 v[72:75], v[44:47], a[28:31], v[72:75]
ds_read_b128 v[32:35], v4 offset:45056
v_mfma_f32_16x16x32_bf16 v[92:95], v[44:47], a[68:71], v[92:95]
v_mfma_f32_16x16x32_bf16 v[76:79], v[48:51], a[28:31], v[76:79]
v_mfma_f32_16x16x32_bf16 v[96:99], v[48:51], a[68:71], v[96:99]
v_mfma_f32_16x16x32_bf16 v[80:83], v[52:55], a[28:31], v[80:83]
v_mfma_f32_16x16x32_bf16 v[100:103], v[52:55], a[68:71], v[100:103]
s_waitcnt vmcnt(2) lgkmcnt(0)
v_mfma_f32_16x16x32_bf16 v[64:67], v[16:19], a[32:35], v[64:67]
ds_read_b128 v[36:39], v4 offset:46080
v_mfma_f32_16x16x32_bf16 v[84:87], v[16:19], a[72:75], v[84:87]
ds_read_b128 v[40:43], v4 offset:47104
v_mfma_f32_16x16x32_bf16 v[68:71], v[20:23], a[32:35], v[68:71]
ds_read_b128 v[44:47], v4 offset:48128
v_mfma_f32_16x16x32_bf16 v[88:91], v[20:23], a[72:75], v[88:91]
ds_read_b128 v[48:51], v4 offset:49152
v_mfma_f32_16x16x32_bf16 v[72:75], v[24:27], a[32:35], v[72:75]
ds_read_b128 v[52:55], v4 offset:50176
v_mfma_f32_16x16x32_bf16 v[92:95], v[24:27], a[72:75], v[92:95]
v_mfma_f32_16x16x32_bf16 v[76:79], v[28:31], a[32:35], v[76:79]
v_mfma_f32_16x16x32_bf16 v[96:99], v[28:31], a[72:75], v[96:99]
v_mfma_f32_16x16x32_bf16 v[80:83], v[32:35], a[32:35], v[80:83]
v_mfma_f32_16x16x32_bf16 v[100:103], v[32:35], a[72:75], v[100:103]
s_waitcnt vmcnt(0) lgkmcnt(0)
v_mfma_f32_16x16x32_bf16 v[64:67], v[36:39], a[36:39], v[64:67]
v_mfma_f32_16x16x32_bf16 v[84:87], v[36:39], a[76:79], v[84:87]
v_mfma_f32_16x16x32_bf16 v[68:71], v[40:43], a[36:39], v[68:71]
v_mfma_f32_16x16x32_bf16 v[88:91], v[40:43], a[76:79], v[88:91]
v_mfma_f32_16x16x32_bf16 v[72:75], v[44:47], a[36:39], v[72:75]
v_mfma_f32_16x16x32_bf16 v[92:95], v[44:47], a[76:79], v[92:95]
v_mfma_f32_16x16x32_bf16 v[76:79], v[48:51], a[36:39], v[76:79]
v_mfma_f32_16x16x32_bf16 v[96:99], v[48:51], a[76:79], v[96:99]
v_mfma_f32_16x16x32_bf16 v[80:83], v[52:55], a[36:39], v[80:83]
v_mfma_f32_16x16x32_bf16 v[100:103], v[52:55], a[76:79], v[100:103]
s_mul_i32 s12, s4, 5120
s_add_u32 s12, s12, 0
v_add_u32 v8, s12, v2
s_xor_b32 s12, s4, 2
s_mul_i32 s12, s12, 5120
s_add_u32 s12, s12, 0
v_add_u32 v9, s12, v2
v_lshrrev_b32 v10, 4, v1
v_lshlrev_b32 v11, 4, v10
v_add_u32 v11, 153600, v11
v_lshlrev_b32 v12, 3, v10
s_mul_i32 s12, s9, 160
s_add_u32 s12, s12, 155264
v_add_u32 v12, s12, v12
s_barrier
ds_write_b128 v8, v[84:87] offset:0
ds_write_b128 v8, v[88:91] offset:1024
ds_write_b128 v8, v[92:95] offset:2048
ds_write_b128 v8, v[96:99] offset:3072
ds_write_b128 v8, v[100:103] offset:4096
ds_read_b128 v[36:39], v11 offset:0
ds_read_b128 v[40:43], v11 offset:64
ds_read_b128 v[44:47], v11 offset:128
ds_read_b128 v[48:51], v11 offset:192
ds_read_b128 v[52:55], v11 offset:256
ds_read_b128 v[132:135], v11 offset:320
ds_read_b128 v[136:139], v11 offset:384
ds_read_b128 v[140:143], v11 offset:448
ds_read_b128 v[144:147], v11 offset:512
ds_read_b128 v[148:151], v11 offset:576
s_waitcnt lgkmcnt(10)
s_barrier
ds_read_b128 v[16:19], v9 offset:0
ds_read_b128 v[20:23], v9 offset:1024
ds_read_b128 v[24:27], v9 offset:2048
ds_read_b128 v[28:31], v9 offset:3072
ds_read_b128 v[32:35], v9 offset:4096
ds_read_b64 v[152:153], v12 offset:0
ds_read_b64 v[162:163], v12 offset:1280
ds_read_b64 v[154:155], v12 offset:32
ds_read_b64 v[164:165], v12 offset:1312
ds_read_b64 v[156:157], v12 offset:64
ds_read_b64 v[166:167], v12 offset:1344
ds_read_b64 v[158:159], v12 offset:96
ds_read_b64 v[168:169], v12 offset:1376
ds_read_b64 v[160:161], v12 offset:128
ds_read_b64 v[170:171], v12 offset:1408
s_waitcnt lgkmcnt(15)
v_lshlrev_b32 v172, 16, v104
v_and_b32 v173, 0xffff0000, v104
v_fmac_f32 v172, v36, v64
v_fmac_f32 v173, v37, v65
v_lshlrev_b32 v174, 16, v105
v_and_b32 v175, 0xffff0000, v105
v_fmac_f32 v174, v38, v66
v_fmac_f32 v175, v39, v67
v_lshlrev_b32 v176, 16, v106
v_and_b32 v177, 0xffff0000, v106
v_fmac_f32 v176, v40, v68
v_fmac_f32 v177, v41, v69
v_lshlrev_b32 v178, 16, v107
v_and_b32 v179, 0xffff0000, v107
v_fmac_f32 v178, v42, v70
v_fmac_f32 v179, v43, v71
v_lshlrev_b32 v180, 16, v108
v_and_b32 v181, 0xffff0000, v108
v_fmac_f32 v180, v44, v72
v_fmac_f32 v181, v45, v73
v_lshlrev_b32 v182, 16, v109
v_and_b32 v183, 0xffff0000, v109
v_fmac_f32 v182, v46, v74
v_fmac_f32 v183, v47, v75
v_lshlrev_b32 v184, 16, v110
v_and_b32 v185, 0xffff0000, v110
v_fmac_f32 v184, v48, v76
v_fmac_f32 v185, v49, v77
v_lshlrev_b32 v186, 16, v111
v_and_b32 v187, 0xffff0000, v111
v_fmac_f32 v186, v50, v78
v_fmac_f32 v187, v51, v79
v_lshlrev_b32 v188, 16, v112
v_and_b32 v189, 0xffff0000, v112
v_fmac_f32 v188, v52, v80
v_fmac_f32 v189, v53, v81
v_lshlrev_b32 v190, 16, v113
v_and_b32 v191, 0xffff0000, v113
v_fmac_f32 v190, v54, v82
v_fmac_f32 v191, v55, v83
s_waitcnt lgkmcnt(10)
v_fmac_f32 v172, v36, v16
v_fmac_f32 v173, v37, v17
v_cvt_pk_bf16_f32 v214, v172, v173
v_mul_f32 v172, v172, v132
v_mul_f32 v173, v173, v133
v_cvt_pk_bf16_f32 v84, v172, v173
v_fmac_f32 v174, v38, v18
v_fmac_f32 v175, v39, v19
v_cvt_pk_bf16_f32 v215, v174, v175
v_mul_f32 v174, v174, v134
v_mul_f32 v175, v175, v135
v_cvt_pk_bf16_f32 v85, v174, v175
v_fmac_f32 v176, v40, v20
v_fmac_f32 v177, v41, v21
v_cvt_pk_bf16_f32 v216, v176, v177
v_mul_f32 v176, v176, v136
v_mul_f32 v177, v177, v137
v_cvt_pk_bf16_f32 v86, v176, v177
v_fmac_f32 v178, v42, v22
v_fmac_f32 v179, v43, v23
v_cvt_pk_bf16_f32 v217, v178, v179
v_mul_f32 v178, v178, v138
v_mul_f32 v179, v179, v139
v_cvt_pk_bf16_f32 v87, v178, v179
v_fmac_f32 v180, v44, v24
v_fmac_f32 v181, v45, v25
v_cvt_pk_bf16_f32 v218, v180, v181
v_mul_f32 v180, v180, v140
v_mul_f32 v181, v181, v141
v_cvt_pk_bf16_f32 v88, v180, v181
v_fmac_f32 v182, v46, v26
v_fmac_f32 v183, v47, v27
v_cvt_pk_bf16_f32 v219, v182, v183
v_mul_f32 v182, v182, v142
v_mul_f32 v183, v183, v143
v_cvt_pk_bf16_f32 v89, v182, v183
v_fmac_f32 v184, v48, v28
v_fmac_f32 v185, v49, v29
v_cvt_pk_bf16_f32 v220, v184, v185
v_mul_f32 v184, v184, v144
v_mul_f32 v185, v185, v145
v_cvt_pk_bf16_f32 v90, v184, v185
v_fmac_f32 v186, v50, v30
v_fmac_f32 v187, v51, v31
v_cvt_pk_bf16_f32 v221, v186, v187
v_mul_f32 v186, v186, v146
v_mul_f32 v187, v187, v147
v_cvt_pk_bf16_f32 v91, v186, v187
v_fmac_f32 v188, v52, v32
v_fmac_f32 v189, v53, v33
v_cvt_pk_bf16_f32 v222, v188, v189
v_mul_f32 v188, v188, v148
v_mul_f32 v189, v189, v149
v_cvt_pk_bf16_f32 v92, v188, v189
v_fmac_f32 v190, v54, v34
v_fmac_f32 v191, v55, v35
v_cvt_pk_bf16_f32 v223, v190, v191
v_mul_f32 v190, v190, v150
v_mul_f32 v191, v191, v151
v_cvt_pk_bf16_f32 v93, v190, v191
s_lshr_b32 s12, s42, 1
s_and_b32 s13, s42, 1
s_lshl_b32 s13, s13, 4
v_and_b32 v8, 15, v1
v_add_u32 v8, s13, v8
v_lshrrev_b32 v13, 1, v10
v_and_b32 v14, 1, v10
v_lshlrev_b32 v15, 4, v8
v_lshl_add_u32 v56, v13, 10, v15
v_lshl_add_u32 v56, v14, 9, v56
v_lshl_add_u32 v57, v13, 9, v15
v_lshl_add_u32 v57, v14, 3, v57
s_mul_i32 s13, s12, 40
s_mul_i32 s14, s9, 5
s_add_u32 s13, s13, s14
s_lshl_b32 s13, s13, 10
s_add_u32 s13, s13, 0xd00000
buffer_store_dwordx4 v[84:87], v56, s[44:47], s13 offen sc1
buffer_store_dwordx4 v[88:91], v56, s[44:47], s13 offen offset:2048 sc1
s_add_u32 s13, s13, 4096
buffer_store_dwordx2 v[92:93], v57, s[44:47], s13 offen sc1
s_waitcnt lgkmcnt(0)
v_mov_b32 v58, 0x3f803f80
v_mov_b32 v96, 0
v_mov_b32 v97, 0
v_mov_b32 v98, 0
v_mov_b32 v99, 0
v_mov_b32 v100, 0
v_mov_b32 v101, 0
v_dot2_f32_bf16 v96, v214, v58, v96
v_dot2_f32_bf16 v97, v214, v214, v97
v_dot2_f32_bf16 v98, v84, v58, v98
v_dot2_f32_bf16 v99, v84, v84, v99
v_dot2_f32_bf16 v100, v84, v152, v100
v_dot2_f32_bf16 v101, v84, v162, v101
v_dot2_f32_bf16 v96, v215, v58, v96
v_dot2_f32_bf16 v97, v215, v215, v97
v_dot2_f32_bf16 v98, v85, v58, v98
v_dot2_f32_bf16 v99, v85, v85, v99
v_dot2_f32_bf16 v100, v85, v153, v100
v_dot2_f32_bf16 v101, v85, v163, v101
v_dot2_f32_bf16 v96, v216, v58, v96
v_dot2_f32_bf16 v97, v216, v216, v97
v_dot2_f32_bf16 v98, v86, v58, v98
v_dot2_f32_bf16 v99, v86, v86, v99
v_dot2_f32_bf16 v100, v86, v154, v100
v_dot2_f32_bf16 v101, v86, v164, v101
v_dot2_f32_bf16 v96, v217, v58, v96
v_dot2_f32_bf16 v97, v217, v217, v97
v_dot2_f32_bf16 v98, v87, v58, v98
v_dot2_f32_bf16 v99, v87, v87, v99
v_dot2_f32_bf16 v100, v87, v155, v100
v_dot2_f32_bf16 v101, v87, v165, v101
v_dot2_f32_bf16 v96, v218, v58, v96
v_dot2_f32_bf16 v97, v218, v218, v97
v_dot2_f32_bf16 v98, v88, v58, v98
v_dot2_f32_bf16 v99, v88, v88, v99
v_dot2_f32_bf16 v100, v88, v156, v100
v_dot2_f32_bf16 v101, v88, v166, v101
v_dot2_f32_bf16 v96, v219, v58, v96
v_dot2_f32_bf16 v97, v219, v219, v97
v_dot2_f32_bf16 v98, v89, v58, v98
v_dot2_f32_bf16 v99, v89, v89, v99
v_dot2_f32_bf16 v100, v89, v157, v100
v_dot2_f32_bf16 v101, v89, v167, v101
v_dot2_f32_bf16 v96, v220, v58, v96
v_dot2_f32_bf16 v97, v220, v220, v97
v_dot2_f32_bf16 v98, v90, v58, v98
v_dot2_f32_bf16 v99, v90, v90, v99
v_dot2_f32_bf16 v100, v90, v158, v100
v_dot2_f32_bf16 v101, v90, v168, v101
v_dot2_f32_bf16 v96, v221, v58, v96
v_dot2_f32_bf16 v97, v221, v221, v97
v_dot2_f32_bf16 v98, v91, v58, v98
v_dot2_f32_bf16 v99, v91, v91, v99
v_dot2_f32_bf16 v100, v91, v159, v100
v_dot2_f32_bf16 v101, v91, v169, v101
v_dot2_f32_bf16 v96, v222, v58, v96
v_dot2_f32_bf16 v97, v222, v222, v97
v_dot2_f32_bf16 v98, v92, v58, v98
v_dot2_f32_bf16 v99, v92, v92, v99
v_dot2_f32_bf16 v100, v92, v160, v100
v_dot2_f32_bf16 v101, v92, v170, v101
v_dot2_f32_bf16 v96, v223, v58, v96
v_dot2_f32_bf16 v97, v223, v223, v97
v_dot2_f32_bf16 v98, v93, v58, v98
v_dot2_f32_bf16 v99, v93, v93, v99
v_dot2_f32_bf16 v100, v93, v161, v100
v_dot2_f32_bf16 v101, v93, v171, v101
v_mov_b32 v102, 0
s_nop 2
v_permlane32_swap_b32 v96, v97
v_permlane32_swap_b32 v98, v99
v_permlane32_swap_b32 v100, v101
v_add_f32 v96, v96, v97
v_add_f32 v98, v98, v99
v_add_f32 v100, v100, v101
v_lshlrev_b32 v15, 5, v8
v_lshl_add_u32 v15, v10, 2, v15
v_permlane16_swap_b32 v96, v98
v_permlane16_swap_b32 v100, v102
s_lshl_b32 s13, s12, 3
s_add_u32 s13, s13, s9
s_lshl_b32 s13, s13, 10
s_add_u32 s13, s13, 0x50000
v_add_f32 v96, v96, v98
v_add_f32 v100, v100, v102
buffer_store_dword v96, v15, s[44:47], s13 offen sc1
buffer_store_dword v100, v15, s[44:47], s13 offen offset:16 sc1
s_waitcnt vmcnt(0)
s_barrier
s_lshl_b32 s12, s8, 3
s_add_u32 s12, s12, s9
s_cmp_lg_u32 s4, 0
s_cbranch_scc1 L_fs_44
s_lshl_b32 s64, s12, 7
s_add_u32 s64, s64, 0x18000
v_mov_b32 v252, s5
v_mov_b32 v253, 0
s_mov_b64 exec, 1
buffer_store_dword v252, v253, s[44:47], s64 offen sc1
s_mov_b64 exec, -1
L_fs_44:
s_cmp_lg_u32 s4, 3
s_cbranch_scc1 L_ct_45
s_lshl_b32 s64, s3, 4
v_and_b32 v249, 15, v1
v_add_u32 v249, s64, v249
v_lshlrev_b32 v249, 7, v249
v_min_u32 v249, L_code_end-L_code_begin-4, v249
global_load_dword v249, v249, s[22:23]
L_ct_45:
s_add_u32 m0, s77, 30720
s_add_u32 s79, s78, 0
buffer_load_dwordx4 v2, s[44:47], s79 offen sc1 lds
s_add_u32 m0, s77, 34816
s_add_u32 s79, s78, 4096
buffer_load_dwordx4 v2, s[44:47], s79 offen sc1 lds
s_add_u32 m0, s77, 38912
s_add_u32 s79, s78, 8192
buffer_load_dwordx4 v2, s[44:47], s79 offen sc1 lds
s_add_u32 m0, s77, 43008
s_add_u32 s79, s78, 12288
buffer_load_dwordx4 v2, s[44:47], s79 offen sc1 lds
s_add_u32 m0, s77, 47104
s_add_u32 s79, s78, 16384
buffer_load_dwordx4 v2, s[44:47], s79 offen sc1 lds
s_add_u32 m0, s77, 51200
s_add_u32 s79, s78, 20480
buffer_load_dwordx4 v2, s[44:47], s79 offen sc1 lds
s_add_u32 m0, s77, 55296
s_add_u32 s79, s78, 24576
buffer_load_dwordx4 v2, s[44:47], s79 offen sc1 lds
s_add_u32 m0, s77, 59392
s_add_u32 s79, s78, 28672
buffer_load_dwordx4 v2, s[44:47], s79 offen sc1 lds
s_add_u32 m0, s77, 63488
s_add_u32 s79, s78, 32768
buffer_load_dwordx4 v2, s[44:47], s79 offen sc1 lds
s_add_u32 m0, s77, 67584
s_add_u32 s79, s78, 36864
buffer_load_dwordx4 v2, s[44:47], s79 offen sc1 lds
s_add_u32 m0, s77, 71680
s_add_u32 s79, s78, 40960
buffer_load_dwordx4 v2, s[44:47], s79 offen sc1 lds
s_add_u32 m0, s77, 75776
s_add_u32 s79, s78, 45056
buffer_load_dwordx4 v2, s[44:47], s79 offen sc1 lds
s_add_u32 m0, s77, 79872
s_add_u32 s79, s78, 49152
buffer_load_dwordx4 v2, s[44:47], s79 offen sc1 lds
s_add_u32 m0, s77, 83968
s_add_u32 s79, s78, 53248
buffer_load_dwordx4 v2, s[44:47], s79 offen sc1 lds
s_add_u32 m0, s77, 88064
s_add_u32 s79, s78, 57344
buffer_load_dwordx4 v2, s[44:47], s79 offen sc1 lds
s_add_u32 m0, s77, 92160
s_add_u32 s79, s78, 61440
buffer_load_dwordx4 v2, s[44:47], s79 offen sc1 lds
s_add_u32 m0, s77, 96256
s_add_u32 s79, s78, 65536
buffer_load_dwordx4 v2, s[44:47], s79 offen sc1 lds
s_add_u32 m0, s77, 100352
s_add_u32 s79, s78, 69632
buffer_load_dwordx4 v2, s[44:47], s79 offen sc1 lds
v_lshlrev_b32 v2, 4, v1
v_add_u32 v4, 30720, v2
v_add_u32 v5, 92160, v2
v_mul_u32_u24 v8, 20, v1
v_add_u32 v8, 155264, v8
ds_read_b32 v16, v8 offset:0
ds_read_b32 v24, v8 offset:1280
ds_read_b32 v17, v8 offset:4
ds_read_b32 v25, v8 offset:1284
ds_read_b32 v18, v8 offset:8
ds_read_b32 v26, v8 offset:1288
ds_read_b32 v19, v8 offset:12
ds_read_b32 v27, v8 offset:1292
ds_read_b32 v20, v8 offset:16
ds_read_b32 v28, v8 offset:1296
v_mov_b32 v58, 0x3f803f80
v_mov_b32 v148, 0
v_mov_b32 v149, 0
v_mov_b32 v150, 0
v_mov_b32 v151, 0
v_mov_b32 v152, 0
s_waitcnt lgkmcnt(0)
v_dot2_f32_bf16 v148, v16, v58, v148
v_dot2_f32_bf16 v149, v16, v16, v149
v_dot2_f32_bf16 v150, v16, v24, v150
v_dot2_f32_bf16 v151, v24, v58, v151
v_dot2_f32_bf16 v152, v24, v24, v152
v_dot2_f32_bf16 v148, v17, v58, v148
v_dot2_f32_bf16 v149, v17, v17, v149
v_dot2_f32_bf16 v150, v17, v25, v150
v_dot2_f32_bf16 v151, v25, v58, v151
v_dot2_f32_bf16 v152, v25, v25, v152
v_dot2_f32_bf16 v148, v18, v58, v148
v_dot2_f32_bf16 v149, v18, v18, v149
v_dot2_f32_bf16 v150, v18, v26, v150
v_dot2_f32_bf16 v151, v26, v58, v151
v_dot2_f32_bf16 v152, v26, v26, v152
v_dot2_f32_bf16 v148, v19, v58, v148
v_dot2_f32_bf16 v149, v19, v19, v149
v_dot2_f32_bf16 v150, v19, v27, v150
v_dot2_f32_bf16 v151, v27, v58, v151
v_dot2_f32_bf16 v152, v27, v27, v152
v_dot2_f32_bf16 v148, v20, v58, v148
v_dot2_f32_bf16 v149, v20, v20, v149
v_dot2_f32_bf16 v150, v20, v28, v150
v_dot2_f32_bf16 v151, v28, v58, v151
v_dot2_f32_bf16 v152, v28, v28, v152
v_add_f32_dpp v148, v148, v148 row_ror:1 row_mask:0xf bank_mask:0xf
v_add_f32_dpp v149, v149, v149 row_ror:1 row_mask:0xf bank_mask:0xf
v_add_f32_dpp v150, v150, v150 row_ror:1 row_mask:0xf bank_mask:0xf
v_add_f32_dpp v151, v151, v151 row_ror:1 row_mask:0xf bank_mask:0xf
v_add_f32_dpp v152, v152, v152 row_ror:1 row_mask:0xf bank_mask:0xf
v_add_f32_dpp v148, v148, v148 row_ror:2 row_mask:0xf bank_mask:0xf
v_add_f32_dpp v149, v149, v149 row_ror:2 row_mask:0xf bank_mask:0xf
v_add_f32_dpp v150, v150, v150 row_ror:2 row_mask:0xf bank_mask:0xf
v_add_f32_dpp v151, v151, v151 row_ror:2 row_mask:0xf bank_mask:0xf
v_add_f32_dpp v152, v152, v152 row_ror:2 row_mask:0xf bank_mask:0xf
v_add_f32_dpp v148, v148, v148 row_ror:4 row_mask:0xf bank_mask:0xf
v_add_f32_dpp v149, v149, v149 row_ror:4 row_mask:0xf bank_mask:0xf
v_add_f32_dpp v150, v150, v150 row_ror:4 row_mask:0xf bank_mask:0xf
v_add_f32_dpp v151, v151, v151 row_ror:4 row_mask:0xf bank_mask:0xf
v_add_f32_dpp v152, v152, v152 row_ror:4 row_mask:0xf bank_mask:0xf
v_add_f32_dpp v148, v148, v148 row_ror:8 row_mask:0xf bank_mask:0xf
v_add_f32_dpp v149, v149, v149 row_ror:8 row_mask:0xf bank_mask:0xf
v_add_f32_dpp v150, v150, v150 row_ror:8 row_mask:0xf bank_mask:0xf
v_add_f32_dpp v151, v151, v151 row_ror:8 row_mask:0xf bank_mask:0xf
v_add_f32_dpp v152, v152, v152 row_ror:8 row_mask:0xf bank_mask:0xf
v_mov_b32 v16, v148
v_mov_b32 v17, v149
v_mov_b32 v18, v150
v_mov_b32 v19, v151
v_mov_b32 v20, v152
v_permlane16_swap_b32 v148, v16
v_permlane16_swap_b32 v149, v17
v_permlane16_swap_b32 v150, v18
v_permlane16_swap_b32 v151, v19
v_permlane16_swap_b32 v152, v20
v_add_f32 v148, v148, v16
v_add_f32 v149, v149, v17
v_add_f32 v150, v150, v18
v_add_f32 v151, v151, v19
v_add_f32 v152, v152, v20
v_mov_b32 v16, v148
v_mov_b32 v17, v149
v_mov_b32 v18, v150
v_mov_b32 v19, v151
v_mov_b32 v20, v152
v_permlane32_swap_b32 v148, v16
v_permlane32_swap_b32 v149, v17
v_permlane32_swap_b32 v150, v18
v_permlane32_swap_b32 v151, v19
v_permlane32_swap_b32 v152, v20
v_add_f32 v148, v148, v16
v_add_f32 v149, v149, v17
v_add_f32 v150, v150, v18
v_add_f32 v151, v151, v19
v_add_f32 v152, v152, v20
v_and_b32 v8, 15, v1
v_lshrrev_b32 v9, 4, v1
v_xor_b32 v10, v8, v9
v_and_b32 v10, 1, v10
v_lshrrev_b32 v11, 1, v8
v_cmp_eq_u32 vcc, 0, v10
v_cmp_gt_u32 s[66:67], 2, v11
s_nop 1
s_nop 1
s_and_b64 s[66:67], s[66:67], vcc
v_mov_b32 v12, 0
v_mov_b32 v13, -1
v_cndmask_b32 v60, v12, v13, s[66:67]
v_cmp_eq_u32 s[66:67], 2, v11
s_nop 1
s_nop 1
s_and_b64 s[66:67], s[66:67], vcc
v_mov_b32 v13, 0x3f803f80
v_cndmask_b32 v61, v12, v13, s[66:67]
v_and_b32 v11, 1, v11
v_mul_u32_u24 v11, 1280, v11
v_lshrrev_b32 v9, 1, v9
v_lshl_add_u32 v62, v9, 3, v11
v_add_u32 v62, 155264, v62
v_lshl_add_u32 v63, v9, 4, v11
v_add_u32 v63, 155264, v63
s_mul_i32 s76, s9, 245760
s_add_u32 s76, s76, 0x2a00000
s_cmp_eq_u32 s4, 1
s_cbranch_scc1 L_w2d1_47
s_cmp_eq_u32 s4, 2
s_cbranch_scc1 L_w2d2_48
s_cmp_eq_u32 s4, 3
s_cbranch_scc1 L_w2d3_49
s_nop 0
L_w2d0_46:
s_mov_b32 m0, 0
s_add_u32 s79, s76, 0
buffer_load_dwordx4 v2, s[44:47], s79 offen sc1 lds
s_mov_b32 m0, 4096
s_add_u32 s79, s76, 4096
buffer_load_dwordx4 v2, s[44:47], s79 offen sc1 lds
s_mov_b32 m0, 8192
s_add_u32 s79, s76, 8192
buffer_load_dwordx4 v2, s[44:47], s79 offen sc1 lds
s_mov_b32 m0, 12288
s_add_u32 s79, s76, 12288
buffer_load_dwordx4 v2, s[44:47], s79 offen sc1 lds
s_mov_b32 m0, 16384
s_add_u32 s79, s76, 16384
buffer_load_dwordx4 v2, s[44:47], s79 offen sc1 lds
s_mov_b32 m0, 20480
s_add_u32 s79, s76, 20480
buffer_load_dwordx4 v2, s[44:47], s79 offen sc1 lds
s_mov_b32 m0, 24576
s_add_u32 s79, s76, 24576
buffer_load_dwordx4 v2, s[44:47], s79 offen sc1 lds
s_mov_b32 m0, 28672
s_add_u32 s79, s76, 28672
buffer_load_dwordx4 v2, s[44:47], s79 offen sc1 lds
s_branch L_w2de_50
L_w2d1_47:
s_mov_b32 m0, 1024
s_add_u32 s79, s76, 1024
buffer_load_dwordx4 v2, s[44:47], s79 offen sc1 lds
s_mov_b32 m0, 5120
s_add_u32 s79, s76, 5120
buffer_load_dwordx4 v2, s[44:47], s79 offen sc1 lds
s_mov_b32 m0, 9216
s_add_u32 s79, s76, 9216
buffer_load_dwordx4 v2, s[44:47], s79 offen sc1 lds
s_mov_b32 m0, 13312
s_add_u32 s79, s76, 13312
buffer_load_dwordx4 v2, s[44:47], s79 offen sc1 lds
s_mov_b32 m0, 17408
s_add_u32 s79, s76, 17408
buffer_load_dwordx4 v2, s[44:47], s79 offen sc1 lds
s_mov_b32 m0, 21504
s_add_u32 s79, s76, 21504
buffer_load_dwordx4 v2, s[44:47], s79 offen sc1 lds
s_mov_b32 m0, 25600
s_add_u32 s79, s76, 25600
buffer_load_dwordx4 v2, s[44:47], s79 offen sc1 lds
s_mov_b32 m0, 29696
s_add_u32 s79, s76, 29696
buffer_load_dwordx4 v2, s[44:47], s79 offen sc1 lds
s_branch L_w2de_50
L_w2d2_48:
s_mov_b32 m0, 2048
s_add_u32 s79, s76, 2048
buffer_load_dwordx4 v2, s[44:47], s79 offen sc1 lds
s_mov_b32 m0, 6144
s_add_u32 s79, s76, 6144
buffer_load_dwordx4 v2, s[44:47], s79 offen sc1 lds
s_mov_b32 m0, 10240
s_add_u32 s79, s76, 10240
buffer_load_dwordx4 v2, s[44:47], s79 offen sc1 lds
s_mov_b32 m0, 14336
s_add_u32 s79, s76, 14336
buffer_load_dwordx4 v2, s[44:47], s79 offen sc1 lds
s_mov_b32 m0, 18432
s_add_u32 s79, s76, 18432
buffer_load_dwordx4 v2, s[44:47], s79 offen sc1 lds
s_mov_b32 m0, 22528
s_add_u32 s79, s76, 22528
buffer_load_dwordx4 v2, s[44:47], s79 offen sc1 lds
s_mov_b32 m0, 26624
s_add_u32 s79, s76, 26624
buffer_load_dwordx4 v2, s[44:47], s79 offen sc1 lds
s_mov_b32 m0, 2048
s_add_u32 s79, s76, 2048
buffer_load_dwordx4 v2, s[44:47], s79 offen sc1 lds
s_branch L_w2de_50
L_w2d3_49:
s_mov_b32 m0, 3072
s_add_u32 s79, s76, 3072
buffer_load_dwordx4 v2, s[44:47], s79 offen sc1 lds
s_mov_b32 m0, 7168
s_add_u32 s79, s76, 7168
buffer_load_dwordx4 v2, s[44:47], s79 offen sc1 lds
s_mov_b32 m0, 11264
s_add_u32 s79, s76, 11264
buffer_load_dwordx4 v2, s[44:47], s79 offen sc1 lds
s_mov_b32 m0, 15360
s_add_u32 s79, s76, 15360
buffer_load_dwordx4 v2, s[44:47], s79 offen sc1 lds
s_mov_b32 m0, 19456
s_add_u32 s79, s76, 19456
buffer_load_dwordx4 v2, s[44:47], s79 offen sc1 lds
s_mov_b32 m0, 23552
s_add_u32 s79, s76, 23552
buffer_load_dwordx4 v2, s[44:47], s79 offen sc1 lds
s_mov_b32 m0, 27648
s_add_u32 s79, s76, 27648
buffer_load_dwordx4 v2, s[44:47], s79 offen sc1 lds
s_mov_b32 m0, 3072
s_add_u32 s79, s76, 3072
buffer_load_dwordx4 v2, s[44:47], s79 offen sc1 lds
L_w2de_50:
v_and_b32 v8, 15, v1
s_lshl_b32 s12, s10, 4
v_add_u32 v8, s12, v8
v_lshlrev_b32 v8, 7, v8
v_add_u32 v14, 0x18000, v8
v_lshlrev_b32 v2, 4, v1
s_cmp_lg_u32 s4, 0
s_cbranch_scc1 L_pd_52
s_mov_b32 s64, 0
L_pl_51:
buffer_load_dword v250, v14, s[44:47], 0 offen sc1
s_add_u32 s64, s64, 1
s_cmp_gt_u32 s64, 1048576
s_cbranch_scc1 L_pd_52
s_waitcnt vmcnt(0)
v_cmp_ne_u32 vcc, s5, v250
s_nop 3
s_cmp_eq_u64 vcc, 0
s_cbranch_scc1 L_pd_52
s_branch L_pl_51
L_pd_52:
s_waitcnt vmcnt(8) lgkmcnt(0)
s_barrier
s_lshl_b32 s12, s10, 2
s_add_u32 s12, s12, s4
s_mul_i32 s13, s12, 40960
s_add_u32 s13, s13, 0xd00000
buffer_load_dwordx4 a[0:3], v2, s[44:47], s13 offen offset:0 sc1
buffer_load_dwordx4 a[4:7], v2, s[44:47], s13 offen offset:1024 sc1
buffer_load_dwordx4 a[8:11], v2, s[44:47], s13 offen offset:2048 sc1
buffer_load_dwordx4 a[12:15], v2, s[44:47], s13 offen offset:3072 sc1
s_add_u32 s13, s13, 4096
buffer_load_dwordx4 a[16:19], v2, s[44:47], s13 offen offset:0 sc1
buffer_load_dwordx4 a[20:23], v2, s[44:47], s13 offen offset:1024 sc1
buffer_load_dwordx4 a[24:27], v2, s[44:47], s13 offen offset:2048 sc1
buffer_load_dwordx4 a[28:31], v2, s[44:47], s13 offen offset:3072 sc1
s_add_u32 s13, s13, 4096
buffer_load_dwordx4 a[32:35], v2, s[44:47], s13 offen offset:0 sc1
buffer_load_dwordx4 a[36:39], v2, s[44:47], s13 offen offset:1024 sc1
buffer_load_dwordx4 a[40:43], v2, s[44:47], s13 offen offset:2048 sc1
buffer_load_dwordx4 a[44:47], v2, s[44:47], s13 offen offset:3072 sc1
s_add_u32 s13, s13, 4096
buffer_load_dwordx4 a[48:51], v2, s[44:47], s13 offen offset:0 sc1
buffer_load_dwordx4 a[52:55], v2, s[44:47], s13 offen offset:1024 sc1
buffer_load_dwordx4 a[56:59], v2, s[44:47], s13 offen offset:2048 sc1
buffer_load_dwordx4 a[60:63], v2, s[44:47], s13 offen offset:3072 sc1
s_lshl_b32 s14, s12, 13
s_add_u32 s14, s14, 0x50000
v_and_b32 v8, 31, v1
v_lshlrev_b32 v8, 5, v8
v_lshrrev_b32 v9, 5, v1
v_lshl_add_u32 v8, v9, 4, v8
buffer_load_dwordx4 v[116:119], v8, s[44:47], s14 offen offset:0 sc1
buffer_load_dwordx4 v[120:123], v8, s[44:47], s14 offen offset:1024 sc1
buffer_load_dwordx4 v[124:127], v8, s[44:47], s14 offen offset:2048 sc1
buffer_load_dwordx4 v[128:131], v8, s[44:47], s14 offen offset:3072 sc1
s_add_u32 s14, s14, 4096
buffer_load_dwordx4 v[132:135], v8, s[44:47], s14 offen offset:0 sc1
buffer_load_dwordx4 v[136:139], v8, s[44:47], s14 offen offset:1024 sc1
buffer_load_dwordx4 v[140:143], v8, s[44:47], s14 offen offset:2048 sc1
buffer_load_dwordx4 v[144:147], v8, s[44:47], s14 offen offset:3072 sc1
ds_read_b128 v[16:19], v4 offset:0
ds_read_b128 v[20:23], v4 offset:1024
ds_read_b128 v[24:27], v4 offset:2048
ds_read_b128 v[28:31], v4 offset:3072
ds_read_b128 v[32:35], v4 offset:4096
ds_read_b128 v[36:39], v4 offset:5120
v_lshlrev_b32 v13, 7, v1
v_mov_b32 v9, 0x7f000000
v_cmp_gt_u32 vcc, 60, v1
s_nop 1
v_cndmask_b32 v13, v9, v13, vcc
s_mul_i32 s90, s3, 61440
s_mul_i32 s65, s4, 15360
s_add_u32 s90, s90, s65
s_add_u32 s90, s90, 0
s_add_u32 s90, s90, 0x2a00000
s_mul_i32 s91, s3, 61440
s_mul_i32 s65, s4, 15360
s_add_u32 s91, s91, s65
s_add_u32 s91, s91, 7680
s_add_u32 s91, s91, 0x2a00000
s_cmp_eq_u32 s4, 0
s_cbranch_scc1 L_gsA_53
s_waitcnt vmcnt(23) lgkmcnt(3)
v_mfma_f32_32x32x16_bf16 v[64:79], v[16:19], a[0:3], 0
ds_read_b128 v[40:43], v4 offset:6144
s_add_u32 s13, s13, 4096
buffer_load_dwordx4 a[64:67], v2, s[44:47], s13 offen offset:0 sc1
v_mfma_f32_32x32x16_bf16 v[80:95], v[20:23], a[0:3], 0
ds_read_b128 v[44:47], v4 offset:7168
v_mfma_f32_32x32x16_bf16 v[96:111], v[24:27], a[0:3], 0
ds_read_b128 v[48:51], v4 offset:8192
s_waitcnt vmcnt(23) lgkmcnt(3)
v_mfma_f32_32x32x16_bf16 v[64:79], v[28:31], a[4:7], v[64:79]
ds_read_b128 v[16:19], v4 offset:9216
buffer_load_dwordx4 a[68:71], v2, s[44:47], s13 offen offset:1024 sc1
v_mfma_f32_32x32x16_bf16 v[80:95], v[32:35], a[4:7], v[80:95]
ds_read_b128 v[20:23], v4 offset:10240
v_mfma_f32_32x32x16_bf16 v[96:111], v[36:39], a[4:7], v[96:111]
ds_read_b128 v[24:27], v4 offset:11264
s_waitcnt vmcnt(23) lgkmcnt(3)
v_mfma_f32_32x32x16_bf16 v[64:79], v[40:43], a[8:11], v[64:79]
ds_read_b128 v[28:31], v4 offset:12288
buffer_load_dwordx4 a[72:75], v2, s[44:47], s13 offen offset:2048 sc1
v_mfma_f32_32x32x16_bf16 v[80:95], v[44:47], a[8:11], v[80:95]
ds_read_b128 v[32:35], v4 offset:13312
v_mfma_f32_32x32x16_bf16 v[96:111], v[48:51], a[8:11], v[96:111]
ds_read_b128 v[36:39], v4 offset:14336
s_waitcnt vmcnt(23) lgkmcnt(3)
v_mfma_f32_32x32x16_bf16 v[64:79], v[16:19], a[12:15], v[64:79]
ds_read_b128 v[40:43], v4 offset:15360
buffer_load_dwordx4 a[76:79], v2, s[44:47], s13 offen offset:3072 sc1
v_mfma_f32_32x32x16_bf16 v[80:95], v[20:23], a[12:15], v[80:95]
ds_read_b128 v[44:47], v4 offset:16384
v_mfma_f32_32x32x16_bf16 v[96:111], v[24:27], a[12:15], v[96:111]
ds_read_b128 v[48:51], v4 offset:17408
s_waitcnt vmcnt(23) lgkmcnt(3)
v_mfma_f32_32x32x16_bf16 v[64:79], v[28:31], a[16:19], v[64:79]
ds_read_b128 v[16:19], v4 offset:18432
s_add_u32 s13, s13, 4096
buffer_load_dwordx4 a[80:83], v2, s[44:47], s13 offen offset:0 sc1
v_mfma_f32_32x32x16_bf16 v[80:95], v[32:35], a[16:19], v[80:95]
ds_read_b128 v[20:23], v4 offset:19456
v_mfma_f32_32x32x16_bf16 v[96:111], v[36:39], a[16:19], v[96:111]
ds_read_b128 v[24:27], v4 offset:20480
s_waitcnt vmcnt(23) lgkmcnt(3)
v_mfma_f32_32x32x16_bf16 v[64:79], v[40:43], a[20:23], v[64:79]
ds_read_b128 v[28:31], v4 offset:21504
buffer_load_dwordx4 a[84:87], v2, s[44:47], s13 offen offset:1024 sc1
v_mfma_f32_32x32x16_bf16 v[80:95], v[44:47], a[20:23], v[80:95]
ds_read_b128 v[32:35], v4 offset:22528
v_mfma_f32_32x32x16_bf16 v[96:111], v[48:51], a[20:23], v[96:111]
ds_read_b128 v[36:39], v4 offset:23552
s_waitcnt vmcnt(23) lgkmcnt(3)
v_mfma_f32_32x32x16_bf16 v[64:79], v[16:19], a[24:27], v[64:79]
ds_read_b128 v[40:43], v4 offset:24576
buffer_load_dwordx4 a[88:91], v2, s[44:47], s13 offen offset:2048 sc1
v_mfma_f32_32x32x16_bf16 v[80:95], v[20:23], a[24:27], v[80:95]
ds_read_b128 v[44:47], v4 offset:25600
v_mfma_f32_32x32x16_bf16 v[96:111], v[24:27], a[24:27], v[96:111]
ds_read_b128 v[48:51], v4 offset:26624
s_waitcnt vmcnt(23) lgkmcnt(3)
v_mfma_f32_32x32x16_bf16 v[64:79], v[28:31], a[28:31], v[64:79]
ds_read_b128 v[16:19], v4 offset:27648
buffer_load_dwordx4 a[92:95], v2, s[44:47], s13 offen offset:3072 sc1
v_mfma_f32_32x32x16_bf16 v[80:95], v[32:35], a[28:31], v[80:95]
ds_read_b128 v[20:23], v4 offset:28672
v_mfma_f32_32x32x16_bf16 v[96:111], v[36:39], a[28:31], v[96:111]
ds_read_b128 v[24:27], v4 offset:29696
s_waitcnt vmcnt(23) lgkmcnt(3)
v_mfma_f32_32x32x16_bf16 v[64:79], v[40:43], a[32:35], v[64:79]
ds_read_b128 v[28:31], v4 offset:30720
s_add_u32 s13, s13, 4096
buffer_load_dwordx4 a[96:99], v2, s[44:47], s13 offen offset:0 sc1
v_mfma_f32_32x32x16_bf16 v[80:95], v[44:47], a[32:35], v[80:95]
ds_read_b128 v[32:35], v4 offset:31744
v_mfma_f32_32x32x16_bf16 v[96:111], v[48:51], a[32:35], v[96:111]
ds_read_b128 v[36:39], v4 offset:32768
s_waitcnt vmcnt(23) lgkmcnt(3)
v_mfma_f32_32x32x16_bf16 v[64:79], v[16:19], a[36:39], v[64:79]
ds_read_b128 v[40:43], v4 offset:33792
buffer_load_dwordx4 a[100:103], v2, s[44:47], s13 offen offset:1024 sc1
v_mfma_f32_32x32x16_bf16 v[80:95], v[20:23], a[36:39], v[80:95]
ds_read_b128 v[44:47], v4 offset:34816
v_mfma_f32_32x32x16_bf16 v[96:111], v[24:27], a[36:39], v[96:111]
ds_read_b128 v[48:51], v4 offset:35840
s_branch L_gsJ_54
L_gsA_53:
ds_read_b64 v[52:53], v62 offset:0
ds_read_b64 v[54:55], v62 offset:32
s_waitcnt lgkmcnt(0)
s_waitcnt vmcnt(23) lgkmcnt(3)
ds_read_b64 v[56:57], v62 offset:16
ds_read_b64 v[58:59], v62 offset:48
v_mfma_f32_32x32x16_bf16 v[64:79], v[16:19], a[0:3], 0
ds_read_b128 v[40:43], v4 offset:6144
s_add_u32 s13, s13, 4096
buffer_load_dwordx4 a[64:67], v2, s[44:47], s13 offen offset:0 sc1
v_and_or_b32 v52, v52, v60, v61
v_and_or_b32 v53, v53, v60, v61
v_and_or_b32 v54, v54, v60, v61
v_and_or_b32 v55, v55, v60, v61
v_mfma_f32_32x32x16_bf16 v[80:95], v[20:23], a[0:3], 0
ds_read_b128 v[44:47], v4 offset:7168
v_mfma_f32_32x32x16_bf16 v[96:111], v[24:27], a[0:3], 0
ds_read_b128 v[48:51], v4 offset:8192
v_mfma_f32_16x16x32_bf16 v[160:163], v[16:19], v[52:55], 0
v_mfma_f32_16x16x32_bf16 v[164:167], v[20:23], v[52:55], 0
v_mfma_f32_16x16x32_bf16 v[168:171], v[24:27], v[52:55], 0
s_waitcnt vmcnt(23) lgkmcnt(3)
ds_read_b64 v[52:53], v62 offset:64
ds_read_b64 v[54:55], v62 offset:96
v_mfma_f32_32x32x16_bf16 v[64:79], v[28:31], a[4:7], v[64:79]
ds_read_b128 v[16:19], v4 offset:9216
buffer_load_dwordx4 a[68:71], v2, s[44:47], s13 offen offset:1024 sc1
v_and_or_b32 v56, v56, v60, v61
v_and_or_b32 v57, v57, v60, v61
v_and_or_b32 v58, v58, v60, v61
v_and_or_b32 v59, v59, v60, v61
v_mfma_f32_32x32x16_bf16 v[80:95], v[32:35], a[4:7], v[80:95]
ds_read_b128 v[20:23], v4 offset:10240
v_mfma_f32_32x32x16_bf16 v[96:111], v[36:39], a[4:7], v[96:111]
ds_read_b128 v[24:27], v4 offset:11264
v_mfma_f32_16x16x32_bf16 v[160:163], v[28:31], v[56:59], v[160:163]
v_mfma_f32_16x16x32_bf16 v[164:167], v[32:35], v[56:59], v[164:167]
v_mfma_f32_16x16x32_bf16 v[168:171], v[36:39], v[56:59], v[168:171]
s_waitcnt vmcnt(23) lgkmcnt(3)
ds_read_b64 v[56:57], v62 offset:80
ds_read_b64 v[58:59], v62 offset:112
v_mfma_f32_32x32x16_bf16 v[64:79], v[40:43], a[8:11], v[64:79]
ds_read_b128 v[28:31], v4 offset:12288
buffer_load_dwordx4 a[72:75], v2, s[44:47], s13 offen offset:2048 sc1
v_and_or_b32 v52, v52, v60, v61
v_and_or_b32 v53, v53, v60, v61
v_and_or_b32 v54, v54, v60, v61
v_and_or_b32 v55, v55, v60, v61
v_mfma_f32_32x32x16_bf16 v[80:95], v[44:47], a[8:11], v[80:95]
ds_read_b128 v[32:35], v4 offset:13312
v_mfma_f32_32x32x16_bf16 v[96:111], v[48:51], a[8:11], v[96:111]
ds_read_b128 v[36:39], v4 offset:14336
v_mfma_f32_16x16x32_bf16 v[160:163], v[40:43], v[52:55], v[160:163]
v_mfma_f32_16x16x32_bf16 v[164:167], v[44:47], v[52:55], v[164:167]
v_mfma_f32_16x16x32_bf16 v[168:171], v[48:51], v[52:55], v[168:171]
s_waitcnt vmcnt(23) lgkmcnt(3)
ds_read_b64 v[52:53], v63 offset:128
ds_read_b64 v[54:55], v63 offset:136
v_mfma_f32_32x32x16_bf16 v[64:79], v[16:19], a[12:15], v[64:79]
ds_read_b128 v[40:43], v4 offset:15360
buffer_load_dwordx4 a[76:79], v2, s[44:47], s13 offen offset:3072 sc1
v_and_or_b32 v56, v56, v60, v61
v_and_or_b32 v57, v57, v60, v61
v_and_or_b32 v58, v58, v60, v61
v_and_or_b32 v59, v59, v60, v61
v_mfma_f32_32x32x16_bf16 v[80:95], v[20:23], a[12:15], v[80:95]
ds_read_b128 v[44:47], v4 offset:16384
v_mfma_f32_32x32x16_bf16 v[96:111], v[24:27], a[12:15], v[96:111]
ds_read_b128 v[48:51], v4 offset:17408
v_mfma_f32_16x16x32_bf16 v[160:163], v[16:19], v[56:59], v[160:163]
v_mfma_f32_16x16x32_bf16 v[164:167], v[20:23], v[56:59], v[164:167]
v_mfma_f32_16x16x32_bf16 v[168:171], v[24:27], v[56:59], v[168:171]
s_waitcnt vmcnt(23) lgkmcnt(3)
ds_read_b64 v[56:57], v62 offset:160
ds_read_b64 v[58:59], v62 offset:192
v_mfma_f32_32x32x16_bf16 v[64:79], v[28:31], a[16:19], v[64:79]
ds_read_b128 v[16:19], v4 offset:18432
s_add_u32 s13, s13, 4096
buffer_load_dwordx4 a[80:83], v2, s[44:47], s13 offen offset:0 sc1
v_and_or_b32 v52, v52, v60, v61
v_and_or_b32 v53, v53, v60, v61
v_and_or_b32 v54, v54, v60, v61
v_and_or_b32 v55, v55, v60, v61
v_mfma_f32_32x32x16_bf16 v[80:95], v[32:35], a[16:19], v[80:95]
ds_read_b128 v[20:23], v4 offset:19456
v_mfma_f32_32x32x16_bf16 v[96:111], v[36:39], a[16:19], v[96:111]
ds_read_b128 v[24:27], v4 offset:20480
v_mfma_f32_16x16x32_bf16 v[160:163], v[28:31], v[52:55], v[160:163]
v_mfma_f32_16x16x32_bf16 v[164:167], v[32:35], v[52:55], v[164:167]
v_mfma_f32_16x16x32_bf16 v[168:171], v[36:39], v[52:55], v[168:171]
s_waitcnt vmcnt(23) lgkmcnt(3)
ds_read_b64 v[52:53], v62 offset:176
ds_read_b64 v[54:55], v62 offset:208
v_mfma_f32_32x32x16_bf16 v[64:79], v[40:43], a[20:23], v[64:79]
ds_read_b128 v[28:31], v4 offset:21504
buffer_load_dwordx4 a[84:87], v2, s[44:47], s13 offen offset:1024 sc1
v_and_or_b32 v56, v56, v60, v61
v_and_or_b32 v57, v57, v60, v61
v_and_or_b32 v58, v58, v60, v61
v_and_or_b32 v59, v59, v60, v61
v_mfma_f32_32x32x16_bf16 v[80:95], v[44:47], a[20:23], v[80:95]
ds_read_b128 v[32:35], v4 offset:22528
v_mfma_f32_32x32x16_bf16 v[96:111], v[48:51], a[20:23], v[96:111]
ds_read_b128 v[36:39], v4 offset:23552
v_mfma_f32_16x16x32_bf16 v[160:163], v[40:43], v[56:59], v[160:163]
v_mfma_f32_16x16x32_bf16 v[164:167], v[44:47], v[56:59], v[164:167]
v_mfma_f32_16x16x32_bf16 v[168:171], v[48:51], v[56:59], v[168:171]
s_waitcnt vmcnt(23) lgkmcnt(3)
ds_read_b64 v[56:57], v62 offset:224
ds_read_b64 v[58:59], v62 offset:256
v_mfma_f32_32x32x16_bf16 v[64:79], v[16:19], a[24:27], v[64:79]
ds_read_b128 v[40:43], v4 offset:24576
buffer_load_dwordx4 a[88:91], v2, s[44:47], s13 offen offset:2048 sc1
v_and_or_b32 v52, v52, v60, v61
v_and_or_b32 v53, v53, v60, v61
v_and_or_b32 v54, v54, v60, v61
v_and_or_b32 v55, v55, v60, v61
v_mfma_f32_32x32x16_bf16 v[80:95], v[20:23], a[24:27], v[80:95]
ds_read_b128 v[44:47], v4 offset:25600
v_mfma_f32_32x32x16_bf16 v[96:111], v[24:27], a[24:27], v[96:111]
ds_read_b128 v[48:51], v4 offset:26624
v_mfma_f32_16x16x32_bf16 v[160:163], v[16:19], v[52:55], v[160:163]
v_mfma_f32_16x16x32_bf16 v[164:167], v[20:23], v[52:55], v[164:167]
v_mfma_f32_16x16x32_bf16 v[168:171], v[24:27], v[52:55], v[168:171]
s_waitcnt vmcnt(23) lgkmcnt(3)
ds_read_b64 v[52:53], v62 offset:240
ds_read_b64 v[54:55], v62 offset:272
v_mfma_f32_32x32x16_bf16 v[64:79], v[28:31], a[28:31], v[64:79]
ds_read_b128 v[16:19], v4 offset:27648
buffer_load_dwordx4 a[92:95], v2, s[44:47], s13 offen offset:3072 sc1
v_and_or_b32 v56, v56, v60, v61
v_and_or_b32 v57, v57, v60, v61
v_and_or_b32 v58, v58, v60, v61
v_and_or_b32 v59, v59, v60, v61
v_mfma_f32_32x32x16_bf16 v[80:95], v[32:35], a[28:31], v[80:95]
ds_read_b128 v[20:23], v4 offset:28672
v_mfma_f32_32x32x16_bf16 v[96:111], v[36:39], a[28:31], v[96:111]
ds_read_b128 v[24:27], v4 offset:29696
v_mfma_f32_16x16x32_bf16 v[160:163], v[28:31], v[56:59], v[160:163]
v_mfma_f32_16x16x32_bf16 v[164:167], v[32:35], v[56:59], v[164:167]
v_mfma_f32_16x16x32_bf16 v[168:171], v[36:39], v[56:59], v[168:171]
s_waitcnt vmcnt(23) lgkmcnt(3)
ds_read_b64 v[56:57], v63 offset:288
ds_read_b64 v[58:59], v63 offset:296
v_mfma_f32_32x32x16_bf16 v[64:79], v[40:43], a[32:35], v[64:79]
ds_read_b128 v[28:31], v4 offset:30720
s_add_u32 s13, s13, 4096
buffer_load_dwordx4 a[96:99], v2, s[44:47], s13 offen offset:0 sc1
v_and_or_b32 v52, v52, v60, v61
v_and_or_b32 v53, v53, v60, v61
v_and_or_b32 v54, v54, v60, v61
v_and_or_b32 v55, v55, v60, v61
v_mfma_f32_32x32x16_bf16 v[80:95], v[44:47], a[32:35], v[80:95]
ds_read_b128 v[32:35], v4 offset:31744
v_mfma_f32_32x32x16_bf16 v[96:111], v[48:51], a[32:35], v[96:111]
ds_read_b128 v[36:39], v4 offset:32768
v_mfma_f32_16x16x32_bf16 v[160:163], v[40:43], v[52:55], v[160:163]
v_mfma_f32_16x16x32_bf16 v[164:167], v[44:47], v[52:55], v[164:167]
v_mfma_f32_16x16x32_bf16 v[168:171], v[48:51], v[52:55], v[168:171]
s_waitcnt vmcnt(23) lgkmcnt(3)
v_mfma_f32_32x32x16_bf16 v[64:79], v[16:19], a[36:39], v[64:79]
ds_read_b128 v[40:43], v4 offset:33792
buffer_load_dwordx4 a[100:103], v2, s[44:47], s13 offen offset:1024 sc1
v_and_or_b32 v56, v56, v60, v61
v_and_or_b32 v57, v57, v60, v61
v_and_or_b32 v58, v58, v60, v61
v_and_or_b32 v59, v59, v60, v61
v_mfma_f32_32x32x16_bf16 v[80:95], v[20:23], a[36:39], v[80:95]
ds_read_b128 v[44:47], v4 offset:34816
v_mfma_f32_32x32x16_bf16 v[96:111], v[24:27], a[36:39], v[96:111]
ds_read_b128 v[48:51], v4 offset:35840
v_mfma_f32_16x16x32_bf16 v[160:163], v[16:19], v[56:59], v[160:163]
v_mfma_f32_16x16x32_bf16 v[164:167], v[20:23], v[56:59], v[164:167]
v_mfma_f32_16x16x32_bf16 v[168:171], v[24:27], v[56:59], v[168:171]
L_gsJ_54:
s_cmp_eq_u32 s4, 1
s_cbranch_scc1 L_gsA_55
s_waitcnt vmcnt(23) lgkmcnt(3)
v_mfma_f32_32x32x16_bf16 v[64:79], v[28:31], a[40:43], v[64:79]
ds_read_b128 v[16:19], v4 offset:36864
buffer_load_dwordx4 a[104:107], v2, s[44:47], s13 offen offset:2048 sc1
v_mfma_f32_32x32x16_bf16 v[80:95], v[32:35], a[40:43], v[80:95]
ds_read_b128 v[20:23], v4 offset:37888
v_mfma_f32_32x32x16_bf16 v[96:111], v[36:39], a[40:43], v[96:111]
ds_read_b128 v[24:27], v4 offset:38912
s_waitcnt vmcnt(23) lgkmcnt(3)
v_mfma_f32_32x32x16_bf16 v[64:79], v[40:43], a[44:47], v[64:79]
ds_read_b128 v[28:31], v4 offset:39936
buffer_load_dwordx4 a[108:111], v2, s[44:47], s13 offen offset:3072 sc1
v_mfma_f32_32x32x16_bf16 v[80:95], v[44:47], a[44:47], v[80:95]
ds_read_b128 v[32:35], v4 offset:40960
v_mfma_f32_32x32x16_bf16 v[96:111], v[48:51], a[44:47], v[96:111]
ds_read_b128 v[36:39], v4 offset:41984
s_waitcnt vmcnt(23) lgkmcnt(3)
v_mfma_f32_32x32x16_bf16 v[64:79], v[16:19], a[48:51], v[64:79]
ds_read_b128 v[40:43], v4 offset:43008
s_add_u32 s13, s13, 4096
buffer_load_dwordx4 a[112:115], v2, s[44:47], s13 offen offset:0 sc1
v_mfma_f32_32x32x16_bf16 v[80:95], v[20:23], a[48:51], v[80:95]
ds_read_b128 v[44:47], v4 offset:44032
v_mfma_f32_32x32x16_bf16 v[96:111], v[24:27], a[48:51], v[96:111]
ds_read_b128 v[48:51], v4 offset:45056
s_waitcnt vmcnt(23) lgkmcnt(3)
v_mfma_f32_32x32x16_bf16 v[64:79], v[28:31], a[52:55], v[64:79]
ds_read_b128 v[16:19], v4 offset:46080
buffer_load_dwordx4 a[116:119], v2, s[44:47], s13 offen offset:1024 sc1
v_mfma_f32_32x32x16_bf16 v[80:95], v[32:35], a[52:55], v[80:95]
ds_read_b128 v[20:23], v4 offset:47104
v_mfma_f32_32x32x16_bf16 v[96:111], v[36:39], a[52:55], v[96:111]
ds_read_b128 v[24:27], v4 offset:48128
s_waitcnt vmcnt(23) lgkmcnt(3)
v_mfma_f32_32x32x16_bf16 v[64:79], v[40:43], a[56:59], v[64:79]
ds_read_b128 v[28:31], v4 offset:49152
buffer_load_dwordx4 a[120:123], v2, s[44:47], s13 offen offset:2048 sc1
v_mfma_f32_32x32x16_bf16 v[80:95], v[44:47], a[56:59], v[80:95]
ds_read_b128 v[32:35], v4 offset:50176
v_mfma_f32_32x32x16_bf16 v[96:111], v[48:51], a[56:59], v[96:111]
ds_read_b128 v[36:39], v4 offset:51200
s_waitcnt vmcnt(23) lgkmcnt(3)
v_mfma_f32_32x32x16_bf16 v[64:79], v[16:19], a[60:63], v[64:79]
ds_read_b128 v[40:43], v4 offset:52224
buffer_load_dwordx4 a[124:127], v2, s[44:47], s13 offen offset:3072 sc1
v_mfma_f32_32x32x16_bf16 v[80:95], v[20:23], a[60:63], v[80:95]
ds_read_b128 v[44:47], v4 offset:53248
v_mfma_f32_32x32x16_bf16 v[96:111], v[24:27], a[60:63], v[96:111]
ds_read_b128 v[48:51], v4 offset:54272
s_waitcnt vmcnt(15) lgkmcnt(3)
v_mfma_f32_32x32x16_bf16 v[64:79], v[28:31], a[64:67], v[64:79]
ds_read_b128 v[16:19], v4 offset:55296
s_add_u32 s13, s13, 4096
buffer_load_dwordx4 a[128:131], v2, s[44:47], s13 offen offset:0 sc1
v_mfma_f32_32x32x16_bf16 v[80:95], v[32:35], a[64:67], v[80:95]
ds_read_b128 v[20:23], v4 offset:56320
v_mfma_f32_32x32x16_bf16 v[96:111], v[36:39], a[64:67], v[96:111]
ds_read_b128 v[24:27], v4 offset:57344
s_waitcnt vmcnt(15) lgkmcnt(3)
v_mfma_f32_32x32x16_bf16 v[64:79], v[40:43], a[68:71], v[64:79]
ds_read_b128 v[28:31], v4 offset:58368
buffer_load_dwordx4 a[132:135], v2, s[44:47], s13 offen offset:1024 sc1
v_mfma_f32_32x32x16_bf16 v[80:95], v[44:47], a[68:71], v[80:95]
ds_read_b128 v[32:35], v4 offset:59392
v_mfma_f32_32x32x16_bf16 v[96:111], v[48:51], a[68:71], v[96:111]
ds_read_b128 v[36:39], v4 offset:60416
s_waitcnt vmcnt(15) lgkmcnt(3)
v_mfma_f32_32x32x16_bf16 v[64:79], v[16:19], a[72:75], v[64:79]
ds_read_b128 v[40:43], v5 offset:0
buffer_load_dwordx4 a[136:139], v2, s[44:47], s13 offen offset:2048 sc1
v_mfma_f32_32x32x16_bf16 v[80:95], v[20:23], a[72:75], v[80:95]
ds_read_b128 v[44:47], v5 offset:1024
v_mfma_f32_32x32x16_bf16 v[96:111], v[24:27], a[72:75], v[96:111]
ds_read_b128 v[48:51], v5 offset:2048
s_waitcnt vmcnt(15) lgkmcnt(3)
v_mfma_f32_32x32x16_bf16 v[64:79], v[28:31], a[76:79], v[64:79]
ds_read_b128 v[16:19], v5 offset:3072
buffer_load_dwordx4 a[140:143], v2, s[44:47], s13 offen offset:3072 sc1
v_mfma_f32_32x32x16_bf16 v[80:95], v[32:35], a[76:79], v[80:95]
ds_read_b128 v[20:23], v5 offset:4096
v_mfma_f32_32x32x16_bf16 v[96:111], v[36:39], a[76:79], v[96:111]
ds_read_b128 v[24:27], v5 offset:5120
s_branch L_gsJ_56
L_gsA_55:
ds_read_b64 v[52:53], v62 offset:320
ds_read_b64 v[54:55], v62 offset:352
s_waitcnt lgkmcnt(0)
s_waitcnt vmcnt(23) lgkmcnt(3)
ds_read_b64 v[56:57], v62 offset:336
ds_read_b64 v[58:59], v62 offset:368
v_mfma_f32_32x32x16_bf16 v[64:79], v[28:31], a[40:43], v[64:79]
ds_read_b128 v[16:19], v4 offset:36864
buffer_load_dwordx4 a[104:107], v2, s[44:47], s13 offen offset:2048 sc1
v_and_or_b32 v52, v52, v60, v61
v_and_or_b32 v53, v53, v60, v61
v_and_or_b32 v54, v54, v60, v61
v_and_or_b32 v55, v55, v60, v61
v_mfma_f32_32x32x16_bf16 v[80:95], v[32:35], a[40:43], v[80:95]
ds_read_b128 v[20:23], v4 offset:37888
v_mfma_f32_32x32x16_bf16 v[96:111], v[36:39], a[40:43], v[96:111]
ds_read_b128 v[24:27], v4 offset:38912
v_mfma_f32_16x16x32_bf16 v[160:163], v[28:31], v[52:55], 0
v_mfma_f32_16x16x32_bf16 v[164:167], v[32:35], v[52:55], 0
v_mfma_f32_16x16x32_bf16 v[168:171], v[36:39], v[52:55], 0
s_waitcnt vmcnt(23) lgkmcnt(3)
ds_read_b64 v[52:53], v62 offset:384
ds_read_b64 v[54:55], v62 offset:416
v_mfma_f32_32x32x16_bf16 v[64:79], v[40:43], a[44:47], v[64:79]
ds_read_b128 v[28:31], v4 offset:39936
buffer_load_dwordx4 a[108:111], v2, s[44:47], s13 offen offset:3072 sc1
v_and_or_b32 v56, v56, v60, v61
v_and_or_b32 v57, v57, v60, v61
v_and_or_b32 v58, v58, v60, v61
v_and_or_b32 v59, v59, v60, v61
v_mfma_f32_32x32x16_bf16 v[80:95], v[44:47], a[44:47], v[80:95]
ds_read_b128 v[32:35], v4 offset:40960
v_mfma_f32_32x32x16_bf16 v[96:111], v[48:51], a[44:47], v[96:111]
ds_read_b128 v[36:39], v4 offset:41984
v_mfma_f32_16x16x32_bf16 v[160:163], v[40:43], v[56:59], v[160:163]
v_mfma_f32_16x16x32_bf16 v[164:167], v[44:47], v[56:59], v[164:167]
v_mfma_f32_16x16x32_bf16 v[168:171], v[48:51], v[56:59], v[168:171]
s_waitcnt vmcnt(23) lgkmcnt(3)
ds_read_b64 v[56:57], v62 offset:400
ds_read_b64 v[58:59], v62 offset:432
v_mfma_f32_32x32x16_bf16 v[64:79], v[16:19], a[48:51], v[64:79]
ds_read_b128 v[40:43], v4 offset:43008
s_add_u32 s13, s13, 4096
buffer_load_dwordx4 a[112:115], v2, s[44:47], s13 offen offset:0 sc1
v_and_or_b32 v52, v52, v60, v61
v_and_or_b32 v53, v53, v60, v61
v_and_or_b32 v54, v54, v60, v61
v_and_or_b32 v55, v55, v60, v61
v_mfma_f32_32x32x16_bf16 v[80:95], v[20:23], a[48:51], v[80:95]
ds_read_b128 v[44:47], v4 offset:44032
v_mfma_f32_32x32x16_bf16 v[96:111], v[24:27], a[48:51], v[96:111]
ds_read_b128 v[48:51], v4 offset:45056
v_mfma_f32_16x16x32_bf16 v[160:163], v[16:19], v[52:55], v[160:163]
v_mfma_f32_16x16x32_bf16 v[164:167], v[20:23], v[52:55], v[164:167]
v_mfma_f32_16x16x32_bf16 v[168:171], v[24:27], v[52:55], v[168:171]
s_waitcnt vmcnt(23) lgkmcnt(3)
ds_read_b64 v[52:53], v63 offset:448
ds_read_b64 v[54:55], v63 offset:456
v_mfma_f32_32x32x16_bf16 v[64:79], v[28:31], a[52:55], v[64:79]
ds_read_b128 v[16:19], v4 offset:46080
buffer_load_dwordx4 a[116:119], v2, s[44:47], s13 offen offset:1024 sc1
v_and_or_b32 v56, v56, v60, v61
v_and_or_b32 v57, v57, v60, v61
v_and_or_b32 v58, v58, v60, v61
v_and_or_b32 v59, v59, v60, v61
v_mfma_f32_32x32x16_bf16 v[80:95], v[32:35], a[52:55], v[80:95]
ds_read_b128 v[20:23], v4 offset:47104
v_mfma_f32_32x32x16_bf16 v[96:111], v[36:39], a[52:55], v[96:111]
ds_read_b128 v[24:27], v4 offset:48128
v_mfma_f32_16x16x32_bf16 v[160:163], v[28:31], v[56:59], v[160:163]
v_mfma_f32_16x16x32_bf16 v[164:167], v[32:35], v[56:59], v[164:167]
v_mfma_f32_16x16x32_bf16 v[168:171], v[36:39], v[56:59], v[168:171]
s_waitcnt vmcnt(23) lgkmcnt(3)
ds_read_b64 v[56:57], v62 offset:480
ds_read_b64 v[58:59], v62 offset:512
v_mfma_f32_32x32x16_bf16 v[64:79], v[40:43], a[56:59], v[64:79]
ds_read_b128 v[28:31], v4 offset:49152
buffer_load_dwordx4 a[120:123], v2, s[44:47], s13 offen offset:2048 sc1
v_and_or_b32 v52, v52, v60, v61
v_and_or_b32 v53, v53, v60, v61
v_and_or_b32 v54, v54, v60, v61
v_and_or_b32 v55, v55, v60, v61
v_mfma_f32_32x32x16_bf16 v[80:95], v[44:47], a[56:59], v[80:95]
ds_read_b128 v[32:35], v4 offset:50176
v_mfma_f32_32x32x16_bf16 v[96:111], v[48:51], a[56:59], v[96:111]
ds_read_b128 v[36:39], v4 offset:51200
v_mfma_f32_16x16x32_bf16 v[160:163], v[40:43], v[52:55], v[160:163]
v_mfma_f32_16x16x32_bf16 v[164:167], v[44:47], v[52:55], v[164:167]
v_mfma_f32_16x16x32_bf16 v[168:171], v[48:51], v[52:55], v[168:171]
s_waitcnt vmcnt(23) lgkmcnt(3)
ds_read_b64 v[52:53], v62 offset:496
ds_read_b64 v[54:55], v62 offset:528
v_mfma_f32_32x32x16_bf16 v[64:79], v[16:19], a[60:63], v[64:79]
ds_read_b128 v[40:43], v4 offset:52224
buffer_load_dwordx4 a[124:127], v2, s[44:47], s13 offen offset:3072 sc1
v_and_or_b32 v56, v56, v60, v61
v_and_or_b32 v57, v57, v60, v61
v_and_or_b32 v58, v58, v60, v61
v_and_or_b32 v59, v59, v60, v61
v_mfma_f32_32x32x16_bf16 v[80:95], v[20:23], a[60:63], v[80:95]
ds_read_b128 v[44:47], v4 offset:53248
v_mfma_f32_32x32x16_bf16 v[96:111], v[24:27], a[60:63], v[96:111]
ds_read_b128 v[48:51], v4 offset:54272
v_mfma_f32_16x16x32_bf16 v[160:163], v[16:19], v[56:59], v[160:163]
v_mfma_f32_16x16x32_bf16 v[164:167], v[20:23], v[56:59], v[164:167]
v_mfma_f32_16x16x32_bf16 v[168:171], v[24:27], v[56:59], v[168:171]
s_waitcnt vmcnt(15) lgkmcnt(3)
ds_read_b64 v[56:57], v62 offset:544
ds_read_b64 v[58:59], v62 offset:576
v_mfma_f32_32x32x16_bf16 v[64:79], v[28:31], a[64:67], v[64:79]
ds_read_b128 v[16:19], v4 offset:55296
s_add_u32 s13, s13, 4096
buffer_load_dwordx4 a[128:131], v2, s[44:47], s13 offen offset:0 sc1
v_and_or_b32 v52, v52, v60, v61
v_and_or_b32 v53, v53, v60, v61
v_and_or_b32 v54, v54, v60, v61
v_and_or_b32 v55, v55, v60, v61
v_mfma_f32_32x32x16_bf16 v[80:95], v[32:35], a[64:67], v[80:95]
ds_read_b128 v[20:23], v4 offset:56320
v_mfma_f32_32x32x16_bf16 v[96:111], v[36:39], a[64:67], v[96:111]
ds_read_b128 v[24:27], v4 offset:57344
v_mfma_f32_16x16x32_bf16 v[160:163], v[28:31], v[52:55], v[160:163]
v_mfma_f32_16x16x32_bf16 v[164:167], v[32:35], v[52:55], v[164:167]
v_mfma_f32_16x16x32_bf16 v[168:171], v[36:39], v[52:55], v[168:171]
s_waitcnt vmcnt(15) lgkmcnt(3)
ds_read_b64 v[52:53], v62 offset:560
ds_read_b64 v[54:55], v62 offset:592
v_mfma_f32_32x32x16_bf16 v[64:79], v[40:43], a[68:71], v[64:79]
ds_read_b128 v[28:31], v4 offset:58368
buffer_load_dwordx4 a[132:135], v2, s[44:47], s13 offen offset:1024 sc1
v_and_or_b32 v56, v56, v60, v61
v_and_or_b32 v57, v57, v60, v61
v_and_or_b32 v58, v58, v60, v61
v_and_or_b32 v59, v59, v60, v61
v_mfma_f32_32x32x16_bf16 v[80:95], v[44:47], a[68:71], v[80:95]
ds_read_b128 v[32:35], v4 offset:59392
v_mfma_f32_32x32x16_bf16 v[96:111], v[48:51], a[68:71], v[96:111]
ds_read_b128 v[36:39], v4 offset:60416
v_mfma_f32_16x16x32_bf16 v[160:163], v[40:43], v[56:59], v[160:163]
v_mfma_f32_16x16x32_bf16 v[164:167], v[44:47], v[56:59], v[164:167]
v_mfma_f32_16x16x32_bf16 v[168:171], v[48:51], v[56:59], v[168:171]
s_waitcnt vmcnt(15) lgkmcnt(3)
ds_read_b64 v[56:57], v63 offset:608
ds_read_b64 v[58:59], v63 offset:616
v_mfma_f32_32x32x16_bf16 v[64:79], v[16:19], a[72:75], v[64:79]
ds_read_b128 v[40:43], v5 offset:0
buffer_load_dwordx4 a[136:139], v2, s[44:47], s13 offen offset:2048 sc1
v_and_or_b32 v52, v52, v60, v61
v_and_or_b32 v53, v53, v60, v61
v_and_or_b32 v54, v54, v60, v61
v_and_or_b32 v55, v55, v60, v61
v_mfma_f32_32x32x16_bf16 v[80:95], v[20:23], a[72:75], v[80:95]
ds_read_b128 v[44:47], v5 offset:1024
v_mfma_f32_32x32x16_bf16 v[96:111], v[24:27], a[72:75], v[96:111]
ds_read_b128 v[48:51], v5 offset:2048
v_mfma_f32_16x16x32_bf16 v[160:163], v[16:19], v[52:55], v[160:163]
v_mfma_f32_16x16x32_bf16 v[164:167], v[20:23], v[52:55], v[164:167]
v_mfma_f32_16x16x32_bf16 v[168:171], v[24:27], v[52:55], v[168:171]
s_waitcnt vmcnt(15) lgkmcnt(3)
v_mfma_f32_32x32x16_bf16 v[64:79], v[28:31], a[76:79], v[64:79]
ds_read_b128 v[16:19], v5 offset:3072
buffer_load_dwordx4 a[140:143], v2, s[44:47], s13 offen offset:3072 sc1
v_and_or_b32 v56, v56, v60, v61
v_and_or_b32 v57, v57, v60, v61
v_and_or_b32 v58, v58, v60, v61
v_and_or_b32 v59, v59, v60, v61
v_mfma_f32_32x32x16_bf16 v[80:95], v[32:35], a[76:79], v[80:95]
ds_read_b128 v[20:23], v5 offset:4096
v_mfma_f32_32x32x16_bf16 v[96:111], v[36:39], a[76:79], v[96:111]
ds_read_b128 v[24:27], v5 offset:5120
v_mfma_f32_16x16x32_bf16 v[160:163], v[28:31], v[56:59], v[160:163]
v_mfma_f32_16x16x32_bf16 v[164:167], v[32:35], v[56:59], v[164:167]
v_mfma_f32_16x16x32_bf16 v[168:171], v[36:39], v[56:59], v[168:171]
L_gsJ_56:
s_cmp_eq_u32 s4, 2
s_cbranch_scc1 L_gsA_57
s_waitcnt vmcnt(15) lgkmcnt(3)
v_mfma_f32_32x32x16_bf16 v[64:79], v[40:43], a[80:83], v[64:79]
ds_read_b128 v[28:31], v5 offset:6144
s_add_u32 s13, s13, 4096
buffer_load_dwordx4 a[144:147], v2, s[44:47], s13 offen offset:0 sc1
v_mfma_f32_32x32x16_bf16 v[80:95], v[44:47], a[80:83], v[80:95]
ds_read_b128 v[32:35], v5 offset:7168
v_mfma_f32_32x32x16_bf16 v[96:111], v[48:51], a[80:83], v[96:111]
ds_read_b128 v[36:39], v5 offset:8192
s_waitcnt vmcnt(15) lgkmcnt(3)
v_mfma_f32_32x32x16_bf16 v[64:79], v[16:19], a[84:87], v[64:79]
ds_read_b128 v[40:43], v5 offset:9216
buffer_load_dwordx4 a[148:151], v2, s[44:47], s13 offen offset:1024 sc1
v_mfma_f32_32x32x16_bf16 v[80:95], v[20:23], a[84:87], v[80:95]
ds_read_b128 v[44:47], v5 offset:10240
v_mfma_f32_32x32x16_bf16 v[96:111], v[24:27], a[84:87], v[96:111]
ds_read_b128 v[48:51], v5 offset:11264
s_waitcnt vmcnt(15) lgkmcnt(3)
v_mfma_f32_32x32x16_bf16 v[64:79], v[28:31], a[88:91], v[64:79]
ds_read_b128 v[16:19], v5 offset:12288
buffer_load_dwordx4 a[152:155], v2, s[44:47], s13 offen offset:2048 sc1
v_mfma_f32_32x32x16_bf16 v[80:95], v[32:35], a[88:91], v[80:95]
ds_read_b128 v[20:23], v5 offset:13312
v_mfma_f32_32x32x16_bf16 v[96:111], v[36:39], a[88:91], v[96:111]
ds_read_b128 v[24:27], v5 offset:14336
s_waitcnt vmcnt(15) lgkmcnt(3)
v_mfma_f32_32x32x16_bf16 v[64:79], v[40:43], a[92:95], v[64:79]
ds_read_b128 v[28:31], v5 offset:15360
buffer_load_dwordx4 a[156:159], v2, s[44:47], s13 offen offset:3072 sc1
v_mfma_f32_32x32x16_bf16 v[80:95], v[44:47], a[92:95], v[80:95]
ds_read_b128 v[32:35], v5 offset:16384
v_mfma_f32_32x32x16_bf16 v[96:111], v[48:51], a[92:95], v[96:111]
ds_read_b128 v[36:39], v5 offset:17408
s_waitcnt vmcnt(15) lgkmcnt(3)
v_mfma_f32_32x32x16_bf16 v[64:79], v[16:19], a[96:99], v[64:79]
ds_read_b128 v[40:43], v5 offset:18432
v_mfma_f32_32x32x16_bf16 v[80:95], v[20:23], a[96:99], v[80:95]
ds_read_b128 v[44:47], v5 offset:19456
v_mfma_f32_32x32x16_bf16 v[96:111], v[24:27], a[96:99], v[96:111]
ds_read_b128 v[48:51], v5 offset:20480
s_waitcnt vmcnt(14) lgkmcnt(3)
v_mfma_f32_32x32x16_bf16 v[64:79], v[28:31], a[100:103], v[64:79]
ds_read_b128 v[16:19], v5 offset:21504
v_mfma_f32_32x32x16_bf16 v[80:95], v[32:35], a[100:103], v[80:95]
ds_read_b128 v[20:23], v5 offset:22528
v_mfma_f32_32x32x16_bf16 v[96:111], v[36:39], a[100:103], v[96:111]
ds_read_b128 v[24:27], v5 offset:23552
s_waitcnt vmcnt(13) lgkmcnt(3)
v_mfma_f32_32x32x16_bf16 v[64:79], v[40:43], a[104:107], v[64:79]
ds_read_b128 v[28:31], v5 offset:24576
v_mfma_f32_32x32x16_bf16 v[80:95], v[44:47], a[104:107], v[80:95]
ds_read_b128 v[32:35], v5 offset:25600
v_mfma_f32_32x32x16_bf16 v[96:111], v[48:51], a[104:107], v[96:111]
ds_read_b128 v[36:39], v5 offset:26624
s_waitcnt vmcnt(12) lgkmcnt(3)
v_mfma_f32_32x32x16_bf16 v[64:79], v[16:19], a[108:111], v[64:79]
ds_read_b128 v[40:43], v5 offset:27648
v_mfma_f32_32x32x16_bf16 v[80:95], v[20:23], a[108:111], v[80:95]
ds_read_b128 v[44:47], v5 offset:28672
v_mfma_f32_32x32x16_bf16 v[96:111], v[24:27], a[108:111], v[96:111]
ds_read_b128 v[48:51], v5 offset:29696
s_waitcnt vmcnt(11) lgkmcnt(3)
v_mfma_f32_32x32x16_bf16 v[64:79], v[28:31], a[112:115], v[64:79]
ds_read_b128 v[16:19], v5 offset:30720
v_mfma_f32_32x32x16_bf16 v[80:95], v[32:35], a[112:115], v[80:95]
ds_read_b128 v[20:23], v5 offset:31744
v_mfma_f32_32x32x16_bf16 v[96:111], v[36:39], a[112:115], v[96:111]
ds_read_b128 v[24:27], v5 offset:32768
s_waitcnt vmcnt(10) lgkmcnt(3)
v_mfma_f32_32x32x16_bf16 v[64:79], v[40:43], a[116:119], v[64:79]
ds_read_b128 v[28:31], v5 offset:33792
v_mfma_f32_32x32x16_bf16 v[80:95], v[44:47], a[116:119], v[80:95]
ds_read_b128 v[32:35], v5 offset:34816
v_mfma_f32_32x32x16_bf16 v[96:111], v[48:51], a[116:119], v[96:111]
ds_read_b128 v[36:39], v5 offset:35840
s_branch L_gsJ_58
L_gsA_57:
ds_read_b64 v[52:53], v62 offset:640
ds_read_b64 v[54:55], v62 offset:672
s_waitcnt lgkmcnt(0)
s_waitcnt vmcnt(15) lgkmcnt(3)
ds_read_b64 v[56:57], v62 offset:656
ds_read_b64 v[58:59], v62 offset:688
v_mfma_f32_32x32x16_bf16 v[64:79], v[40:43], a[80:83], v[64:79]
ds_read_b128 v[28:31], v5 offset:6144
s_add_u32 s13, s13, 4096
buffer_load_dwordx4 a[144:147], v2, s[44:47], s13 offen offset:0 sc1
v_and_or_b32 v52, v52, v60, v61
v_and_or_b32 v53, v53, v60, v61
v_and_or_b32 v54, v54, v60, v61
v_and_or_b32 v55, v55, v60, v61
v_mfma_f32_32x32x16_bf16 v[80:95], v[44:47], a[80:83], v[80:95]
ds_read_b128 v[32:35], v5 offset:7168
v_mfma_f32_32x32x16_bf16 v[96:111], v[48:51], a[80:83], v[96:111]
ds_read_b128 v[36:39], v5 offset:8192
v_mfma_f32_16x16x32_bf16 v[160:163], v[40:43], v[52:55], 0
v_mfma_f32_16x16x32_bf16 v[164:167], v[44:47], v[52:55], 0
v_mfma_f32_16x16x32_bf16 v[168:171], v[48:51], v[52:55], 0
s_waitcnt vmcnt(15) lgkmcnt(3)
ds_read_b64 v[52:53], v62 offset:704
ds_read_b64 v[54:55], v62 offset:736
v_mfma_f32_32x32x16_bf16 v[64:79], v[16:19], a[84:87], v[64:79]
ds_read_b128 v[40:43], v5 offset:9216
buffer_load_dwordx4 a[148:151], v2, s[44:47], s13 offen offset:1024 sc1
v_and_or_b32 v56, v56, v60, v61
v_and_or_b32 v57, v57, v60, v61
v_and_or_b32 v58, v58, v60, v61
v_and_or_b32 v59, v59, v60, v61
v_mfma_f32_32x32x16_bf16 v[80:95], v[20:23], a[84:87], v[80:95]
ds_read_b128 v[44:47], v5 offset:10240
v_mfma_f32_32x32x16_bf16 v[96:111], v[24:27], a[84:87], v[96:111]
ds_read_b128 v[48:51], v5 offset:11264
v_mfma_f32_16x16x32_bf16 v[160:163], v[16:19], v[56:59], v[160:163]
v_mfma_f32_16x16x32_bf16 v[164:167], v[20:23], v[56:59], v[164:167]
v_mfma_f32_16x16x32_bf16 v[168:171], v[24:27], v[56:59], v[168:171]
s_waitcnt vmcnt(15) lgkmcnt(3)
ds_read_b64 v[56:57], v62 offset:720
ds_read_b64 v[58:59], v62 offset:752
v_mfma_f32_32x32x16_bf16 v[64:79], v[28:31], a[88:91], v[64:79]
ds_read_b128 v[16:19], v5 offset:12288
buffer_load_dwordx4 a[152:155], v2, s[44:47], s13 offen offset:2048 sc1
v_and_or_b32 v52, v52, v60, v61
v_and_or_b32 v53, v53, v60, v61
v_and_or_b32 v54, v54, v60, v61
v_and_or_b32 v55, v55, v60, v61
v_mfma_f32_32x32x16_bf16 v[80:95], v[32:35], a[88:91], v[80:95]
ds_read_b128 v[20:23], v5 offset:13312
v_mfma_f32_32x32x16_bf16 v[96:111], v[36:39], a[88:91], v[96:111]
ds_read_b128 v[24:27], v5 offset:14336
v_mfma_f32_16x16x32_bf16 v[160:163], v[28:31], v[52:55], v[160:163]
v_mfma_f32_16x16x32_bf16 v[164:167], v[32:35], v[52:55], v[164:167]
v_mfma_f32_16x16x32_bf16 v[168:171], v[36:39], v[52:55], v[168:171]
s_waitcnt vmcnt(15) lgkmcnt(3)
ds_read_b64 v[52:53], v63 offset:768
ds_read_b64 v[54:55], v63 offset:776
v_mfma_f32_32x32x16_bf16 v[64:79], v[40:43], a[92:95], v[64:79]
ds_read_b128 v[28:31], v5 offset:15360
buffer_load_dwordx4 a[156:159], v2, s[44:47], s13 offen offset:3072 sc1
v_and_or_b32 v56, v56, v60, v61
v_and_or_b32 v57, v57, v60, v61
v_and_or_b32 v58, v58, v60, v61
v_and_or_b32 v59, v59, v60, v61
v_mfma_f32_32x32x16_bf16 v[80:95], v[44:47], a[92:95], v[80:95]
ds_read_b128 v[32:35], v5 offset:16384
v_mfma_f32_32x32x16_bf16 v[96:111], v[48:51], a[92:95], v[96:111]
ds_read_b128 v[36:39], v5 offset:17408
v_mfma_f32_16x16x32_bf16 v[160:163], v[40:43], v[56:59], v[160:163]
v_mfma_f32_16x16x32_bf16 v[164:167], v[44:47], v[56:59], v[164:167]
v_mfma_f32_16x16x32_bf16 v[168:171], v[48:51], v[56:59], v[168:171]
s_waitcnt vmcnt(15) lgkmcnt(3)
ds_read_b64 v[56:57], v62 offset:800
ds_read_b64 v[58:59], v62 offset:832
v_mfma_f32_32x32x16_bf16 v[64:79], v[16:19], a[96:99], v[64:79]
ds_read_b128 v[40:43], v5 offset:18432
v_and_or_b32 v52, v52, v60, v61
v_and_or_b32 v53, v53, v60, v61
v_and_or_b32 v54, v54, v60, v61
v_and_or_b32 v55, v55, v60, v61
v_mfma_f32_32x32x16_bf16 v[80:95], v[20:23], a[96:99], v[80:95]
ds_read_b128 v[44:47], v5 offset:19456
v_mfma_f32_32x32x16_bf16 v[96:111], v[24:27], a[96:99], v[96:111]
ds_read_b128 v[48:51], v5 offset:20480
v_mfma_f32_16x16x32_bf16 v[160:163], v[16:19], v[52:55], v[160:163]
v_mfma_f32_16x16x32_bf16 v[164:167], v[20:23], v[52:55], v[164:167]
v_mfma_f32_16x16x32_bf16 v[168:171], v[24:27], v[52:55], v[168:171]
s_waitcnt vmcnt(14) lgkmcnt(3)
ds_read_b64 v[52:53], v62 offset:816
ds_read_b64 v[54:55], v62 offset:848
v_mfma_f32_32x32x16_bf16 v[64:79], v[28:31], a[100:103], v[64:79]
ds_read_b128 v[16:19], v5 offset:21504
v_and_or_b32 v56, v56, v60, v61
v_and_or_b32 v57, v57, v60, v61
v_and_or_b32 v58, v58, v60, v61
v_and_or_b32 v59, v59, v60, v61
v_mfma_f32_32x32x16_bf16 v[80:95], v[32:35], a[100:103], v[80:95]
ds_read_b128 v[20:23], v5 offset:22528
v_mfma_f32_32x32x16_bf16 v[96:111], v[36:39], a[100:103], v[96:111]
ds_read_b128 v[24:27], v5 offset:23552
v_mfma_f32_16x16x32_bf16 v[160:163], v[28:31], v[56:59], v[160:163]
v_mfma_f32_16x16x32_bf16 v[164:167], v[32:35], v[56:59], v[164:167]
v_mfma_f32_16x16x32_bf16 v[168:171], v[36:39], v[56:59], v[168:171]
s_waitcnt vmcnt(13) lgkmcnt(3)
ds_read_b64 v[56:57], v62 offset:864
ds_read_b64 v[58:59], v62 offset:896
v_mfma_f32_32x32x16_bf16 v[64:79], v[40:43], a[104:107], v[64:79]
ds_read_b128 v[28:31], v5 offset:24576
v_and_or_b32 v52, v52, v60, v61
v_and_or_b32 v53, v53, v60, v61
v_and_or_b32 v54, v54, v60, v61
v_and_or_b32 v55, v55, v60, v61
v_mfma_f32_32x32x16_bf16 v[80:95], v[44:47], a[104:107], v[80:95]
ds_read_b128 v[32:35], v5 offset:25600
v_mfma_f32_32x32x16_bf16 v[96:111], v[48:51], a[104:107], v[96:111]
ds_read_b128 v[36:39], v5 offset:26624
v_mfma_f32_16x16x32_bf16 v[160:163], v[40:43], v[52:55], v[160:163]
v_mfma_f32_16x16x32_bf16 v[164:167], v[44:47], v[52:55], v[164:167]
v_mfma_f32_16x16x32_bf16 v[168:171], v[48:51], v[52:55], v[168:171]
s_waitcnt vmcnt(12) lgkmcnt(3)
ds_read_b64 v[52:53], v62 offset:880
ds_read_b64 v[54:55], v62 offset:912
v_mfma_f32_32x32x16_bf16 v[64:79], v[16:19], a[108:111], v[64:79]
ds_read_b128 v[40:43], v5 offset:27648
v_and_or_b32 v56, v56, v60, v61
v_and_or_b32 v57, v57, v60, v61
v_and_or_b32 v58, v58, v60, v61
v_and_or_b32 v59, v59, v60, v61
v_mfma_f32_32x32x16_bf16 v[80:95], v[20:23], a[108:111], v[80:95]
ds_read_b128 v[44:47], v5 offset:28672
v_mfma_f32_32x32x16_bf16 v[96:111], v[24:27], a[108:111], v[96:111]
ds_read_b128 v[48:51], v5 offset:29696
v_mfma_f32_16x16x32_bf16 v[160:163], v[16:19], v[56:59], v[160:163]
v_mfma_f32_16x16x32_bf16 v[164:167], v[20:23], v[56:59], v[164:167]
v_mfma_f32_16x16x32_bf16 v[168:171], v[24:27], v[56:59], v[168:171]
s_waitcnt vmcnt(11) lgkmcnt(3)
ds_read_b64 v[56:57], v63 offset:928
ds_read_b64 v[58:59], v63 offset:936
v_mfma_f32_32x32x16_bf16 v[64:79], v[28:31], a[112:115], v[64:79]
ds_read_b128 v[16:19], v5 offset:30720
v_and_or_b32 v52, v52, v60, v61
v_and_or_b32 v53, v53, v60, v61
v_and_or_b32 v54, v54, v60, v61
v_and_or_b32 v55, v55, v60, v61
v_mfma_f32_32x32x16_bf16 v[80:95], v[32:35], a[112:115], v[80:95]
ds_read_b128 v[20:23], v5 offset:31744
v_mfma_f32_32x32x16_bf16 v[96:111], v[36:39], a[112:115], v[96:111]
ds_read_b128 v[24:27], v5 offset:32768
v_mfma_f32_16x16x32_bf16 v[160:163], v[28:31], v[52:55], v[160:163]
v_mfma_f32_16x16x32_bf16 v[164:167], v[32:35], v[52:55], v[164:167]
v_mfma_f32_16x16x32_bf16 v[168:171], v[36:39], v[52:55], v[168:171]
s_waitcnt vmcnt(10) lgkmcnt(3)
v_mfma_f32_32x32x16_bf16 v[64:79], v[40:43], a[116:119], v[64:79]
ds_read_b128 v[28:31], v5 offset:33792
v_and_or_b32 v56, v56, v60, v61
v_and_or_b32 v57, v57, v60, v61
v_and_or_b32 v58, v58, v60, v61
v_and_or_b32 v59, v59, v60, v61
v_mfma_f32_32x32x16_bf16 v[80:95], v[44:47], a[116:119], v[80:95]
ds_read_b128 v[32:35], v5 offset:34816
v_mfma_f32_32x32x16_bf16 v[96:111], v[48:51], a[116:119], v[96:111]
ds_read_b128 v[36:39], v5 offset:35840
v_mfma_f32_16x16x32_bf16 v[160:163], v[40:43], v[56:59], v[160:163]
v_mfma_f32_16x16x32_bf16 v[164:167], v[44:47], v[56:59], v[164:167]
v_mfma_f32_16x16x32_bf16 v[168:171], v[48:51], v[56:59], v[168:171]
L_gsJ_58:
s_cmp_eq_u32 s4, 3
s_cbranch_scc1 L_gsA_59
s_waitcnt vmcnt(9) lgkmcnt(3)
v_mfma_f32_32x32x16_bf16 v[64:79], v[16:19], a[120:123], v[64:79]
ds_read_b128 v[40:43], v5 offset:36864
v_mfma_f32_32x32x16_bf16 v[80:95], v[20:23], a[120:123], v[80:95]
ds_read_b128 v[44:47], v5 offset:37888
v_mfma_f32_32x32x16_bf16 v[96:111], v[24:27], a[120:123], v[96:111]
ds_read_b128 v[48:51], v5 offset:38912
s_waitcnt vmcnt(8) lgkmcnt(3)
v_mfma_f32_32x32x16_bf16 v[64:79], v[28:31], a[124:127], v[64:79]
ds_read_b128 v[16:19], v5 offset:39936
v_mfma_f32_32x32x16_bf16 v[80:95], v[32:35], a[124:127], v[80:95]
ds_read_b128 v[20:23], v5 offset:40960
v_mfma_f32_32x32x16_bf16 v[96:111], v[36:39], a[124:127], v[96:111]
ds_read_b128 v[24:27], v5 offset:41984
s_waitcnt vmcnt(7) lgkmcnt(3)
v_mfma_f32_32x32x16_bf16 v[64:79], v[40:43], a[128:131], v[64:79]
ds_read_b128 v[28:31], v5 offset:43008
v_mfma_f32_32x32x16_bf16 v[80:95], v[44:47], a[128:131], v[80:95]
ds_read_b128 v[32:35], v5 offset:44032
v_mfma_f32_32x32x16_bf16 v[96:111], v[48:51], a[128:131], v[96:111]
ds_read_b128 v[36:39], v5 offset:45056
s_waitcnt vmcnt(6) lgkmcnt(3)
v_mfma_f32_32x32x16_bf16 v[64:79], v[16:19], a[132:135], v[64:79]
ds_read_b128 v[40:43], v5 offset:46080
v_mfma_f32_32x32x16_bf16 v[80:95], v[20:23], a[132:135], v[80:95]
ds_read_b128 v[44:47], v5 offset:47104
v_mfma_f32_32x32x16_bf16 v[96:111], v[24:27], a[132:135], v[96:111]
ds_read_b128 v[48:51], v5 offset:48128
s_waitcnt vmcnt(5) lgkmcnt(3)
v_mfma_f32_32x32x16_bf16 v[64:79], v[28:31], a[136:139], v[64:79]
ds_read_b128 v[16:19], v5 offset:49152
v_mfma_f32_32x32x16_bf16 v[80:95], v[32:35], a[136:139], v[80:95]
ds_read_b128 v[20:23], v5 offset:50176
v_mfma_f32_32x32x16_bf16 v[96:111], v[36:39], a[136:139], v[96:111]
ds_read_b128 v[24:27], v5 offset:51200
s_waitcnt vmcnt(4) lgkmcnt(3)
v_mfma_f32_32x32x16_bf16 v[64:79], v[40:43], a[140:143], v[64:79]
ds_read_b128 v[28:31], v5 offset:52224
v_mfma_f32_32x32x16_bf16 v[80:95], v[44:47], a[140:143], v[80:95]
ds_read_b128 v[32:35], v5 offset:53248
v_mfma_f32_32x32x16_bf16 v[96:111], v[48:51], a[140:143], v[96:111]
ds_read_b128 v[36:39], v5 offset:54272
s_waitcnt vmcnt(3) lgkmcnt(3)
v_mfma_f32_32x32x16_bf16 v[64:79], v[16:19], a[144:147], v[64:79]
ds_read_b128 v[40:43], v5 offset:55296
v_mfma_f32_32x32x16_bf16 v[80:95], v[20:23], a[144:147], v[80:95]
ds_read_b128 v[44:47], v5 offset:56320
v_mfma_f32_32x32x16_bf16 v[96:111], v[24:27], a[144:147], v[96:111]
ds_read_b128 v[48:51], v5 offset:57344
s_waitcnt vmcnt(2) lgkmcnt(3)
v_mfma_f32_32x32x16_bf16 v[64:79], v[28:31], a[148:151], v[64:79]
ds_read_b128 v[16:19], v5 offset:58368
v_mfma_f32_32x32x16_bf16 v[80:95], v[32:35], a[148:151], v[80:95]
ds_read_b128 v[20:23], v5 offset:59392
v_mfma_f32_32x32x16_bf16 v[96:111], v[36:39], a[148:151], v[96:111]
ds_read_b128 v[24:27], v5 offset:60416
s_waitcnt vmcnt(1) lgkmcnt(3)
v_mfma_f32_32x32x16_bf16 v[64:79], v[40:43], a[152:155], v[64:79]
v_mfma_f32_32x32x16_bf16 v[80:95], v[44:47], a[152:155], v[80:95]
v_mfma_f32_32x32x16_bf16 v[96:111], v[48:51], a[152:155], v[96:111]
s_waitcnt vmcnt(0) lgkmcnt(0)
v_mfma_f32_32x32x16_bf16 v[64:79], v[16:19], a[156:159], v[64:79]
v_mfma_f32_32x32x16_bf16 v[80:95], v[20:23], a[156:159], v[80:95]
v_mfma_f32_32x32x16_bf16 v[96:111], v[24:27], a[156:159], v[96:111]
s_branch L_gsJ_60
L_gsA_59:
ds_read_b64 v[52:53], v62 offset:960
ds_read_b64 v[54:55], v62 offset:992
s_waitcnt lgkmcnt(0)
s_waitcnt vmcnt(9) lgkmcnt(3)
ds_read_b64 v[56:57], v62 offset:976
ds_read_b64 v[58:59], v62 offset:1008
v_mfma_f32_32x32x16_bf16 v[64:79], v[16:19], a[120:123], v[64:79]
ds_read_b128 v[40:43], v5 offset:36864
v_and_or_b32 v52, v52, v60, v61
v_and_or_b32 v53, v53, v60, v61
v_and_or_b32 v54, v54, v60, v61
v_and_or_b32 v55, v55, v60, v61
v_mfma_f32_32x32x16_bf16 v[80:95], v[20:23], a[120:123], v[80:95]
ds_read_b128 v[44:47], v5 offset:37888
v_mfma_f32_32x32x16_bf16 v[96:111], v[24:27], a[120:123], v[96:111]
ds_read_b128 v[48:51], v5 offset:38912
v_mfma_f32_16x16x32_bf16 v[160:163], v[16:19], v[52:55], 0
v_mfma_f32_16x16x32_bf16 v[164:167], v[20:23], v[52:55], 0
v_mfma_f32_16x16x32_bf16 v[168:171], v[24:27], v[52:55], 0
s_waitcnt vmcnt(8) lgkmcnt(3)
ds_read_b64 v[52:53], v62 offset:1024
ds_read_b64 v[54:55], v62 offset:1056
v_mfma_f32_32x32x16_bf16 v[64:79], v[28:31], a[124:127], v[64:79]
ds_read_b128 v[16:19], v5 offset:39936
v_and_or_b32 v56, v56, v60, v61
v_and_or_b32 v57, v57, v60, v61
v_and_or_b32 v58, v58, v60, v61
v_and_or_b32 v59, v59, v60, v61
v_mfma_f32_32x32x16_bf16 v[80:95], v[32:35], a[124:127], v[80:95]
ds_read_b128 v[20:23], v5 offset:40960
v_mfma_f32_32x32x16_bf16 v[96:111], v[36:39], a[124:127], v[96:111]
ds_read_b128 v[24:27], v5 offset:41984
v_mfma_f32_16x16x32_bf16 v[160:163], v[28:31], v[56:59], v[160:163]
v_mfma_f32_16x16x32_bf16 v[164:167], v[32:35], v[56:59], v[164:167]
v_mfma_f32_16x16x32_bf16 v[168:171], v[36:39], v[56:59], v[168:171]
s_waitcnt vmcnt(7) lgkmcnt(3)
ds_read_b64 v[56:57], v62 offset:1040
ds_read_b64 v[58:59], v62 offset:1072
v_mfma_f32_32x32x16_bf16 v[64:79], v[40:43], a[128:131], v[64:79]
ds_read_b128 v[28:31], v5 offset:43008
v_and_or_b32 v52, v52, v60, v61
v_and_or_b32 v53, v53, v60, v61
v_and_or_b32 v54, v54, v60, v61
v_and_or_b32 v55, v55, v60, v61
v_mfma_f32_32x32x16_bf16 v[80:95], v[44:47], a[128:131], v[80:95]
ds_read_b128 v[32:35], v5 offset:44032
v_mfma_f32_32x32x16_bf16 v[96:111], v[48:51], a[128:131], v[96:111]
ds_read_b128 v[36:39], v5 offset:45056
v_mfma_f32_16x16x32_bf16 v[160:163], v[40:43], v[52:55], v[160:163]
v_mfma_f32_16x16x32_bf16 v[164:167], v[44:47], v[52:55], v[164:167]
v_mfma_f32_16x16x32_bf16 v[168:171], v[48:51], v[52:55], v[168:171]
s_waitcnt vmcnt(6) lgkmcnt(3)
ds_read_b64 v[52:53], v63 offset:1088
ds_read_b64 v[54:55], v63 offset:1096
v_mfma_f32_32x32x16_bf16 v[64:79], v[16:19], a[132:135], v[64:79]
ds_read_b128 v[40:43], v5 offset:46080
v_and_or_b32 v56, v56, v60, v61
v_and_or_b32 v57, v57, v60, v61
v_and_or_b32 v58, v58, v60, v61
v_and_or_b32 v59, v59, v60, v61
v_mfma_f32_32x32x16_bf16 v[80:95], v[20:23], a[132:135], v[80:95]
ds_read_b128 v[44:47], v5 offset:47104
v_mfma_f32_32x32x16_bf16 v[96:111], v[24:27], a[132:135], v[96:111]
ds_read_b128 v[48:51], v5 offset:48128
v_mfma_f32_16x16x32_bf16 v[160:163], v[16:19], v[56:59], v[160:163]
v_mfma_f32_16x16x32_bf16 v[164:167], v[20:23], v[56:59], v[164:167]
v_mfma_f32_16x16x32_bf16 v[168:171], v[24:27], v[56:59], v[168:171]
s_waitcnt vmcnt(5) lgkmcnt(3)
ds_read_b64 v[56:57], v62 offset:1120
ds_read_b64 v[58:59], v62 offset:1152
v_mfma_f32_32x32x16_bf16 v[64:79], v[28:31], a[136:139], v[64:79]
ds_read_b128 v[16:19], v5 offset:49152
v_and_or_b32 v52, v52, v60, v61
v_and_or_b32 v53, v53, v60, v61
v_and_or_b32 v54, v54, v60, v61
v_and_or_b32 v55, v55, v60, v61
v_mfma_f32_32x32x16_bf16 v[80:95], v[32:35], a[136:139], v[80:95]
ds_read_b128 v[20:23], v5 offset:50176
v_mfma_f32_32x32x16_bf16 v[96:111], v[36:39], a[136:139], v[96:111]
ds_read_b128 v[24:27], v5 offset:51200
v_mfma_f32_16x16x32_bf16 v[160:163], v[28:31], v[52:55], v[160:163]
v_mfma_f32_16x16x32_bf16 v[164:167], v[32:35], v[52:55], v[164:167]
v_mfma_f32_16x16x32_bf16 v[168:171], v[36:39], v[52:55], v[168:171]
s_waitcnt vmcnt(4) lgkmcnt(3)
ds_read_b64 v[52:53], v62 offset:1136
ds_read_b64 v[54:55], v62 offset:1168
v_mfma_f32_32x32x16_bf16 v[64:79], v[40:43], a[140:143], v[64:79]
ds_read_b128 v[28:31], v5 offset:52224
v_and_or_b32 v56, v56, v60, v61
v_and_or_b32 v57, v57, v60, v61
v_and_or_b32 v58, v58, v60, v61
v_and_or_b32 v59, v59, v60, v61
v_mfma_f32_32x32x16_bf16 v[80:95], v[44:47], a[140:143], v[80:95]
ds_read_b128 v[32:35], v5 offset:53248
v_mfma_f32_32x32x16_bf16 v[96:111], v[48:51], a[140:143], v[96:111]
ds_read_b128 v[36:39], v5 offset:54272
v_mfma_f32_16x16x32_bf16 v[160:163], v[40:43], v[56:59], v[160:163]
v_mfma_f32_16x16x32_bf16 v[164:167], v[44:47], v[56:59], v[164:167]
v_mfma_f32_16x16x32_bf16 v[168:171], v[48:51], v[56:59], v[168:171]
s_waitcnt vmcnt(3) lgkmcnt(3)
ds_read_b64 v[56:57], v62 offset:1184
ds_read_b64 v[58:59], v62 offset:1216
v_mfma_f32_32x32x16_bf16 v[64:79], v[16:19], a[144:147], v[64:79]
ds_read_b128 v[40:43], v5 offset:55296
v_and_or_b32 v52, v52, v60, v61
v_and_or_b32 v53, v53, v60, v61
v_and_or_b32 v54, v54, v60, v61
v_and_or_b32 v55, v55, v60, v61
v_mfma_f32_32x32x16_bf16 v[80:95], v[20:23], a[144:147], v[80:95]
ds_read_b128 v[44:47], v5 offset:56320
v_mfma_f32_32x32x16_bf16 v[96:111], v[24:27], a[144:147], v[96:111]
ds_read_b128 v[48:51], v5 offset:57344
v_mfma_f32_16x16x32_bf16 v[160:163], v[16:19], v[52:55], v[160:163]
v_mfma_f32_16x16x32_bf16 v[164:167], v[20:23], v[52:55], v[164:167]
v_mfma_f32_16x16x32_bf16 v[168:171], v[24:27], v[52:55], v[168:171]
s_waitcnt vmcnt(2) lgkmcnt(3)
ds_read_b64 v[52:53], v62 offset:1200
ds_read_b64 v[54:55], v62 offset:1232
v_mfma_f32_32x32x16_bf16 v[64:79], v[28:31], a[148:151], v[64:79]
ds_read_b128 v[16:19], v5 offset:58368
v_and_or_b32 v56, v56, v60, v61
v_and_or_b32 v57, v57, v60, v61
v_and_or_b32 v58, v58, v60, v61
v_and_or_b32 v59, v59, v60, v61
v_mfma_f32_32x32x16_bf16 v[80:95], v[32:35], a[148:151], v[80:95]
ds_read_b128 v[20:23], v5 offset:59392
v_mfma_f32_32x32x16_bf16 v[96:111], v[36:39], a[148:151], v[96:111]
ds_read_b128 v[24:27], v5 offset:60416
v_mfma_f32_16x16x32_bf16 v[160:163], v[28:31], v[56:59], v[160:163]
v_mfma_f32_16x16x32_bf16 v[164:167], v[32:35], v[56:59], v[164:167]
v_mfma_f32_16x16x32_bf16 v[168:171], v[36:39], v[56:59], v[168:171]
s_waitcnt vmcnt(1) lgkmcnt(3)
ds_read_b64 v[56:57], v63 offset:1248
ds_read_b64 v[58:59], v63 offset:1256
v_mfma_f32_32x32x16_bf16 v[64:79], v[40:43], a[152:155], v[64:79]
v_and_or_b32 v52, v52, v60, v61
v_and_or_b32 v53, v53, v60, v61
v_and_or_b32 v54, v54, v60, v61
v_and_or_b32 v55, v55, v60, v61
v_mfma_f32_32x32x16_bf16 v[80:95], v[44:47], a[152:155], v[80:95]
v_mfma_f32_32x32x16_bf16 v[96:111], v[48:51], a[152:155], v[96:111]
v_mfma_f32_16x16x32_bf16 v[160:163], v[40:43], v[52:55], v[160:163]
v_mfma_f32_16x16x32_bf16 v[164:167], v[44:47], v[52:55], v[164:167]
v_mfma_f32_16x16x32_bf16 v[168:171], v[48:51], v[52:55], v[168:171]
s_waitcnt vmcnt(0) lgkmcnt(0)
v_mfma_f32_32x32x16_bf16 v[64:79], v[16:19], a[156:159], v[64:79]
v_and_or_b32 v56, v56, v60, v61
v_and_or_b32 v57, v57, v60, v61
v_and_or_b32 v58, v58, v60, v61
v_and_or_b32 v59, v59, v60, v61
v_mfma_f32_32x32x16_bf16 v[80:95], v[20:23], a[156:159], v[80:95]
v_mfma_f32_32x32x16_bf16 v[96:111], v[24:27], a[156:159], v[96:111]
v_mfma_f32_16x16x32_bf16 v[160:163], v[16:19], v[56:59], v[160:163]
v_mfma_f32_16x16x32_bf16 v[164:167], v[20:23], v[56:59], v[164:167]
v_mfma_f32_16x16x32_bf16 v[168:171], v[24:27], v[56:59], v[168:171]
L_gsJ_60:
v_and_b32 v8, 15, v1
v_lshrrev_b32 v9, 4, v1
v_lshrrev_b32 v10, 1, v8
v_mul_u32_u24 v10, 384, v10
v_and_b32 v11, 1, v8
v_lshl_add_u32 v10, v11, 6, v10
v_lshl_add_u32 v10, v9, 4, v10
s_mul_i32 s14, s4, 1152
s_add_u32 s14, s14, 158976
v_add_u32 v10, s14, v10
v_cmp_gt_u32 vcc, 6, v8
s_nop 3
s_and_saveexec_b64 s[66:67], vcc
s_nop 4
ds_write_b128 v10, v[160:163] offset:0
ds_write_b128 v10, v[164:167] offset:128
ds_write_b128 v10, v[168:171] offset:256
s_mov_b64 exec, s[66:67]
s_waitcnt lgkmcnt(0)
s_barrier
v_lshlrev_b32 v8, 4, v0
v_min_u32 v8, 71*16, v8
v_add_u32 v9, 158976, v8
ds_read_b128 v[16:19], v9
ds_read_b128 v[20:23], v9 offset:1152
ds_read_b128 v[24:27], v9 offset:2304
ds_read_b128 v[28:31], v9 offset:3456
v_add_u32 v15, 157824, v8
v_add_f32 v116, v116, v120
v_add_f32 v124, v124, v128
v_add_f32 v132, v132, v136
v_add_f32 v140, v140, v144
v_add_f32 v116, v116, v124
v_add_f32 v132, v132, v140
v_add_f32 v116, v116, v132
v_add_f32 v117, v117, v121
v_add_f32 v125, v125, v129
v_add_f32 v133, v133, v137
v_add_f32 v141, v141, v145
v_add_f32 v117, v117, v125
v_add_f32 v133, v133, v141
v_add_f32 v117, v117, v133
v_add_f32 v118, v118, v122
v_add_f32 v126, v126, v130
v_add_f32 v134, v134, v138
v_add_f32 v142, v142, v146
v_add_f32 v118, v118, v126
v_add_f32 v134, v134, v142
v_add_f32 v118, v118, v134
v_add_f32 v119, v119, v123
v_add_f32 v127, v127, v131
v_add_f32 v135, v135, v139
v_add_f32 v143, v143, v147
v_add_f32 v119, v119, v127
v_add_f32 v135, v135, v143
v_add_f32 v119, v119, v135
v_mov_b32 v120, v116
v_mov_b32 v121, v117
v_mov_b32 v122, v118
v_mov_b32 v123, v119
v_permlane32_swap_b32 v116, v120
v_permlane32_swap_b32 v117, v121
v_permlane32_swap_b32 v118, v122
v_permlane32_swap_b32 v119, v123
v_mul_f32 v124, 0x3acccccd, v116
v_mul_f32 v125, 0x3acccccd, v118
v_fma_f32 v125, -v124, v124, v125
v_max_f32 v125, 0, v125
v_add_f32 v125, 0x3727c5ac, v125
v_rsq_f32 v125, v125
v_fma_f32 v126, -v124, v148, v117
v_fma_f32 v126, v126, v125, v151
v_mul_f32 v126, 0x3acccccd, v126
v_mul_f32 v127, v124, v149
v_fma_f32 v127, -2.0, v120, v127
v_fma_f32 v127, v124, v127, v119
v_mul_f32 v127, v127, v125
v_fma_f32 v128, -v124, v150, v122
v_fma_f32 v127, 2.0, v128, v127
v_fma_f32 v127, v127, v125, v152
v_mul_f32 v127, 0x3acccccd, v127
v_fma_f32 v127, -v126, v126, v127
v_max_f32 v127, 0, v127
v_add_f32 v127, 0x3727c5ac, v127
v_rsq_f32 v127, v127
s_nop 0
v_mul_f32 v116, v125, v127
v_mul_f32 v117, v116, v124
v_sub_f32 v117, 0, v117
v_mov_b32 v118, v127
v_mul_f32 v119, v127, v126
v_sub_f32 v119, 0, v119
s_waitcnt lgkmcnt(0)
v_add_f32 v16, v16, v20
v_add_f32 v24, v24, v28
v_add_f32 v16, v16, v24
v_add_f32 v17, v17, v21
v_add_f32 v25, v25, v29
v_add_f32 v17, v17, v25
v_add_f32 v18, v18, v22
v_add_f32 v26, v26, v30
v_add_f32 v18, v18, v26
v_add_f32 v19, v19, v23
v_add_f32 v27, v27, v31
v_add_f32 v19, v19, v27
v_cmp_gt_u32 vcc, 72, v0
s_nop 3
s_and_saveexec_b64 s[66:67], vcc
ds_write_b128 v15, v[16:19]
s_mov_b64 exec, s[66:67]
s_waitcnt lgkmcnt(0)
s_barrier
v_lshrrev_b32 v8, 5, v1
v_lshlrev_b32 v9, 4, v8
v_add_u32 v9, 154880, v9
v_and_b32 v10, 15, v1
v_bfe_u32 v11, v1, 4, 1
s_lshl_b32 s13, s12, 1
v_add_u32 v11, s13, v11
v_mul_u32_u24 v11, 49152, v11
v_lshl_add_u32 v11, v10, 4, v11
v_lshl_add_u32 v11, v8, 8, v11
s_mul_i32 s13, s11, 3072
s_add_u32 s13, s13, 0x1000000
s_nop 0
v_mov_b32 v120, v117
v_mov_b32 v122, v118
v_mov_b32 v124, v119
v_mov_b32 v126, 0xbdd2d3e8
v_mov_b32 v128, 0xc0135761
v_mov_b32 v130, 1.0
v_mov_b32 v131, 1.0
ds_read_b128 v[16:19], v9 offset:2944
ds_read_b128 v[20:23], v9 offset:3328
ds_read_b128 v[24:27], v9 offset:3712
ds_read_b128 v[28:31], v9 offset:0
ds_read_b128 v[32:35], v9 offset:2976
ds_read_b128 v[36:39], v9 offset:3360
ds_read_b128 v[40:43], v9 offset:3744
ds_read_b128 v[44:47], v9 offset:32
s_waitcnt lgkmcnt(4)
v_pk_fma_f32 v[64:65], v[116:117], v[64:65], v[28:29] op_sel_hi:[0,1,1]
v_pk_fma_f32 v[66:67], v[116:117], v[66:67], v[30:31] op_sel_hi:[0,1,1]
v_pk_fma_f32 v[64:65], v[120:121], v[16:17], v[64:65] op_sel_hi:[0,1,1]
v_pk_fma_f32 v[66:67], v[120:121], v[18:19], v[66:67] op_sel_hi:[0,1,1]
v_pk_fma_f32 v[64:65], v[122:123], v[20:21], v[64:65] op_sel_hi:[0,1,1]
v_pk_fma_f32 v[66:67], v[122:123], v[22:23], v[66:67] op_sel_hi:[0,1,1]
v_pk_fma_f32 v[64:65], v[124:125], v[24:25], v[64:65] op_sel_hi:[0,1,1]
v_pk_fma_f32 v[66:67], v[124:125], v[26:27], v[66:67] op_sel_hi:[0,1,1]
v_pk_mul_f32 v[48:49], v[64:65], v[64:65]
v_pk_mul_f32 v[50:51], v[66:67], v[66:67]
v_pk_fma_f32 v[48:49], v[126:127], v[48:49], v[128:129] op_sel_hi:[0,1,0]
v_pk_fma_f32 v[50:51], v[126:127], v[50:51], v[128:129] op_sel_hi:[0,1,0]
v_pk_mul_f32 v[48:49], v[64:65], v[48:49]
v_pk_mul_f32 v[50:51], v[66:67], v[50:51]
v_exp_f32 v48, v48
v_exp_f32 v49, v49
v_exp_f32 v50, v50
v_exp_f32 v51, v51
v_pk_add_f32 v[48:49], v[48:49], v[130:131]
v_pk_add_f32 v[50:51], v[50:51], v[130:131]
v_rcp_f32 v48, v48
v_rcp_f32 v49, v49
v_rcp_f32 v50, v50
v_rcp_f32 v51, v51
v_pk_mul_f32 v[64:65], v[64:65], v[48:49]
v_pk_mul_f32 v[66:67], v[66:67], v[50:51]
v_cvt_pk_bf16_f32 v52, v64, v65
v_cvt_pk_bf16_f32 v53, v66, v67
ds_read_b128 v[16:19], v9 offset:3008
ds_read_b128 v[20:23], v9 offset:3392
ds_read_b128 v[24:27], v9 offset:3776
ds_read_b128 v[28:31], v9 offset:64
s_waitcnt lgkmcnt(4)
v_pk_fma_f32 v[68:69], v[116:117], v[68:69], v[44:45] op_sel_hi:[0,1,1]
v_pk_fma_f32 v[70:71], v[116:117], v[70:71], v[46:47] op_sel_hi:[0,1,1]
v_pk_fma_f32 v[68:69], v[120:121], v[32:33], v[68:69] op_sel_hi:[0,1,1]
v_pk_fma_f32 v[70:71], v[120:121], v[34:35], v[70:71] op_sel_hi:[0,1,1]
v_pk_fma_f32 v[68:69], v[122:123], v[36:37], v[68:69] op_sel_hi:[0,1,1]
v_pk_fma_f32 v[70:71], v[122:123], v[38:39], v[70:71] op_sel_hi:[0,1,1]
v_pk_fma_f32 v[68:69], v[124:125], v[40:41], v[68:69] op_sel_hi:[0,1,1]
v_pk_fma_f32 v[70:71], v[124:125], v[42:43], v[70:71] op_sel_hi:[0,1,1]
v_pk_mul_f32 v[48:49], v[68:69], v[68:69]
v_pk_mul_f32 v[50:51], v[70:71], v[70:71]
v_pk_fma_f32 v[48:49], v[126:127], v[48:49], v[128:129] op_sel_hi:[0,1,0]
v_pk_fma_f32 v[50:51], v[126:127], v[50:51], v[128:129] op_sel_hi:[0,1,0]
v_pk_mul_f32 v[48:49], v[68:69], v[48:49]
v_pk_mul_f32 v[50:51], v[70:71], v[50:51]
v_exp_f32 v48, v48
v_exp_f32 v49, v49
v_exp_f32 v50, v50
v_exp_f32 v51, v51
v_pk_add_f32 v[48:49], v[48:49], v[130:131]
v_pk_add_f32 v[50:51], v[50:51], v[130:131]
v_rcp_f32 v48, v48
v_rcp_f32 v49, v49
v_rcp_f32 v50, v50
v_rcp_f32 v51, v51
v_pk_mul_f32 v[68:69], v[68:69], v[48:49]
v_pk_mul_f32 v[70:71], v[70:71], v[50:51]
v_cvt_pk_bf16_f32 v54, v68, v69
v_cvt_pk_bf16_f32 v55, v70, v71
buffer_store_dwordx4 v[52:55], v11, s[44:47], s13 offen offset:0 sc1
ds_read_b128 v[32:35], v9 offset:3040
ds_read_b128 v[36:39], v9 offset:3424
ds_read_b128 v[40:43], v9 offset:3808
ds_read_b128 v[44:47], v9 offset:96
s_waitcnt lgkmcnt(4)
v_pk_fma_f32 v[72:73], v[116:117], v[72:73], v[28:29] op_sel_hi:[0,1,1]
v_pk_fma_f32 v[74:75], v[116:117], v[74:75], v[30:31] op_sel_hi:[0,1,1]
v_pk_fma_f32 v[72:73], v[120:121], v[16:17], v[72:73] op_sel_hi:[0,1,1]
v_pk_fma_f32 v[74:75], v[120:121], v[18:19], v[74:75] op_sel_hi:[0,1,1]
v_pk_fma_f32 v[72:73], v[122:123], v[20:21], v[72:73] op_sel_hi:[0,1,1]
v_pk_fma_f32 v[74:75], v[122:123], v[22:23], v[74:75] op_sel_hi:[0,1,1]
v_pk_fma_f32 v[72:73], v[124:125], v[24:25], v[72:73] op_sel_hi:[0,1,1]
v_pk_fma_f32 v[74:75], v[124:125], v[26:27], v[74:75] op_sel_hi:[0,1,1]
v_pk_mul_f32 v[48:49], v[72:73], v[72:73]
v_pk_mul_f32 v[50:51], v[74:75], v[74:75]
v_pk_fma_f32 v[48:49], v[126:127], v[48:49], v[128:129] op_sel_hi:[0,1,0]
v_pk_fma_f32 v[50:51], v[126:127], v[50:51], v[128:129] op_sel_hi:[0,1,0]
v_pk_mul_f32 v[48:49], v[72:73], v[48:49]
v_pk_mul_f32 v[50:51], v[74:75], v[50:51]
v_exp_f32 v48, v48
v_exp_f32 v49, v49
v_exp_f32 v50, v50
v_exp_f32 v51, v51
v_pk_add_f32 v[48:49], v[48:49], v[130:131]
v_pk_add_f32 v[50:51], v[50:51], v[130:131]
v_rcp_f32 v48, v48
v_rcp_f32 v49, v49
v_rcp_f32 v50, v50
v_rcp_f32 v51, v51
v_pk_mul_f32 v[72:73], v[72:73], v[48:49]
v_pk_mul_f32 v[74:75], v[74:75], v[50:51]
v_cvt_pk_bf16_f32 v56, v72, v73
v_cvt_pk_bf16_f32 v57, v74, v75
ds_read_b128 v[16:19], v9 offset:3072
ds_read_b128 v[20:23], v9 offset:3456
ds_read_b128 v[24:27], v9 offset:3840
ds_read_b128 v[28:31], v9 offset:128
s_waitcnt lgkmcnt(4)
v_pk_fma_f32 v[76:77], v[116:117], v[76:77], v[44:45] op_sel_hi:[0,1,1]
v_pk_fma_f32 v[78:79], v[116:117], v[78:79], v[46:47] op_sel_hi:[0,1,1]
v_pk_fma_f32 v[76:77], v[120:121], v[32:33], v[76:77] op_sel_hi:[0,1,1]
v_pk_fma_f32 v[78:79], v[120:121], v[34:35], v[78:79] op_sel_hi:[0,1,1]
v_pk_fma_f32 v[76:77], v[122:123], v[36:37], v[76:77] op_sel_hi:[0,1,1]
v_pk_fma_f32 v[78:79], v[122:123], v[38:39], v[78:79] op_sel_hi:[0,1,1]
v_pk_fma_f32 v[76:77], v[124:125], v[40:41], v[76:77] op_sel_hi:[0,1,1]
v_pk_fma_f32 v[78:79], v[124:125], v[42:43], v[78:79] op_sel_hi:[0,1,1]
v_pk_mul_f32 v[48:49], v[76:77], v[76:77]
v_pk_mul_f32 v[50:51], v[78:79], v[78:79]
v_pk_fma_f32 v[48:49], v[126:127], v[48:49], v[128:129] op_sel_hi:[0,1,0]
v_pk_fma_f32 v[50:51], v[126:127], v[50:51], v[128:129] op_sel_hi:[0,1,0]
v_pk_mul_f32 v[48:49], v[76:77], v[48:49]
v_pk_mul_f32 v[50:51], v[78:79], v[50:51]
v_exp_f32 v48, v48
v_exp_f32 v49, v49
v_exp_f32 v50, v50
v_exp_f32 v51, v51
v_pk_add_f32 v[48:49], v[48:49], v[130:131]
v_pk_add_f32 v[50:51], v[50:51], v[130:131]
v_rcp_f32 v48, v48
v_rcp_f32 v49, v49
v_rcp_f32 v50, v50
v_rcp_f32 v51, v51
v_pk_mul_f32 v[76:77], v[76:77], v[48:49]
v_pk_mul_f32 v[78:79], v[78:79], v[50:51]
v_cvt_pk_bf16_f32 v58, v76, v77
v_cvt_pk_bf16_f32 v59, v78, v79
buffer_store_dwordx4 v[56:59], v11, s[44:47], s13 offen offset:512 sc1
ds_read_b128 v[32:35], v9 offset:3104
ds_read_b128 v[36:39], v9 offset:3488
ds_read_b128 v[40:43], v9 offset:3872
ds_read_b128 v[44:47], v9 offset:160
s_waitcnt lgkmcnt(4)
v_pk_fma_f32 v[80:81], v[116:117], v[80:81], v[28:29] op_sel_hi:[0,1,1]
v_pk_fma_f32 v[82:83], v[116:117], v[82:83], v[30:31] op_sel_hi:[0,1,1]
v_pk_fma_f32 v[80:81], v[120:121], v[16:17], v[80:81] op_sel_hi:[0,1,1]
v_pk_fma_f32 v[82:83], v[120:121], v[18:19], v[82:83] op_sel_hi:[0,1,1]
v_pk_fma_f32 v[80:81], v[122:123], v[20:21], v[80:81] op_sel_hi:[0,1,1]
v_pk_fma_f32 v[82:83], v[122:123], v[22:23], v[82:83] op_sel_hi:[0,1,1]
v_pk_fma_f32 v[80:81], v[124:125], v[24:25], v[80:81] op_sel_hi:[0,1,1]
v_pk_fma_f32 v[82:83], v[124:125], v[26:27], v[82:83] op_sel_hi:[0,1,1]
v_pk_mul_f32 v[48:49], v[80:81], v[80:81]
v_pk_mul_f32 v[50:51], v[82:83], v[82:83]
v_pk_fma_f32 v[48:49], v[126:127], v[48:49], v[128:129] op_sel_hi:[0,1,0]
v_pk_fma_f32 v[50:51], v[126:127], v[50:51], v[128:129] op_sel_hi:[0,1,0]
v_pk_mul_f32 v[48:49], v[80:81], v[48:49]
v_pk_mul_f32 v[50:51], v[82:83], v[50:51]
v_exp_f32 v48, v48
v_exp_f32 v49, v49
v_exp_f32 v50, v50
v_exp_f32 v51, v51
v_pk_add_f32 v[48:49], v[48:49], v[130:131]
v_pk_add_f32 v[50:51], v[50:51], v[130:131]
v_rcp_f32 v48, v48
v_rcp_f32 v49, v49
v_rcp_f32 v50, v50
v_rcp_f32 v51, v51
v_pk_mul_f32 v[80:81], v[80:81], v[48:49]
v_pk_mul_f32 v[82:83], v[82:83], v[50:51]
v_cvt_pk_bf16_f32 v52, v80, v81
v_cvt_pk_bf16_f32 v53, v82, v83
ds_read_b128 v[16:19], v9 offset:3136
ds_read_b128 v[20:23], v9 offset:3520
ds_read_b128 v[24:27], v9 offset:3904
ds_read_b128 v[28:31], v9 offset:192
s_waitcnt lgkmcnt(4)
v_pk_fma_f32 v[84:85], v[116:117], v[84:85], v[44:45] op_sel_hi:[0,1,1]
v_pk_fma_f32 v[86:87], v[116:117], v[86:87], v[46:47] op_sel_hi:[0,1,1]
v_pk_fma_f32 v[84:85], v[120:121], v[32:33], v[84:85] op_sel_hi:[0,1,1]
v_pk_fma_f32 v[86:87], v[120:121], v[34:35], v[86:87] op_sel_hi:[0,1,1]
v_pk_fma_f32 v[84:85], v[122:123], v[36:37], v[84:85] op_sel_hi:[0,1,1]
v_pk_fma_f32 v[86:87], v[122:123], v[38:39], v[86:87] op_sel_hi:[0,1,1]
v_pk_fma_f32 v[84:85], v[124:125], v[40:41], v[84:85] op_sel_hi:[0,1,1]
v_pk_fma_f32 v[86:87], v[124:125], v[42:43], v[86:87] op_sel_hi:[0,1,1]
v_pk_mul_f32 v[48:49], v[84:85], v[84:85]
v_pk_mul_f32 v[50:51], v[86:87], v[86:87]
v_pk_fma_f32 v[48:49], v[126:127], v[48:49], v[128:129] op_sel_hi:[0,1,0]
v_pk_fma_f32 v[50:51], v[126:127], v[50:51], v[128:129] op_sel_hi:[0,1,0]
v_pk_mul_f32 v[48:49], v[84:85], v[48:49]
v_pk_mul_f32 v[50:51], v[86:87], v[50:51]
v_exp_f32 v48, v48
v_exp_f32 v49, v49
v_exp_f32 v50, v50
v_exp_f32 v51, v51
v_pk_add_f32 v[48:49], v[48:49], v[130:131]
v_pk_add_f32 v[50:51], v[50:51], v[130:131]
v_rcp_f32 v48, v48
v_rcp_f32 v49, v49
v_rcp_f32 v50, v50
v_rcp_f32 v51, v51
v_pk_mul_f32 v[84:85], v[84:85], v[48:49]
v_pk_mul_f32 v[86:87], v[86:87], v[50:51]
v_cvt_pk_bf16_f32 v54, v84, v85
v_cvt_pk_bf16_f32 v55, v86, v87
buffer_store_dwordx4 v[52:55], v11, s[44:47], s13 offen offset:1024 sc1
ds_read_b128 v[32:35], v9 offset:3168
ds_read_b128 v[36:39], v9 offset:3552
ds_read_b128 v[40:43], v9 offset:3936
ds_read_b128 v[44:47], v9 offset:224
s_waitcnt lgkmcnt(4)
v_pk_fma_f32 v[88:89], v[116:117], v[88:89], v[28:29] op_sel_hi:[0,1,1]
v_pk_fma_f32 v[90:91], v[116:117], v[90:91], v[30:31] op_sel_hi:[0,1,1]
v_pk_fma_f32 v[88:89], v[120:121], v[16:17], v[88:89] op_sel_hi:[0,1,1]
v_pk_fma_f32 v[90:91], v[120:121], v[18:19], v[90:91] op_sel_hi:[0,1,1]
v_pk_fma_f32 v[88:89], v[122:123], v[20:21], v[88:89] op_sel_hi:[0,1,1]
v_pk_fma_f32 v[90:91], v[122:123], v[22:23], v[90:91] op_sel_hi:[0,1,1]
v_pk_fma_f32 v[88:89], v[124:125], v[24:25], v[88:89] op_sel_hi:[0,1,1]
v_pk_fma_f32 v[90:91], v[124:125], v[26:27], v[90:91] op_sel_hi:[0,1,1]
v_pk_mul_f32 v[48:49], v[88:89], v[88:89]
v_pk_mul_f32 v[50:51], v[90:91], v[90:91]
v_pk_fma_f32 v[48:49], v[126:127], v[48:49], v[128:129] op_sel_hi:[0,1,0]
v_pk_fma_f32 v[50:51], v[126:127], v[50:51], v[128:129] op_sel_hi:[0,1,0]
v_pk_mul_f32 v[48:49], v[88:89], v[48:49]
v_pk_mul_f32 v[50:51], v[90:91], v[50:51]
v_exp_f32 v48, v48
v_exp_f32 v49, v49
v_exp_f32 v50, v50
v_exp_f32 v51, v51
v_pk_add_f32 v[48:49], v[48:49], v[130:131]
v_pk_add_f32 v[50:51], v[50:51], v[130:131]
v_rcp_f32 v48, v48
v_rcp_f32 v49, v49
v_rcp_f32 v50, v50
v_rcp_f32 v51, v51
v_pk_mul_f32 v[88:89], v[88:89], v[48:49]
v_pk_mul_f32 v[90:91], v[90:91], v[50:51]
v_cvt_pk_bf16_f32 v56, v88, v89
v_cvt_pk_bf16_f32 v57, v90, v91
ds_read_b128 v[16:19], v9 offset:3200
ds_read_b128 v[20:23], v9 offset:3584
ds_read_b128 v[24:27], v9 offset:3968
ds_read_b128 v[28:31], v9 offset:256
s_waitcnt lgkmcnt(4)
v_pk_fma_f32 v[92:93], v[116:117], v[92:93], v[44:45] op_sel_hi:[0,1,1]
v_pk_fma_f32 v[94:95], v[116:117], v[94:95], v[46:47] op_sel_hi:[0,1,1]
v_pk_fma_f32 v[92:93], v[120:121], v[32:33], v[92:93] op_sel_hi:[0,1,1]
v_pk_fma_f32 v[94:95], v[120:121], v[34:35], v[94:95] op_sel_hi:[0,1,1]
v_pk_fma_f32 v[92:93], v[122:123], v[36:37], v[92:93] op_sel_hi:[0,1,1]
v_pk_fma_f32 v[94:95], v[122:123], v[38:39], v[94:95] op_sel_hi:[0,1,1]
v_pk_fma_f32 v[92:93], v[124:125], v[40:41], v[92:93] op_sel_hi:[0,1,1]
v_pk_fma_f32 v[94:95], v[124:125], v[42:43], v[94:95] op_sel_hi:[0,1,1]
v_pk_mul_f32 v[48:49], v[92:93], v[92:93]
v_pk_mul_f32 v[50:51], v[94:95], v[94:95]
v_pk_fma_f32 v[48:49], v[126:127], v[48:49], v[128:129] op_sel_hi:[0,1,0]
v_pk_fma_f32 v[50:51], v[126:127], v[50:51], v[128:129] op_sel_hi:[0,1,0]
v_pk_mul_f32 v[48:49], v[92:93], v[48:49]
v_pk_mul_f32 v[50:51], v[94:95], v[50:51]
v_exp_f32 v48, v48
v_exp_f32 v49, v49
v_exp_f32 v50, v50
v_exp_f32 v51, v51
v_pk_add_f32 v[48:49], v[48:49], v[130:131]
v_pk_add_f32 v[50:51], v[50:51], v[130:131]
v_rcp_f32 v48, v48
v_rcp_f32 v49, v49
v_rcp_f32 v50, v50
v_rcp_f32 v51, v51
v_pk_mul_f32 v[92:93], v[92:93], v[48:49]
v_pk_mul_f32 v[94:95], v[94:95], v[50:51]
v_cvt_pk_bf16_f32 v58, v92, v93
v_cvt_pk_bf16_f32 v59, v94, v95
buffer_store_dwordx4 v[56:59], v11, s[44:47], s13 offen offset:1536 sc1
ds_read_b128 v[32:35], v9 offset:3232
ds_read_b128 v[36:39], v9 offset:3616
ds_read_b128 v[40:43], v9 offset:4000
ds_read_b128 v[44:47], v9 offset:288
s_waitcnt lgkmcnt(4)
v_pk_fma_f32 v[96:97], v[116:117], v[96:97], v[28:29] op_sel_hi:[0,1,1]
v_pk_fma_f32 v[98:99], v[116:117], v[98:99], v[30:31] op_sel_hi:[0,1,1]
v_pk_fma_f32 v[96:97], v[120:121], v[16:17], v[96:97] op_sel_hi:[0,1,1]
v_pk_fma_f32 v[98:99], v[120:121], v[18:19], v[98:99] op_sel_hi:[0,1,1]
v_pk_fma_f32 v[96:97], v[122:123], v[20:21], v[96:97] op_sel_hi:[0,1,1]
v_pk_fma_f32 v[98:99], v[122:123], v[22:23], v[98:99] op_sel_hi:[0,1,1]
v_pk_fma_f32 v[96:97], v[124:125], v[24:25], v[96:97] op_sel_hi:[0,1,1]
v_pk_fma_f32 v[98:99], v[124:125], v[26:27], v[98:99] op_sel_hi:[0,1,1]
v_pk_mul_f32 v[48:49], v[96:97], v[96:97]
v_pk_mul_f32 v[50:51], v[98:99], v[98:99]
v_pk_fma_f32 v[48:49], v[126:127], v[48:49], v[128:129] op_sel_hi:[0,1,0]
v_pk_fma_f32 v[50:51], v[126:127], v[50:51], v[128:129] op_sel_hi:[0,1,0]
v_pk_mul_f32 v[48:49], v[96:97], v[48:49]
v_pk_mul_f32 v[50:51], v[98:99], v[50:51]
v_exp_f32 v48, v48
v_exp_f32 v49, v49
v_exp_f32 v50, v50
v_exp_f32 v51, v51
v_pk_add_f32 v[48:49], v[48:49], v[130:131]
v_pk_add_f32 v[50:51], v[50:51], v[130:131]
v_rcp_f32 v48, v48
v_rcp_f32 v49, v49
v_rcp_f32 v50, v50
v_rcp_f32 v51, v51
v_pk_mul_f32 v[96:97], v[96:97], v[48:49]
v_pk_mul_f32 v[98:99], v[98:99], v[50:51]
v_cvt_pk_bf16_f32 v52, v96, v97
v_cvt_pk_bf16_f32 v53, v98, v99
ds_read_b128 v[16:19], v9 offset:3264
ds_read_b128 v[20:23], v9 offset:3648
ds_read_b128 v[24:27], v9 offset:4032
ds_read_b128 v[28:31], v9 offset:320
s_waitcnt lgkmcnt(4)
v_pk_fma_f32 v[100:101], v[116:117], v[100:101], v[44:45] op_sel_hi:[0,1,1]
v_pk_fma_f32 v[102:103], v[116:117], v[102:103], v[46:47] op_sel_hi:[0,1,1]
v_pk_fma_f32 v[100:101], v[120:121], v[32:33], v[100:101] op_sel_hi:[0,1,1]
v_pk_fma_f32 v[102:103], v[120:121], v[34:35], v[102:103] op_sel_hi:[0,1,1]
v_pk_fma_f32 v[100:101], v[122:123], v[36:37], v[100:101] op_sel_hi:[0,1,1]
v_pk_fma_f32 v[102:103], v[122:123], v[38:39], v[102:103] op_sel_hi:[0,1,1]
v_pk_fma_f32 v[100:101], v[124:125], v[40:41], v[100:101] op_sel_hi:[0,1,1]
v_pk_fma_f32 v[102:103], v[124:125], v[42:43], v[102:103] op_sel_hi:[0,1,1]
v_pk_mul_f32 v[48:49], v[100:101], v[100:101]
v_pk_mul_f32 v[50:51], v[102:103], v[102:103]
v_pk_fma_f32 v[48:49], v[126:127], v[48:49], v[128:129] op_sel_hi:[0,1,0]
v_pk_fma_f32 v[50:51], v[126:127], v[50:51], v[128:129] op_sel_hi:[0,1,0]
v_pk_mul_f32 v[48:49], v[100:101], v[48:49]
v_pk_mul_f32 v[50:51], v[102:103], v[50:51]
v_exp_f32 v48, v48
v_exp_f32 v49, v49
v_exp_f32 v50, v50
v_exp_f32 v51, v51
v_pk_add_f32 v[48:49], v[48:49], v[130:131]
v_pk_add_f32 v[50:51], v[50:51], v[130:131]
v_rcp_f32 v48, v48
v_rcp_f32 v49, v49
v_rcp_f32 v50, v50
v_rcp_f32 v51, v51
v_pk_mul_f32 v[100:101], v[100:101], v[48:49]
v_pk_mul_f32 v[102:103], v[102:103], v[50:51]
v_cvt_pk_bf16_f32 v54, v100, v101
v_cvt_pk_bf16_f32 v55, v102, v103
buffer_store_dwordx4 v[52:55], v11, s[44:47], s13 offen offset:2048 sc1
ds_read_b128 v[32:35], v9 offset:3296
ds_read_b128 v[36:39], v9 offset:3680
ds_read_b128 v[40:43], v9 offset:4064
ds_read_b128 v[44:47], v9 offset:352
s_waitcnt lgkmcnt(4)
v_pk_fma_f32 v[104:105], v[116:117], v[104:105], v[28:29] op_sel_hi:[0,1,1]
v_pk_fma_f32 v[106:107], v[116:117], v[106:107], v[30:31] op_sel_hi:[0,1,1]
v_pk_fma_f32 v[104:105], v[120:121], v[16:17], v[104:105] op_sel_hi:[0,1,1]
v_pk_fma_f32 v[106:107], v[120:121], v[18:19], v[106:107] op_sel_hi:[0,1,1]
v_pk_fma_f32 v[104:105], v[122:123], v[20:21], v[104:105] op_sel_hi:[0,1,1]
v_pk_fma_f32 v[106:107], v[122:123], v[22:23], v[106:107] op_sel_hi:[0,1,1]
v_pk_fma_f32 v[104:105], v[124:125], v[24:25], v[104:105] op_sel_hi:[0,1,1]
v_pk_fma_f32 v[106:107], v[124:125], v[26:27], v[106:107] op_sel_hi:[0,1,1]
v_pk_mul_f32 v[48:49], v[104:105], v[104:105]
v_pk_mul_f32 v[50:51], v[106:107], v[106:107]
v_pk_fma_f32 v[48:49], v[126:127], v[48:49], v[128:129] op_sel_hi:[0,1,0]
v_pk_fma_f32 v[50:51], v[126:127], v[50:51], v[128:129] op_sel_hi:[0,1,0]
v_pk_mul_f32 v[48:49], v[104:105], v[48:49]
v_pk_mul_f32 v[50:51], v[106:107], v[50:51]
v_exp_f32 v48, v48
v_exp_f32 v49, v49
v_exp_f32 v50, v50
v_exp_f32 v51, v51
v_pk_add_f32 v[48:49], v[48:49], v[130:131]
v_pk_add_f32 v[50:51], v[50:51], v[130:131]
v_rcp_f32 v48, v48
v_rcp_f32 v49, v49
v_rcp_f32 v50, v50
v_rcp_f32 v51, v51
v_pk_mul_f32 v[104:105], v[104:105], v[48:49]
v_pk_mul_f32 v[106:107], v[106:107], v[50:51]
v_cvt_pk_bf16_f32 v56, v104, v105
v_cvt_pk_bf16_f32 v57, v106, v107
s_waitcnt lgkmcnt(0)
v_pk_fma_f32 v[108:109], v[116:117], v[108:109], v[44:45] op_sel_hi:[0,1,1]
v_pk_fma_f32 v[110:111], v[116:117], v[110:111], v[46:47] op_sel_hi:[0,1,1]
v_pk_fma_f32 v[108:109], v[120:121], v[32:33], v[108:109] op_sel_hi:[0,1,1]
v_pk_fma_f32 v[110:111], v[120:121], v[34:35], v[110:111] op_sel_hi:[0,1,1]
v_pk_fma_f32 v[108:109], v[122:123], v[36:37], v[108:109] op_sel_hi:[0,1,1]
v_pk_fma_f32 v[110:111], v[122:123], v[38:39], v[110:111] op_sel_hi:[0,1,1]
v_pk_fma_f32 v[108:109], v[124:125], v[40:41], v[108:109] op_sel_hi:[0,1,1]
v_pk_fma_f32 v[110:111], v[124:125], v[42:43], v[110:111] op_sel_hi:[0,1,1]
v_pk_mul_f32 v[48:49], v[108:109], v[108:109]
v_pk_mul_f32 v[50:51], v[110:111], v[110:111]
v_pk_fma_f32 v[48:49], v[126:127], v[48:49], v[128:129] op_sel_hi:[0,1,0]
v_pk_fma_f32 v[50:51], v[126:127], v[50:51], v[128:129] op_sel_hi:[0,1,0]
v_pk_mul_f32 v[48:49], v[108:109], v[48:49]
v_pk_mul_f32 v[50:51], v[110:111], v[50:51]
v_exp_f32 v48, v48
v_exp_f32 v49, v49
v_exp_f32 v50, v50
v_exp_f32 v51, v51
v_pk_add_f32 v[48:49], v[48:49], v[130:131]
v_pk_add_f32 v[50:51], v[50:51], v[130:131]
v_rcp_f32 v48, v48
v_rcp_f32 v49, v49
v_rcp_f32 v50, v50
v_rcp_f32 v51, v51
v_pk_mul_f32 v[108:109], v[108:109], v[48:49]
v_pk_mul_f32 v[110:111], v[110:111], v[50:51]
v_cvt_pk_bf16_f32 v58, v108, v109
v_cvt_pk_bf16_f32 v59, v110, v111
buffer_store_dwordx4 v[56:59], v11, s[44:47], s13 offen offset:2560 sc1
s_waitcnt vmcnt(0)
s_barrier
s_lshl_b32 s12, s10, 4
s_add_u32 s12, s12, s11
s_cmp_lg_u32 s4, 0
s_cbranch_scc1 L_fs_61
s_lshl_b32 s64, s12, 7
s_add_u32 s64, s64, 0x20000
v_mov_b32 v252, s5
v_mov_b32 v253, 0
s_mov_b64 exec, 1
buffer_store_dword v252, v253, s[44:47], s64 offen sc1
s_mov_b64 exec, -1
L_fs_61:
s_cmp_lg_u32 s4, 3
s_cbranch_scc1 L_ct_62
s_lshl_b32 s64, s3, 4
v_and_b32 v249, 15, v1
v_add_u32 v249, s64, v249
v_lshlrev_b32 v249, 7, v249
v_min_u32 v249, L_code_end-L_code_begin-4, v249
global_load_dword v249, v249, s[22:23]
L_ct_62:
v_lshlrev_b32 v2, 4, v1
s_mul_i32 s76, s9, 245760
s_add_u32 s76, s76, 0x2a00000
s_cmp_eq_u32 s4, 1
s_cbranch_scc1 L_w2d1_64
s_cmp_eq_u32 s4, 2
s_cbranch_scc1 L_w2d2_65
s_cmp_eq_u32 s4, 3
s_cbranch_scc1 L_w2d3_66
s_nop 0
L_w2d0_63:
s_mov_b32 m0, 76800
s_add_u32 s79, s76, 122880
buffer_load_dwordx4 v2, s[44:47], s79 offen sc1 lds
s_mov_b32 m0, 80896
s_add_u32 s79, s76, 126976
buffer_load_dwordx4 v2, s[44:47], s79 offen sc1 lds
s_mov_b32 m0, 84992
s_add_u32 s79, s76, 131072
buffer_load_dwordx4 v2, s[44:47], s79 offen sc1 lds
s_mov_b32 m0, 89088
s_add_u32 s79, s76, 135168
buffer_load_dwordx4 v2, s[44:47], s79 offen sc1 lds
s_mov_b32 m0, 93184
s_add_u32 s79, s76, 139264
buffer_load_dwordx4 v2, s[44:47], s79 offen sc1 lds
s_mov_b32 m0, 97280
s_add_u32 s79, s76, 143360
buffer_load_dwordx4 v2, s[44:47], s79 offen sc1 lds
s_mov_b32 m0, 101376
s_add_u32 s79, s76, 147456
buffer_load_dwordx4 v2, s[44:47], s79 offen sc1 lds
s_mov_b32 m0, 105472
s_add_u32 s79, s76, 151552
buffer_load_dwordx4 v2, s[44:47], s79 offen sc1 lds
s_mov_b32 m0, 32768
s_add_u32 s79, s76, 32768
buffer_load_dwordx4 v2, s[44:47], s79 offen sc1 lds
s_mov_b32 m0, 108544
s_add_u32 s79, s76, 154624
buffer_load_dwordx4 v2, s[44:47], s79 offen sc1 lds
s_mov_b32 m0, 35840
s_add_u32 s79, s76, 35840
buffer_load_dwordx4 v2, s[44:47], s79 offen sc1 lds
s_mov_b32 m0, 39936
s_add_u32 s79, s76, 39936
buffer_load_dwordx4 v2, s[44:47], s79 offen sc1 lds
s_mov_b32 m0, 115712
s_add_u32 s79, s76, 161792
buffer_load_dwordx4 v2, s[44:47], s79 offen sc1 lds
s_mov_b32 m0, 43008
s_add_u32 s79, s76, 43008
buffer_load_dwordx4 v2, s[44:47], s79 offen sc1 lds
s_mov_b32 m0, 118784
s_add_u32 s79, s76, 164864
buffer_load_dwordx4 v2, s[44:47], s79 offen sc1 lds
s_mov_b32 m0, 46080
s_add_u32 s79, s76, 46080
buffer_load_dwordx4 v2, s[44:47], s79 offen sc1 lds
s_mov_b32 m0, 50176
s_add_u32 s79, s76, 50176
buffer_load_dwordx4 v2, s[44:47], s79 offen sc1 lds
s_mov_b32 m0, 125952
s_add_u32 s79, s76, 172032
buffer_load_dwordx4 v2, s[44:47], s79 offen sc1 lds
s_mov_b32 m0, 53248
s_add_u32 s79, s76, 53248
buffer_load_dwordx4 v2, s[44:47], s79 offen sc1 lds
s_mov_b32 m0, 129024
s_add_u32 s79, s76, 175104
buffer_load_dwordx4 v2, s[44:47], s79 offen sc1 lds
s_mov_b32 m0, 56320
s_add_u32 s79, s76, 56320
buffer_load_dwordx4 v2, s[44:47], s79 offen sc1 lds
s_mov_b32 m0, 60416
s_add_u32 s79, s76, 60416
buffer_load_dwordx4 v2, s[44:47], s79 offen sc1 lds
s_mov_b32 m0, 136192
s_add_u32 s79, s76, 182272
buffer_load_dwordx4 v2, s[44:47], s79 offen sc1 lds
s_mov_b32 m0, 63488
s_add_u32 s79, s76, 63488
buffer_load_dwordx4 v2, s[44:47], s79 offen sc1 lds
s_mov_b32 m0, 139264
s_add_u32 s79, s76, 185344
buffer_load_dwordx4 v2, s[44:47], s79 offen sc1 lds
s_mov_b32 m0, 66560
s_add_u32 s79, s76, 66560
buffer_load_dwordx4 v2, s[44:47], s79 offen sc1 lds
s_mov_b32 m0, 70656
s_add_u32 s79, s76, 70656
buffer_load_dwordx4 v2, s[44:47], s79 offen sc1 lds
s_mov_b32 m0, 146432
s_add_u32 s79, s76, 192512
buffer_load_dwordx4 v2, s[44:47], s79 offen sc1 lds
s_mov_b32 m0, 73728
s_add_u32 s79, s76, 73728
buffer_load_dwordx4 v2, s[44:47], s79 offen sc1 lds
s_mov_b32 m0, 149504
s_add_u32 s79, s76, 195584
buffer_load_dwordx4 v2, s[44:47], s79 offen sc1 lds
s_branch L_w2de_67
L_w2d1_64:
s_mov_b32 m0, 77824
s_add_u32 s79, s76, 123904
buffer_load_dwordx4 v2, s[44:47], s79 offen sc1 lds
s_mov_b32 m0, 81920
s_add_u32 s79, s76, 128000
buffer_load_dwordx4 v2, s[44:47], s79 offen sc1 lds
s_mov_b32 m0, 86016
s_add_u32 s79, s76, 132096
buffer_load_dwordx4 v2, s[44:47], s79 offen sc1 lds
s_mov_b32 m0, 90112
s_add_u32 s79, s76, 136192
buffer_load_dwordx4 v2, s[44:47], s79 offen sc1 lds
s_mov_b32 m0, 94208
s_add_u32 s79, s76, 140288
buffer_load_dwordx4 v2, s[44:47], s79 offen sc1 lds
s_mov_b32 m0, 98304
s_add_u32 s79, s76, 144384
buffer_load_dwordx4 v2, s[44:47], s79 offen sc1 lds
s_mov_b32 m0, 102400
s_add_u32 s79, s76, 148480
buffer_load_dwordx4 v2, s[44:47], s79 offen sc1 lds
s_mov_b32 m0, 106496
s_add_u32 s79, s76, 152576
buffer_load_dwordx4 v2, s[44:47], s79 offen sc1 lds
s_mov_b32 m0, 33792
s_add_u32 s79, s76, 33792
buffer_load_dwordx4 v2, s[44:47], s79 offen sc1 lds
s_mov_b32 m0, 109568
s_add_u32 s79, s76, 155648
buffer_load_dwordx4 v2, s[44:47], s79 offen sc1 lds
s_mov_b32 m0, 36864
s_add_u32 s79, s76, 36864
buffer_load_dwordx4 v2, s[44:47], s79 offen sc1 lds
s_mov_b32 m0, 112640
s_add_u32 s79, s76, 158720
buffer_load_dwordx4 v2, s[44:47], s79 offen sc1 lds
s_mov_b32 m0, 116736
s_add_u32 s79, s76, 162816
buffer_load_dwordx4 v2, s[44:47], s79 offen sc1 lds
s_mov_b32 m0, 44032
s_add_u32 s79, s76, 44032
buffer_load_dwordx4 v2, s[44:47], s79 offen sc1 lds
s_mov_b32 m0, 119808
s_add_u32 s79, s76, 165888
buffer_load_dwordx4 v2, s[44:47], s79 offen sc1 lds
s_mov_b32 m0, 47104
s_add_u32 s79, s76, 47104
buffer_load_dwordx4 v2, s[44:47], s79 offen sc1 lds
s_mov_b32 m0, 122880
s_add_u32 s79, s76, 168960
buffer_load_dwordx4 v2, s[44:47], s79 offen sc1 lds
s_mov_b32 m0, 126976
s_add_u32 s79, s76, 173056
buffer_load_dwordx4 v2, s[44:47], s79 offen sc1 lds
s_mov_b32 m0, 54272
s_add_u32 s79, s76, 54272
buffer_load_dwordx4 v2, s[44:47], s79 offen sc1 lds
s_mov_b32 m0, 130048
s_add_u32 s79, s76, 176128
buffer_load_dwordx4 v2, s[44:47], s79 offen sc1 lds
s_mov_b32 m0, 57344
s_add_u32 s79, s76, 57344
buffer_load_dwordx4 v2, s[44:47], s79 offen sc1 lds
s_mov_b32 m0, 133120
s_add_u32 s79, s76, 179200
buffer_load_dwordx4 v2, s[44:47], s79 offen sc1 lds
s_mov_b32 m0, 137216
s_add_u32 s79, s76, 183296
buffer_load_dwordx4 v2, s[44:47], s79 offen sc1 lds
s_mov_b32 m0, 64512
s_add_u32 s79, s76, 64512
buffer_load_dwordx4 v2, s[44:47], s79 offen sc1 lds
s_mov_b32 m0, 140288
s_add_u32 s79, s76, 186368
buffer_load_dwordx4 v2, s[44:47], s79 offen sc1 lds
s_mov_b32 m0, 67584
s_add_u32 s79, s76, 67584
buffer_load_dwordx4 v2, s[44:47], s79 offen sc1 lds
s_mov_b32 m0, 143360
s_add_u32 s79, s76, 189440
buffer_load_dwordx4 v2, s[44:47], s79 offen sc1 lds
s_mov_b32 m0, 147456
s_add_u32 s79, s76, 193536
buffer_load_dwordx4 v2, s[44:47], s79 offen sc1 lds
s_mov_b32 m0, 74752
s_add_u32 s79, s76, 74752
buffer_load_dwordx4 v2, s[44:47], s79 offen sc1 lds
s_mov_b32 m0, 150528
s_add_u32 s79, s76, 196608
buffer_load_dwordx4 v2, s[44:47], s79 offen sc1 lds
s_branch L_w2de_67
L_w2d2_65:
s_mov_b32 m0, 78848
s_add_u32 s79, s76, 124928
buffer_load_dwordx4 v2, s[44:47], s79 offen sc1 lds
s_mov_b32 m0, 82944
s_add_u32 s79, s76, 129024
buffer_load_dwordx4 v2, s[44:47], s79 offen sc1 lds
s_mov_b32 m0, 87040
s_add_u32 s79, s76, 133120
buffer_load_dwordx4 v2, s[44:47], s79 offen sc1 lds
s_mov_b32 m0, 91136
s_add_u32 s79, s76, 137216
buffer_load_dwordx4 v2, s[44:47], s79 offen sc1 lds
s_mov_b32 m0, 95232
s_add_u32 s79, s76, 141312
buffer_load_dwordx4 v2, s[44:47], s79 offen sc1 lds
s_mov_b32 m0, 99328
s_add_u32 s79, s76, 145408
buffer_load_dwordx4 v2, s[44:47], s79 offen sc1 lds
s_mov_b32 m0, 103424
s_add_u32 s79, s76, 149504
buffer_load_dwordx4 v2, s[44:47], s79 offen sc1 lds
s_mov_b32 m0, 30720
s_add_u32 s79, s76, 30720
buffer_load_dwordx4 v2, s[44:47], s79 offen sc1 lds
s_mov_b32 m0, 34816
s_add_u32 s79, s76, 34816
buffer_load_dwordx4 v2, s[44:47], s79 offen sc1 lds
s_mov_b32 m0, 110592
s_add_u32 s79, s76, 156672
buffer_load_dwordx4 v2, s[44:47], s79 offen sc1 lds
s_mov_b32 m0, 37888
s_add_u32 s79, s76, 37888
buffer_load_dwordx4 v2, s[44:47], s79 offen sc1 lds
s_mov_b32 m0, 113664
s_add_u32 s79, s76, 159744
buffer_load_dwordx4 v2, s[44:47], s79 offen sc1 lds
s_mov_b32 m0, 40960
s_add_u32 s79, s76, 40960
buffer_load_dwordx4 v2, s[44:47], s79 offen sc1 lds
s_mov_b32 m0, 45056
s_add_u32 s79, s76, 45056
buffer_load_dwordx4 v2, s[44:47], s79 offen sc1 lds
s_mov_b32 m0, 120832
s_add_u32 s79, s76, 166912
buffer_load_dwordx4 v2, s[44:47], s79 offen sc1 lds
s_mov_b32 m0, 48128
s_add_u32 s79, s76, 48128
buffer_load_dwordx4 v2, s[44:47], s79 offen sc1 lds
s_mov_b32 m0, 123904
s_add_u32 s79, s76, 169984
buffer_load_dwordx4 v2, s[44:47], s79 offen sc1 lds
s_mov_b32 m0, 51200
s_add_u32 s79, s76, 51200
buffer_load_dwordx4 v2, s[44:47], s79 offen sc1 lds
s_mov_b32 m0, 55296
s_add_u32 s79, s76, 55296
buffer_load_dwordx4 v2, s[44:47], s79 offen sc1 lds
s_mov_b32 m0, 131072
s_add_u32 s79, s76, 177152
buffer_load_dwordx4 v2, s[44:47], s79 offen sc1 lds
s_mov_b32 m0, 58368
s_add_u32 s79, s76, 58368
buffer_load_dwordx4 v2, s[44:47], s79 offen sc1 lds
s_mov_b32 m0, 134144
s_add_u32 s79, s76, 180224
buffer_load_dwordx4 v2, s[44:47], s79 offen sc1 lds
s_mov_b32 m0, 61440
s_add_u32 s79, s76, 61440
buffer_load_dwordx4 v2, s[44:47], s79 offen sc1 lds
s_mov_b32 m0, 65536
s_add_u32 s79, s76, 65536
buffer_load_dwordx4 v2, s[44:47], s79 offen sc1 lds
s_mov_b32 m0, 141312
s_add_u32 s79, s76, 187392
buffer_load_dwordx4 v2, s[44:47], s79 offen sc1 lds
s_mov_b32 m0, 68608
s_add_u32 s79, s76, 68608
buffer_load_dwordx4 v2, s[44:47], s79 offen sc1 lds
s_mov_b32 m0, 144384
s_add_u32 s79, s76, 190464
buffer_load_dwordx4 v2, s[44:47], s79 offen sc1 lds
s_mov_b32 m0, 71680
s_add_u32 s79, s76, 71680
buffer_load_dwordx4 v2, s[44:47], s79 offen sc1 lds
s_mov_b32 m0, 75776
s_add_u32 s79, s76, 75776
buffer_load_dwordx4 v2, s[44:47], s79 offen sc1 lds
s_mov_b32 m0, 151552
s_add_u32 s79, s76, 197632
buffer_load_dwordx4 v2, s[44:47], s79 offen sc1 lds
s_branch L_w2de_67
L_w2d3_66:
s_mov_b32 m0, 79872
s_add_u32 s79, s76, 125952
buffer_load_dwordx4 v2, s[44:47], s79 offen sc1 lds
s_mov_b32 m0, 83968
s_add_u32 s79, s76, 130048
buffer_load_dwordx4 v2, s[44:47], s79 offen sc1 lds
s_mov_b32 m0, 88064
s_add_u32 s79, s76, 134144
buffer_load_dwordx4 v2, s[44:47], s79 offen sc1 lds
s_mov_b32 m0, 92160
s_add_u32 s79, s76, 138240
buffer_load_dwordx4 v2, s[44:47], s79 offen sc1 lds
s_mov_b32 m0, 96256
s_add_u32 s79, s76, 142336
buffer_load_dwordx4 v2, s[44:47], s79 offen sc1 lds
s_mov_b32 m0, 100352
s_add_u32 s79, s76, 146432
buffer_load_dwordx4 v2, s[44:47], s79 offen sc1 lds
s_mov_b32 m0, 104448
s_add_u32 s79, s76, 150528
buffer_load_dwordx4 v2, s[44:47], s79 offen sc1 lds
s_mov_b32 m0, 31744
s_add_u32 s79, s76, 31744
buffer_load_dwordx4 v2, s[44:47], s79 offen sc1 lds
s_mov_b32 m0, 107520
s_add_u32 s79, s76, 153600
buffer_load_dwordx4 v2, s[44:47], s79 offen sc1 lds
s_mov_b32 m0, 111616
s_add_u32 s79, s76, 157696
buffer_load_dwordx4 v2, s[44:47], s79 offen sc1 lds
s_mov_b32 m0, 38912
s_add_u32 s79, s76, 38912
buffer_load_dwordx4 v2, s[44:47], s79 offen sc1 lds
s_mov_b32 m0, 114688
s_add_u32 s79, s76, 160768
buffer_load_dwordx4 v2, s[44:47], s79 offen sc1 lds
s_mov_b32 m0, 41984
s_add_u32 s79, s76, 41984
buffer_load_dwordx4 v2, s[44:47], s79 offen sc1 lds
s_mov_b32 m0, 117760
s_add_u32 s79, s76, 163840
buffer_load_dwordx4 v2, s[44:47], s79 offen sc1 lds
s_mov_b32 m0, 121856
s_add_u32 s79, s76, 167936
buffer_load_dwordx4 v2, s[44:47], s79 offen sc1 lds
s_mov_b32 m0, 49152
s_add_u32 s79, s76, 49152
buffer_load_dwordx4 v2, s[44:47], s79 offen sc1 lds
s_mov_b32 m0, 124928
s_add_u32 s79, s76, 171008
buffer_load_dwordx4 v2, s[44:47], s79 offen sc1 lds
s_mov_b32 m0, 52224
s_add_u32 s79, s76, 52224
buffer_load_dwordx4 v2, s[44:47], s79 offen sc1 lds
s_mov_b32 m0, 128000
s_add_u32 s79, s76, 174080
buffer_load_dwordx4 v2, s[44:47], s79 offen sc1 lds
s_mov_b32 m0, 132096
s_add_u32 s79, s76, 178176
buffer_load_dwordx4 v2, s[44:47], s79 offen sc1 lds
s_mov_b32 m0, 59392
s_add_u32 s79, s76, 59392
buffer_load_dwordx4 v2, s[44:47], s79 offen sc1 lds
s_mov_b32 m0, 135168
s_add_u32 s79, s76, 181248
buffer_load_dwordx4 v2, s[44:47], s79 offen sc1 lds
s_mov_b32 m0, 62464
s_add_u32 s79, s76, 62464
buffer_load_dwordx4 v2, s[44:47], s79 offen sc1 lds
s_mov_b32 m0, 138240
s_add_u32 s79, s76, 184320
buffer_load_dwordx4 v2, s[44:47], s79 offen sc1 lds
s_mov_b32 m0, 142336
s_add_u32 s79, s76, 188416
buffer_load_dwordx4 v2, s[44:47], s79 offen sc1 lds
s_mov_b32 m0, 69632
s_add_u32 s79, s76, 69632
buffer_load_dwordx4 v2, s[44:47], s79 offen sc1 lds
s_mov_b32 m0, 145408
s_add_u32 s79, s76, 191488
buffer_load_dwordx4 v2, s[44:47], s79 offen sc1 lds
s_mov_b32 m0, 72704
s_add_u32 s79, s76, 72704
buffer_load_dwordx4 v2, s[44:47], s79 offen sc1 lds
s_mov_b32 m0, 148480
s_add_u32 s79, s76, 194560
buffer_load_dwordx4 v2, s[44:47], s79 offen sc1 lds
s_mov_b32 m0, 152576
s_add_u32 s79, s76, 198656
buffer_load_dwordx4 v2, s[44:47], s79 offen sc1 lds
L_w2de_67:
v_and_b32 v8, 15, v1
s_lshr_b32 s12, s8, 1
s_lshl_b32 s12, s12, 4
v_add_u32 v8, s12, v8
v_lshlrev_b32 v8, 7, v8
v_add_u32 v14, 0x20000, v8
s_lshr_b32 s13, s4, 1
s_mul_i32 s13, s13, 76800
v_add_u32 v4, s13, v2
v_add_u32 v5, 40960, v4
s_cmp_lg_u32 s4, 0
s_cbranch_scc1 L_pd_69
s_mov_b32 s64, 0
L_pl_68:
buffer_load_dword v250, v14, s[44:47], 0 offen sc1
s_add_u32 s64, s64, 1
s_cmp_gt_u32 s64, 1048576
s_cbranch_scc1 L_pd_69
s_waitcnt vmcnt(0)
v_cmp_ne_u32 vcc, s5, v250
s_nop 3
s_cmp_eq_u64 vcc, 0
s_cbranch_scc1 L_pd_69
s_branch L_pl_68
L_pd_69:
s_waitcnt vmcnt(0)
s_barrier
s_lshr_b32 s13, s4, 1
s_mul_i32 s13, s13, 24576
s_add_u32 s13, s13, 0x1000000
s_mul_i32 s12, s42, 49152
s_add_u32 s12, s12, s13
s_mul_i32 s14, s43, 49152
s_add_u32 s14, s14, s13
buffer_load_dwordx4 a[0:3], v2, s[44:47], s12 offen offset:0 sc1
buffer_load_dwordx4 a[96:99], v2, s[44:47], s14 offen offset:0 sc1
buffer_load_dwordx4 a[4:7], v2, s[44:47], s12 offen offset:1024 sc1
buffer_load_dwordx4 a[100:103], v2, s[44:47], s14 offen offset:1024 sc1
buffer_load_dwordx4 a[8:11], v2, s[44:47], s12 offen offset:2048 sc1
buffer_load_dwordx4 a[104:107], v2, s[44:47], s14 offen offset:2048 sc1
buffer_load_dwordx4 a[12:15], v2, s[44:47], s12 offen offset:3072 sc1
buffer_load_dwordx4 a[108:111], v2, s[44:47], s14 offen offset:3072 sc1
s_add_u32 s12, s12, 4096
s_add_u32 s14, s14, 4096
buffer_load_dwordx4 a[16:19], v2, s[44:47], s12 offen offset:0 sc1
buffer_load_dwordx4 a[112:115], v2, s[44:47], s14 offen offset:0 sc1
buffer_load_dwordx4 a[20:23], v2, s[44:47], s12 offen offset:1024 sc1
buffer_load_dwordx4 a[116:119], v2, s[44:47], s14 offen offset:1024 sc1
buffer_load_dwordx4 a[24:27], v2, s[44:47], s12 offen offset:2048 sc1
buffer_load_dwordx4 a[120:123], v2, s[44:47], s14 offen offset:2048 sc1
buffer_load_dwordx4 a[28:31], v2, s[44:47], s12 offen offset:3072 sc1
buffer_load_dwordx4 a[124:127], v2, s[44:47], s14 offen offset:3072 sc1
ds_read_b128 v[16:19], v4 offset:0
ds_read_b128 v[20:23], v4 offset:1024
ds_read_b128 v[24:27], v4 offset:2048
ds_read_b128 v[28:31], v4 offset:3072
ds_read_b128 v[32:35], v4 offset:4096
s_waitcnt vmcnt(14) lgkmcnt(0)
v_mfma_f32_16x16x32_bf16 v[64:67], v[16:19], a[0:3], 0
ds_read_b128 v[36:39], v4 offset:5120
v_mfma_f32_16x16x32_bf16 v[84:87], v[16:19], a[96:99], 0
ds_read_b128 v[40:43], v4 offset:6144
v_mfma_f32_16x16x32_bf16 v[68:71], v[20:23], a[0:3], 0
ds_read_b128 v[44:47], v4 offset:7168
v_mfma_f32_16x16x32_bf16 v[88:91], v[20:23], a[96:99], 0
ds_read_b128 v[48:51], v4 offset:8192
v_mfma_f32_16x16x32_bf16 v[72:75], v[24:27], a[0:3], 0
ds_read_b128 v[52:55], v4 offset:9216
v_mfma_f32_16x16x32_bf16 v[92:95], v[24:27], a[96:99], 0
v_mfma_f32_16x16x32_bf16 v[76:79], v[28:31], a[0:3], 0
v_mfma_f32_16x16x32_bf16 v[96:99], v[28:31], a[96:99], 0
s_add_u32 s12, s12, 4096
s_add_u32 s14, s14, 4096
buffer_load_dwordx4 a[32:35], v2, s[44:47], s12 offen offset:0 sc1
buffer_load_dwordx4 a[128:131], v2, s[44:47], s14 offen offset:0 sc1
v_mfma_f32_16x16x32_bf16 v[80:83], v[32:35], a[0:3], 0
v_mfma_f32_16x16x32_bf16 v[100:103], v[32:35], a[96:99], 0
s_waitcnt vmcnt(14) lgkmcnt(0)
v_mfma_f32_16x16x32_bf16 v[64:67], v[36:39], a[4:7], v[64:67]
ds_read_b128 v[16:19], v4 offset:10240
v_mfma_f32_16x16x32_bf16 v[84:87], v[36:39], a[100:103], v[84:87]
ds_read_b128 v[20:23], v4 offset:11264
v_mfma_f32_16x16x32_bf16 v[68:71], v[40:43], a[4:7], v[68:71]
ds_read_b128 v[24:27], v4 offset:12288
v_mfma_f32_16x16x32_bf16 v[88:91], v[40:43], a[100:103], v[88:91]
ds_read_b128 v[28:31], v4 offset:13312
v_mfma_f32_16x16x32_bf16 v[72:75], v[44:47], a[4:7], v[72:75]
ds_read_b128 v[32:35], v4 offset:14336
v_mfma_f32_16x16x32_bf16 v[92:95], v[44:47], a[100:103], v[92:95]
v_mfma_f32_16x16x32_bf16 v[76:79], v[48:51], a[4:7], v[76:79]
v_mfma_f32_16x16x32_bf16 v[96:99], v[48:51], a[100:103], v[96:99]
buffer_load_dwordx4 a[36:39], v2, s[44:47], s12 offen offset:1024 sc1
buffer_load_dwordx4 a[132:135], v2, s[44:47], s14 offen offset:1024 sc1
v_mfma_f32_16x16x32_bf16 v[80:83], v[52:55], a[4:7], v[80:83]
v_mfma_f32_16x16x32_bf16 v[100:103], v[52:55], a[100:103], v[100:103]
s_waitcnt vmcnt(14) lgkmcnt(0)
v_mfma_f32_16x16x32_bf16 v[64:67], v[16:19], a[8:11], v[64:67]
ds_read_b128 v[36:39], v4 offset:15360
v_mfma_f32_16x16x32_bf16 v[84:87], v[16:19], a[104:107], v[84:87]
ds_read_b128 v[40:43], v4 offset:16384
v_mfma_f32_16x16x32_bf16 v[68:71], v[20:23], a[8:11], v[68:71]
ds_read_b128 v[44:47], v4 offset:17408
v_mfma_f32_16x16x32_bf16 v[88:91], v[20:23], a[104:107], v[88:91]
ds_read_b128 v[48:51], v4 offset:18432
v_mfma_f32_16x16x32_bf16 v[72:75], v[24:27], a[8:11], v[72:75]
ds_read_b128 v[52:55], v4 offset:19456
v_mfma_f32_16x16x32_bf16 v[92:95], v[24:27], a[104:107], v[92:95]
v_mfma_f32_16x16x32_bf16 v[76:79], v[28:31], a[8:11], v[76:79]
v_mfma_f32_16x16x32_bf16 v[96:99], v[28:31], a[104:107], v[96:99]
buffer_load_dwordx4 a[40:43], v2, s[44:47], s12 offen offset:2048 sc1
buffer_load_dwordx4 a[136:139], v2, s[44:47], s14 offen offset:2048 sc1
v_mfma_f32_16x16x32_bf16 v[80:83], v[32:35], a[8:11], v[80:83]
v_mfma_f32_16x16x32_bf16 v[100:103], v[32:35], a[104:107], v[100:103]
s_waitcnt vmcnt(14) lgkmcnt(0)
v_mfma_f32_16x16x32_bf16 v[64:67], v[36:39], a[12:15], v[64:67]
ds_read_b128 v[16:19], v4 offset:20480
v_mfma_f32_16x16x32_bf16 v[84:87], v[36:39], a[108:111], v[84:87]
ds_read_b128 v[20:23], v4 offset:21504
v_mfma_f32_16x16x32_bf16 v[68:71], v[40:43], a[12:15], v[68:71]
ds_read_b128 v[24:27], v4 offset:22528
v_mfma_f32_16x16x32_bf16 v[88:91], v[40:43], a[108:111], v[88:91]
ds_read_b128 v[28:31], v4 offset:23552
v_mfma_f32_16x16x32_bf16 v[72:75], v[44:47], a[12:15], v[72:75]
ds_read_b128 v[32:35], v4 offset:24576
v_mfma_f32_16x16x32_bf16 v[92:95], v[44:47], a[108:111], v[92:95]
v_mfma_f32_16x16x32_bf16 v[76:79], v[48:51], a[12:15], v[76:79]
v_mfma_f32_16x16x32_bf16 v[96:99], v[48:51], a[108:111], v[96:99]
buffer_load_dwordx4 a[44:47], v2, s[44:47], s12 offen offset:3072 sc1
buffer_load_dwordx4 a[140:143], v2, s[44:47], s14 offen offset:3072 sc1
v_mfma_f32_16x16x32_bf16 v[80:83], v[52:55], a[12:15], v[80:83]
v_mfma_f32_16x16x32_bf16 v[100:103], v[52:55], a[108:111], v[100:103]
s_waitcnt vmcnt(14) lgkmcnt(0)
v_mfma_f32_16x16x32_bf16 v[64:67], v[16:19], a[16:19], v[64:67]
ds_read_b128 v[36:39], v4 offset:25600
v_mfma_f32_16x16x32_bf16 v[84:87], v[16:19], a[112:115], v[84:87]
ds_read_b128 v[40:43], v4 offset:26624
v_mfma_f32_16x16x32_bf16 v[68:71], v[20:23], a[16:19], v[68:71]
ds_read_b128 v[44:47], v4 offset:27648
v_mfma_f32_16x16x32_bf16 v[88:91], v[20:23], a[112:115], v[88:91]
ds_read_b128 v[48:51], v4 offset:28672
v_mfma_f32_16x16x32_bf16 v[72:75], v[24:27], a[16:19], v[72:75]
ds_read_b128 v[52:55], v4 offset:29696
v_mfma_f32_16x16x32_bf16 v[92:95], v[24:27], a[112:115], v[92:95]
v_mfma_f32_16x16x32_bf16 v[76:79], v[28:31], a[16:19], v[76:79]
v_mfma_f32_16x16x32_bf16 v[96:99], v[28:31], a[112:115], v[96:99]
s_add_u32 s12, s12, 4096
s_add_u32 s14, s14, 4096
buffer_load_dwordx4 a[48:51], v2, s[44:47], s12 offen offset:0 sc1
buffer_load_dwordx4 a[144:147], v2, s[44:47], s14 offen offset:0 sc1
v_mfma_f32_16x16x32_bf16 v[80:83], v[32:35], a[16:19], v[80:83]
v_mfma_f32_16x16x32_bf16 v[100:103], v[32:35], a[112:115], v[100:103]
s_waitcnt vmcnt(14) lgkmcnt(0)
v_mfma_f32_16x16x32_bf16 v[64:67], v[36:39], a[20:23], v[64:67]
ds_read_b128 v[16:19], v4 offset:30720
v_mfma_f32_16x16x32_bf16 v[84:87], v[36:39], a[116:119], v[84:87]
ds_read_b128 v[20:23], v4 offset:31744
v_mfma_f32_16x16x32_bf16 v[68:71], v[40:43], a[20:23], v[68:71]
ds_read_b128 v[24:27], v4 offset:32768
v_mfma_f32_16x16x32_bf16 v[88:91], v[40:43], a[116:119], v[88:91]
ds_read_b128 v[28:31], v4 offset:33792
v_mfma_f32_16x16x32_bf16 v[72:75], v[44:47], a[20:23], v[72:75]
ds_read_b128 v[32:35], v4 offset:34816
v_mfma_f32_16x16x32_bf16 v[92:95], v[44:47], a[116:119], v[92:95]
v_mfma_f32_16x16x32_bf16 v[76:79], v[48:51], a[20:23], v[76:79]
v_mfma_f32_16x16x32_bf16 v[96:99], v[48:51], a[116:119], v[96:99]
buffer_load_dwordx4 a[52:55], v2, s[44:47], s12 offen offset:1024 sc1
buffer_load_dwordx4 a[148:151], v2, s[44:47], s14 offen offset:1024 sc1
v_mfma_f32_16x16x32_bf16 v[80:83], v[52:55], a[20:23], v[80:83]
v_mfma_f32_16x16x32_bf16 v[100:103], v[52:55], a[116:119], v[100:103]
s_waitcnt vmcnt(14) lgkmcnt(0)
v_mfma_f32_16x16x32_bf16 v[64:67], v[16:19], a[24:27], v[64:67]
ds_read_b128 v[36:39], v4 offset:35840
v_mfma_f32_16x16x32_bf16 v[84:87], v[16:19], a[120:123], v[84:87]
ds_read_b128 v[40:43], v4 offset:36864
v_mfma_f32_16x16x32_bf16 v[68:71], v[20:23], a[24:27], v[68:71]
ds_read_b128 v[44:47], v4 offset:37888
v_mfma_f32_16x16x32_bf16 v[88:91], v[20:23], a[120:123], v[88:91]
ds_read_b128 v[48:51], v4 offset:38912
v_mfma_f32_16x16x32_bf16 v[72:75], v[24:27], a[24:27], v[72:75]
ds_read_b128 v[52:55], v4 offset:39936
v_mfma_f32_16x16x32_bf16 v[92:95], v[24:27], a[120:123], v[92:95]
v_mfma_f32_16x16x32_bf16 v[76:79], v[28:31], a[24:27], v[76:79]
v_mfma_f32_16x16x32_bf16 v[96:99], v[28:31], a[120:123], v[96:99]
buffer_load_dwordx4 a[56:59], v2, s[44:47], s12 offen offset:2048 sc1
buffer_load_dwordx4 a[152:155], v2, s[44:47], s14 offen offset:2048 sc1
v_mfma_f32_16x16x32_bf16 v[80:83], v[32:35], a[24:27], v[80:83]
v_mfma_f32_16x16x32_bf16 v[100:103], v[32:35], a[120:123], v[100:103]
s_waitcnt vmcnt(14) lgkmcnt(0)
v_mfma_f32_16x16x32_bf16 v[64:67], v[36:39], a[28:31], v[64:67]
ds_read_b128 v[16:19], v5 offset:0
v_mfma_f32_16x16x32_bf16 v[84:87], v[36:39], a[124:127], v[84:87]
ds_read_b128 v[20:23], v5 offset:1024
v_mfma_f32_16x16x32_bf16 v[68:71], v[40:43], a[28:31], v[68:71]
ds_read_b128 v[24:27], v5 offset:2048
v_mfma_f32_16x16x32_bf16 v[88:91], v[40:43], a[124:127], v[88:91]
ds_read_b128 v[28:31], v5 offset:3072
v_mfma_f32_16x16x32_bf16 v[72:75], v[44:47], a[28:31], v[72:75]
ds_read_b128 v[32:35], v5 offset:4096
v_mfma_f32_16x16x32_bf16 v[92:95], v[44:47], a[124:127], v[92:95]
v_mfma_f32_16x16x32_bf16 v[76:79], v[48:51], a[28:31], v[76:79]
v_mfma_f32_16x16x32_bf16 v[96:99], v[48:51], a[124:127], v[96:99]
buffer_load_dwordx4 a[60:63], v2, s[44:47], s12 offen offset:3072 sc1
buffer_load_dwordx4 a[156:159], v2, s[44:47], s14 offen offset:3072 sc1
v_mfma_f32_16x16x32_bf16 v[80:83], v[52:55], a[28:31], v[80:83]
v_mfma_f32_16x16x32_bf16 v[100:103], v[52:55], a[124:127], v[100:103]
s_waitcnt vmcnt(14) lgkmcnt(0)
v_mfma_f32_16x16x32_bf16 v[64:67], v[16:19], a[32:35], v[64:67]
ds_read_b128 v[36:39], v5 offset:5120
v_mfma_f32_16x16x32_bf16 v[84:87], v[16:19], a[128:131], v[84:87]
ds_read_b128 v[40:43], v5 offset:6144
v_mfma_f32_16x16x32_bf16 v[68:71], v[20:23], a[32:35], v[68:71]
ds_read_b128 v[44:47], v5 offset:7168
v_mfma_f32_16x16x32_bf16 v[88:91], v[20:23], a[128:131], v[88:91]
ds_read_b128 v[48:51], v5 offset:8192
v_mfma_f32_16x16x32_bf16 v[72:75], v[24:27], a[32:35], v[72:75]
ds_read_b128 v[52:55], v5 offset:9216
v_mfma_f32_16x16x32_bf16 v[92:95], v[24:27], a[128:131], v[92:95]
v_mfma_f32_16x16x32_bf16 v[76:79], v[28:31], a[32:35], v[76:79]
v_mfma_f32_16x16x32_bf16 v[96:99], v[28:31], a[128:131], v[96:99]
s_add_u32 s12, s12, 4096
s_add_u32 s14, s14, 4096
buffer_load_dwordx4 a[64:67], v2, s[44:47], s12 offen offset:0 sc1
buffer_load_dwordx4 a[160:163], v2, s[44:47], s14 offen offset:0 sc1
v_mfma_f32_16x16x32_bf16 v[80:83], v[32:35], a[32:35], v[80:83]
v_mfma_f32_16x16x32_bf16 v[100:103], v[32:35], a[128:131], v[100:103]
s_waitcnt lgkmcnt(0)
s_barrier
s_cmp_eq_u32 s4, 1
s_cbranch_scc1 L_w2d1_71
s_cmp_eq_u32 s4, 2
s_cbranch_scc1 L_w2d2_72
s_cmp_eq_u32 s4, 3
s_cbranch_scc1 L_w2d3_73
s_nop 0
L_w2d0_70:
s_mov_b32 m0, 0
s_add_u32 s79, s76, 76800
buffer_load_dwordx4 v2, s[44:47], s79 offen sc1 lds
s_mov_b32 m0, 4096
s_add_u32 s79, s76, 80896
buffer_load_dwordx4 v2, s[44:47], s79 offen sc1 lds
s_mov_b32 m0, 79872
s_add_u32 s79, s76, 202752
buffer_load_dwordx4 v2, s[44:47], s79 offen sc1 lds
s_mov_b32 m0, 7168
s_add_u32 s79, s76, 83968
buffer_load_dwordx4 v2, s[44:47], s79 offen sc1 lds
s_mov_b32 m0, 82944
s_add_u32 s79, s76, 205824
buffer_load_dwordx4 v2, s[44:47], s79 offen sc1 lds
s_mov_b32 m0, 10240
s_add_u32 s79, s76, 87040
buffer_load_dwordx4 v2, s[44:47], s79 offen sc1 lds
s_mov_b32 m0, 14336
s_add_u32 s79, s76, 91136
buffer_load_dwordx4 v2, s[44:47], s79 offen sc1 lds
s_mov_b32 m0, 90112
s_add_u32 s79, s76, 212992
buffer_load_dwordx4 v2, s[44:47], s79 offen sc1 lds
s_mov_b32 m0, 17408
s_add_u32 s79, s76, 94208
buffer_load_dwordx4 v2, s[44:47], s79 offen sc1 lds
s_mov_b32 m0, 93184
s_add_u32 s79, s76, 216064
buffer_load_dwordx4 v2, s[44:47], s79 offen sc1 lds
s_mov_b32 m0, 20480
s_add_u32 s79, s76, 97280
buffer_load_dwordx4 v2, s[44:47], s79 offen sc1 lds
s_mov_b32 m0, 24576
s_add_u32 s79, s76, 101376
buffer_load_dwordx4 v2, s[44:47], s79 offen sc1 lds
s_mov_b32 m0, 100352
s_add_u32 s79, s76, 223232
buffer_load_dwordx4 v2, s[44:47], s79 offen sc1 lds
s_mov_b32 m0, 27648
s_add_u32 s79, s76, 104448
buffer_load_dwordx4 v2, s[44:47], s79 offen sc1 lds
s_mov_b32 m0, 103424
s_add_u32 s79, s76, 226304
buffer_load_dwordx4 v2, s[44:47], s79 offen sc1 lds
s_mov_b32 m0, 30720
s_add_u32 s79, s76, 107520
buffer_load_dwordx4 v2, s[44:47], s79 offen sc1 lds
s_mov_b32 m0, 34816
s_add_u32 s79, s76, 111616
buffer_load_dwordx4 v2, s[44:47], s79 offen sc1 lds
s_mov_b32 m0, 110592
s_add_u32 s79, s76, 233472
buffer_load_dwordx4 v2, s[44:47], s79 offen sc1 lds
s_mov_b32 m0, 37888
s_add_u32 s79, s76, 114688
buffer_load_dwordx4 v2, s[44:47], s79 offen sc1 lds
s_mov_b32 m0, 113664
s_add_u32 s79, s76, 236544
buffer_load_dwordx4 v2, s[44:47], s79 offen sc1 lds
s_mov_b32 m0, 40960
s_add_u32 s79, s76, 117760
buffer_load_dwordx4 v2, s[44:47], s79 offen sc1 lds
s_mov_b32 m0, 45056
s_add_u32 s79, s76, 121856
buffer_load_dwordx4 v2, s[44:47], s79 offen sc1 lds
s_mov_b32 m0, 120832
s_add_u32 s79, s76, 243712
buffer_load_dwordx4 v2, s[44:47], s79 offen sc1 lds
s_branch L_w2de_74
L_w2d1_71:
s_mov_b32 m0, 1024
s_add_u32 s79, s76, 77824
buffer_load_dwordx4 v2, s[44:47], s79 offen sc1 lds
s_mov_b32 m0, 76800
s_add_u32 s79, s76, 199680
buffer_load_dwordx4 v2, s[44:47], s79 offen sc1 lds
s_mov_b32 m0, 80896
s_add_u32 s79, s76, 203776
buffer_load_dwordx4 v2, s[44:47], s79 offen sc1 lds
s_mov_b32 m0, 8192
s_add_u32 s79, s76, 84992
buffer_load_dwordx4 v2, s[44:47], s79 offen sc1 lds
s_mov_b32 m0, 83968
s_add_u32 s79, s76, 206848
buffer_load_dwordx4 v2, s[44:47], s79 offen sc1 lds
s_mov_b32 m0, 11264
s_add_u32 s79, s76, 88064
buffer_load_dwordx4 v2, s[44:47], s79 offen sc1 lds
s_mov_b32 m0, 87040
s_add_u32 s79, s76, 209920
buffer_load_dwordx4 v2, s[44:47], s79 offen sc1 lds
s_mov_b32 m0, 91136
s_add_u32 s79, s76, 214016
buffer_load_dwordx4 v2, s[44:47], s79 offen sc1 lds
s_mov_b32 m0, 18432
s_add_u32 s79, s76, 95232
buffer_load_dwordx4 v2, s[44:47], s79 offen sc1 lds
s_mov_b32 m0, 94208
s_add_u32 s79, s76, 217088
buffer_load_dwordx4 v2, s[44:47], s79 offen sc1 lds
s_mov_b32 m0, 21504
s_add_u32 s79, s76, 98304
buffer_load_dwordx4 v2, s[44:47], s79 offen sc1 lds
s_mov_b32 m0, 97280
s_add_u32 s79, s76, 220160
buffer_load_dwordx4 v2, s[44:47], s79 offen sc1 lds
s_mov_b32 m0, 101376
s_add_u32 s79, s76, 224256
buffer_load_dwordx4 v2, s[44:47], s79 offen sc1 lds
s_mov_b32 m0, 28672
s_add_u32 s79, s76, 105472
buffer_load_dwordx4 v2, s[44:47], s79 offen sc1 lds
s_mov_b32 m0, 104448
s_add_u32 s79, s76, 227328
buffer_load_dwordx4 v2, s[44:47], s79 offen sc1 lds
s_mov_b32 m0, 31744
s_add_u32 s79, s76, 108544
buffer_load_dwordx4 v2, s[44:47], s79 offen sc1 lds
s_mov_b32 m0, 107520
s_add_u32 s79, s76, 230400
buffer_load_dwordx4 v2, s[44:47], s79 offen sc1 lds
s_mov_b32 m0, 111616
s_add_u32 s79, s76, 234496
buffer_load_dwordx4 v2, s[44:47], s79 offen sc1 lds
s_mov_b32 m0, 38912
s_add_u32 s79, s76, 115712
buffer_load_dwordx4 v2, s[44:47], s79 offen sc1 lds
s_mov_b32 m0, 114688
s_add_u32 s79, s76, 237568
buffer_load_dwordx4 v2, s[44:47], s79 offen sc1 lds
s_mov_b32 m0, 41984
s_add_u32 s79, s76, 118784
buffer_load_dwordx4 v2, s[44:47], s79 offen sc1 lds
s_mov_b32 m0, 117760
s_add_u32 s79, s76, 240640
buffer_load_dwordx4 v2, s[44:47], s79 offen sc1 lds
s_mov_b32 m0, 121856
s_add_u32 s79, s76, 244736
buffer_load_dwordx4 v2, s[44:47], s79 offen sc1 lds
s_branch L_w2de_74
L_w2d2_72:
s_mov_b32 m0, 2048
s_add_u32 s79, s76, 78848
buffer_load_dwordx4 v2, s[44:47], s79 offen sc1 lds
s_mov_b32 m0, 77824
s_add_u32 s79, s76, 200704
buffer_load_dwordx4 v2, s[44:47], s79 offen sc1 lds
s_mov_b32 m0, 5120
s_add_u32 s79, s76, 81920
buffer_load_dwordx4 v2, s[44:47], s79 offen sc1 lds
s_mov_b32 m0, 9216
s_add_u32 s79, s76, 86016
buffer_load_dwordx4 v2, s[44:47], s79 offen sc1 lds
s_mov_b32 m0, 84992
s_add_u32 s79, s76, 207872
buffer_load_dwordx4 v2, s[44:47], s79 offen sc1 lds
s_mov_b32 m0, 12288
s_add_u32 s79, s76, 89088
buffer_load_dwordx4 v2, s[44:47], s79 offen sc1 lds
s_mov_b32 m0, 88064
s_add_u32 s79, s76, 210944
buffer_load_dwordx4 v2, s[44:47], s79 offen sc1 lds
s_mov_b32 m0, 15360
s_add_u32 s79, s76, 92160
buffer_load_dwordx4 v2, s[44:47], s79 offen sc1 lds
s_mov_b32 m0, 19456
s_add_u32 s79, s76, 96256
buffer_load_dwordx4 v2, s[44:47], s79 offen sc1 lds
s_mov_b32 m0, 95232
s_add_u32 s79, s76, 218112
buffer_load_dwordx4 v2, s[44:47], s79 offen sc1 lds
s_mov_b32 m0, 22528
s_add_u32 s79, s76, 99328
buffer_load_dwordx4 v2, s[44:47], s79 offen sc1 lds
s_mov_b32 m0, 98304
s_add_u32 s79, s76, 221184
buffer_load_dwordx4 v2, s[44:47], s79 offen sc1 lds
s_mov_b32 m0, 25600
s_add_u32 s79, s76, 102400
buffer_load_dwordx4 v2, s[44:47], s79 offen sc1 lds
s_mov_b32 m0, 29696
s_add_u32 s79, s76, 106496
buffer_load_dwordx4 v2, s[44:47], s79 offen sc1 lds
s_mov_b32 m0, 105472
s_add_u32 s79, s76, 228352
buffer_load_dwordx4 v2, s[44:47], s79 offen sc1 lds
s_mov_b32 m0, 32768
s_add_u32 s79, s76, 109568
buffer_load_dwordx4 v2, s[44:47], s79 offen sc1 lds
s_mov_b32 m0, 108544
s_add_u32 s79, s76, 231424
buffer_load_dwordx4 v2, s[44:47], s79 offen sc1 lds
s_mov_b32 m0, 35840
s_add_u32 s79, s76, 112640
buffer_load_dwordx4 v2, s[44:47], s79 offen sc1 lds
s_mov_b32 m0, 39936
s_add_u32 s79, s76, 116736
buffer_load_dwordx4 v2, s[44:47], s79 offen sc1 lds
s_mov_b32 m0, 115712
s_add_u32 s79, s76, 238592
buffer_load_dwordx4 v2, s[44:47], s79 offen sc1 lds
s_mov_b32 m0, 43008
s_add_u32 s79, s76, 119808
buffer_load_dwordx4 v2, s[44:47], s79 offen sc1 lds
s_mov_b32 m0, 118784
s_add_u32 s79, s76, 241664
buffer_load_dwordx4 v2, s[44:47], s79 offen sc1 lds
s_mov_b32 m0, 2048
s_add_u32 s79, s76, 78848
buffer_load_dwordx4 v2, s[44:47], s79 offen sc1 lds
s_branch L_w2de_74
L_w2d3_73:
s_mov_b32 m0, 3072
s_add_u32 s79, s76, 79872
buffer_load_dwordx4 v2, s[44:47], s79 offen sc1 lds
s_mov_b32 m0, 78848
s_add_u32 s79, s76, 201728
buffer_load_dwordx4 v2, s[44:47], s79 offen sc1 lds
s_mov_b32 m0, 6144
s_add_u32 s79, s76, 82944
buffer_load_dwordx4 v2, s[44:47], s79 offen sc1 lds
s_mov_b32 m0, 81920
s_add_u32 s79, s76, 204800
buffer_load_dwordx4 v2, s[44:47], s79 offen sc1 lds
s_mov_b32 m0, 86016
s_add_u32 s79, s76, 208896
buffer_load_dwordx4 v2, s[44:47], s79 offen sc1 lds
s_mov_b32 m0, 13312
s_add_u32 s79, s76, 90112
buffer_load_dwordx4 v2, s[44:47], s79 offen sc1 lds
s_mov_b32 m0, 89088
s_add_u32 s79, s76, 211968
buffer_load_dwordx4 v2, s[44:47], s79 offen sc1 lds
s_mov_b32 m0, 16384
s_add_u32 s79, s76, 93184
buffer_load_dwordx4 v2, s[44:47], s79 offen sc1 lds
s_mov_b32 m0, 92160
s_add_u32 s79, s76, 215040
buffer_load_dwordx4 v2, s[44:47], s79 offen sc1 lds
s_mov_b32 m0, 96256
s_add_u32 s79, s76, 219136
buffer_load_dwordx4 v2, s[44:47], s79 offen sc1 lds
s_mov_b32 m0, 23552
s_add_u32 s79, s76, 100352
buffer_load_dwordx4 v2, s[44:47], s79 offen sc1 lds
s_mov_b32 m0, 99328
s_add_u32 s79, s76, 222208
buffer_load_dwordx4 v2, s[44:47], s79 offen sc1 lds
s_mov_b32 m0, 26624
s_add_u32 s79, s76, 103424
buffer_load_dwordx4 v2, s[44:47], s79 offen sc1 lds
s_mov_b32 m0, 102400
s_add_u32 s79, s76, 225280
buffer_load_dwordx4 v2, s[44:47], s79 offen sc1 lds
s_mov_b32 m0, 106496
s_add_u32 s79, s76, 229376
buffer_load_dwordx4 v2, s[44:47], s79 offen sc1 lds
s_mov_b32 m0, 33792
s_add_u32 s79, s76, 110592
buffer_load_dwordx4 v2, s[44:47], s79 offen sc1 lds
s_mov_b32 m0, 109568
s_add_u32 s79, s76, 232448
buffer_load_dwordx4 v2, s[44:47], s79 offen sc1 lds
s_mov_b32 m0, 36864
s_add_u32 s79, s76, 113664
buffer_load_dwordx4 v2, s[44:47], s79 offen sc1 lds
s_mov_b32 m0, 112640
s_add_u32 s79, s76, 235520
buffer_load_dwordx4 v2, s[44:47], s79 offen sc1 lds
s_mov_b32 m0, 116736
s_add_u32 s79, s76, 239616
buffer_load_dwordx4 v2, s[44:47], s79 offen sc1 lds
s_mov_b32 m0, 44032
s_add_u32 s79, s76, 120832
buffer_load_dwordx4 v2, s[44:47], s79 offen sc1 lds
s_mov_b32 m0, 119808
s_add_u32 s79, s76, 242688
buffer_load_dwordx4 v2, s[44:47], s79 offen sc1 lds
s_mov_b32 m0, 3072
s_add_u32 s79, s76, 79872
buffer_load_dwordx4 v2, s[44:47], s79 offen sc1 lds
L_w2de_74:
s_waitcnt vmcnt(37) lgkmcnt(0)
v_mfma_f32_16x16x32_bf16 v[64:67], v[36:39], a[36:39], v[64:67]
ds_read_b128 v[16:19], v5 offset:10240
v_mfma_f32_16x16x32_bf16 v[84:87], v[36:39], a[132:135], v[84:87]
ds_read_b128 v[20:23], v5 offset:11264
v_mfma_f32_16x16x32_bf16 v[68:71], v[40:43], a[36:39], v[68:71]
ds_read_b128 v[24:27], v5 offset:12288
v_mfma_f32_16x16x32_bf16 v[88:91], v[40:43], a[132:135], v[88:91]
ds_read_b128 v[28:31], v5 offset:13312
v_mfma_f32_16x16x32_bf16 v[72:75], v[44:47], a[36:39], v[72:75]
ds_read_b128 v[32:35], v5 offset:14336
v_mfma_f32_16x16x32_bf16 v[92:95], v[44:47], a[132:135], v[92:95]
v_mfma_f32_16x16x32_bf16 v[76:79], v[48:51], a[36:39], v[76:79]
v_mfma_f32_16x16x32_bf16 v[96:99], v[48:51], a[132:135], v[96:99]
buffer_load_dwordx4 a[68:71], v2, s[44:47], s12 offen offset:1024 sc1
buffer_load_dwordx4 a[164:167], v2, s[44:47], s14 offen offset:1024 sc1
v_mfma_f32_16x16x32_bf16 v[80:83], v[52:55], a[36:39], v[80:83]
v_mfma_f32_16x16x32_bf16 v[100:103], v[52:55], a[132:135], v[100:103]
s_waitcnt vmcnt(37) lgkmcnt(0)
v_mfma_f32_16x16x32_bf16 v[64:67], v[16:19], a[40:43], v[64:67]
ds_read_b128 v[36:39], v5 offset:15360
v_mfma_f32_16x16x32_bf16 v[84:87], v[16:19], a[136:139], v[84:87]
ds_read_b128 v[40:43], v5 offset:16384
v_mfma_f32_16x16x32_bf16 v[68:71], v[20:23], a[40:43], v[68:71]
ds_read_b128 v[44:47], v5 offset:17408
v_mfma_f32_16x16x32_bf16 v[88:91], v[20:23], a[136:139], v[88:91]
ds_read_b128 v[48:51], v5 offset:18432
v_mfma_f32_16x16x32_bf16 v[72:75], v[24:27], a[40:43], v[72:75]
ds_read_b128 v[52:55], v5 offset:19456
v_mfma_f32_16x16x32_bf16 v[92:95], v[24:27], a[136:139], v[92:95]
v_mfma_f32_16x16x32_bf16 v[76:79], v[28:31], a[40:43], v[76:79]
v_mfma_f32_16x16x32_bf16 v[96:99], v[28:31], a[136:139], v[96:99]
buffer_load_dwordx4 a[72:75], v2, s[44:47], s12 offen offset:2048 sc1
buffer_load_dwordx4 a[168:171], v2, s[44:47], s14 offen offset:2048 sc1
v_mfma_f32_16x16x32_bf16 v[80:83], v[32:35], a[40:43], v[80:83]
v_mfma_f32_16x16x32_bf16 v[100:103], v[32:35], a[136:139], v[100:103]
s_waitcnt vmcnt(37) lgkmcnt(0)
v_mfma_f32_16x16x32_bf16 v[64:67], v[36:39], a[44:47], v[64:67]
ds_read_b128 v[16:19], v5 offset:20480
v_mfma_f32_16x16x32_bf16 v[84:87], v[36:39], a[140:143], v[84:87]
ds_read_b128 v[20:23], v5 offset:21504
v_mfma_f32_16x16x32_bf16 v[68:71], v[40:43], a[44:47], v[68:71]
ds_read_b128 v[24:27], v5 offset:22528
v_mfma_f32_16x16x32_bf16 v[88:91], v[40:43], a[140:143], v[88:91]
ds_read_b128 v[28:31], v5 offset:23552
v_mfma_f32_16x16x32_bf16 v[72:75], v[44:47], a[44:47], v[72:75]
ds_read_b128 v[32:35], v5 offset:24576
v_mfma_f32_16x16x32_bf16 v[92:95], v[44:47], a[140:143], v[92:95]
v_mfma_f32_16x16x32_bf16 v[76:79], v[48:51], a[44:47], v[76:79]
v_mfma_f32_16x16x32_bf16 v[96:99], v[48:51], a[140:143], v[96:99]
buffer_load_dwordx4 a[76:79], v2, s[44:47], s12 offen offset:3072 sc1
buffer_load_dwordx4 a[172:175], v2, s[44:47], s14 offen offset:3072 sc1
v_mfma_f32_16x16x32_bf16 v[80:83], v[52:55], a[44:47], v[80:83]
v_mfma_f32_16x16x32_bf16 v[100:103], v[52:55], a[140:143], v[100:103]
s_waitcnt vmcnt(37) lgkmcnt(0)
v_mfma_f32_16x16x32_bf16 v[64:67], v[16:19], a[48:51], v[64:67]
ds_read_b128 v[36:39], v5 offset:25600
v_mfma_f32_16x16x32_bf16 v[84:87], v[16:19], a[144:147], v[84:87]
ds_read_b128 v[40:43], v5 offset:26624
v_mfma_f32_16x16x32_bf16 v[68:71], v[20:23], a[48:51], v[68:71]
ds_read_b128 v[44:47], v5 offset:27648
v_mfma_f32_16x16x32_bf16 v[88:91], v[20:23], a[144:147], v[88:91]
ds_read_b128 v[48:51], v5 offset:28672
v_mfma_f32_16x16x32_bf16 v[72:75], v[24:27], a[48:51], v[72:75]
ds_read_b128 v[52:55], v5 offset:29696
v_mfma_f32_16x16x32_bf16 v[92:95], v[24:27], a[144:147], v[92:95]
v_mfma_f32_16x16x32_bf16 v[76:79], v[28:31], a[48:51], v[76:79]
v_mfma_f32_16x16x32_bf16 v[96:99], v[28:31], a[144:147], v[96:99]
s_add_u32 s12, s12, 4096
s_add_u32 s14, s14, 4096
buffer_load_dwordx4 a[80:83], v2, s[44:47], s12 offen offset:0 sc1
buffer_load_dwordx4 a[176:179], v2, s[44:47], s14 offen offset:0 sc1
v_mfma_f32_16x16x32_bf16 v[80:83], v[32:35], a[48:51], v[80:83]
v_mfma_f32_16x16x32_bf16 v[100:103], v[32:35], a[144:147], v[100:103]
s_waitcnt vmcnt(37) lgkmcnt(0)
v_mfma_f32_16x16x32_bf16 v[64:67], v[36:39], a[52:55], v[64:67]
ds_read_b128 v[16:19], v5 offset:30720
v_mfma_f32_16x16x32_bf16 v[84:87], v[36:39], a[148:151], v[84:87]
ds_read_b128 v[20:23], v5 offset:31744
v_mfma_f32_16x16x32_bf16 v[68:71], v[40:43], a[52:55], v[68:71]
ds_read_b128 v[24:27], v5 offset:32768
v_mfma_f32_16x16x32_bf16 v[88:91], v[40:43], a[148:151], v[88:91]
ds_read_b128 v[28:31], v5 offset:33792
v_mfma_f32_16x16x32_bf16 v[72:75], v[44:47], a[52:55], v[72:75]
ds_read_b128 v[32:35], v5 offset:34816
v_mfma_f32_16x16x32_bf16 v[92:95], v[44:47], a[148:151], v[92:95]
v_mfma_f32_16x16x32_bf16 v[76:79], v[48:51], a[52:55], v[76:79]
v_mfma_f32_16x16x32_bf16 v[96:99], v[48:51], a[148:151], v[96:99]
buffer_load_dwordx4 a[84:87], v2, s[44:47], s12 offen offset:1024 sc1
buffer_load_dwordx4 a[180:183], v2, s[44:47], s14 offen offset:1024 sc1
v_mfma_f32_16x16x32_bf16 v[80:83], v[52:55], a[52:55], v[80:83]
v_mfma_f32_16x16x32_bf16 v[100:103], v[52:55], a[148:151], v[100:103]
s_waitcnt vmcnt(37) lgkmcnt(0)
v_mfma_f32_16x16x32_bf16 v[64:67], v[16:19], a[56:59], v[64:67]
v_mfma_f32_16x16x32_bf16 v[84:87], v[16:19], a[152:155], v[84:87]
v_mfma_f32_16x16x32_bf16 v[68:71], v[20:23], a[56:59], v[68:71]
v_mfma_f32_16x16x32_bf16 v[88:91], v[20:23], a[152:155], v[88:91]
v_mfma_f32_16x16x32_bf16 v[72:75], v[24:27], a[56:59], v[72:75]
v_mfma_f32_16x16x32_bf16 v[92:95], v[24:27], a[152:155], v[92:95]
v_mfma_f32_16x16x32_bf16 v[76:79], v[28:31], a[56:59], v[76:79]
v_mfma_f32_16x16x32_bf16 v[96:99], v[28:31], a[152:155], v[96:99]
buffer_load_dwordx4 a[88:91], v2, s[44:47], s12 offen offset:2048 sc1
buffer_load_dwordx4 a[184:187], v2, s[44:47], s14 offen offset:2048 sc1
v_mfma_f32_16x16x32_bf16 v[80:83], v[32:35], a[56:59], v[80:83]
v_mfma_f32_16x16x32_bf16 v[100:103], v[32:35], a[152:155], v[100:103]
s_waitcnt vmcnt(12) lgkmcnt(0)
s_barrier
ds_read_b128 v[36:39], v4 offset:0
ds_read_b128 v[40:43], v4 offset:1024
ds_read_b128 v[44:47], v4 offset:2048
ds_read_b128 v[48:51], v4 offset:3072
ds_read_b128 v[52:55], v4 offset:4096
s_waitcnt lgkmcnt(0)
v_mfma_f32_16x16x32_bf16 v[64:67], v[36:39], a[60:63], v[64:67]
ds_read_b128 v[16:19], v4 offset:5120
v_mfma_f32_16x16x32_bf16 v[84:87], v[36:39], a[156:159], v[84:87]
ds_read_b128 v[20:23], v4 offset:6144
v_mfma_f32_16x16x32_bf16 v[68:71], v[40:43], a[60:63], v[68:71]
ds_read_b128 v[24:27], v4 offset:7168
v_mfma_f32_16x16x32_bf16 v[88:91], v[40:43], a[156:159], v[88:91]
ds_read_b128 v[28:31], v4 offset:8192
v_mfma_f32_16x16x32_bf16 v[72:75], v[44:47], a[60:63], v[72:75]
ds_read_b128 v[32:35], v4 offset:9216
v_mfma_f32_16x16x32_bf16 v[92:95], v[44:47], a[156:159], v[92:95]
v_mfma_f32_16x16x32_bf16 v[76:79], v[48:51], a[60:63], v[76:79]
v_mfma_f32_16x16x32_bf16 v[96:99], v[48:51], a[156:159], v[96:99]
buffer_load_dwordx4 a[92:95], v2, s[44:47], s12 offen offset:3072 sc1
buffer_load_dwordx4 a[188:191], v2, s[44:47], s14 offen offset:3072 sc1
v_mfma_f32_16x16x32_bf16 v[80:83], v[52:55], a[60:63], v[80:83]
v_mfma_f32_16x16x32_bf16 v[100:103], v[52:55], a[156:159], v[100:103]
s_waitcnt lgkmcnt(0)
v_mfma_f32_16x16x32_bf16 v[64:67], v[16:19], a[64:67], v[64:67]
ds_read_b128 v[36:39], v4 offset:10240
v_mfma_f32_16x16x32_bf16 v[84:87], v[16:19], a[160:163], v[84:87]
ds_read_b128 v[40:43], v4 offset:11264
v_mfma_f32_16x16x32_bf16 v[68:71], v[20:23], a[64:67], v[68:71]
ds_read_b128 v[44:47], v4 offset:12288
v_mfma_f32_16x16x32_bf16 v[88:91], v[20:23], a[160:163], v[88:91]
ds_read_b128 v[48:51], v4 offset:13312
v_mfma_f32_16x16x32_bf16 v[72:75], v[24:27], a[64:67], v[72:75]
ds_read_b128 v[52:55], v4 offset:14336
v_mfma_f32_16x16x32_bf16 v[92:95], v[24:27], a[160:163], v[92:95]
v_mfma_f32_16x16x32_bf16 v[76:79], v[28:31], a[64:67], v[76:79]
v_mfma_f32_16x16x32_bf16 v[96:99], v[28:31], a[160:163], v[96:99]
v_mfma_f32_16x16x32_bf16 v[80:83], v[32:35], a[64:67], v[80:83]
v_mfma_f32_16x16x32_bf16 v[100:103], v[32:35], a[160:163], v[100:103]
s_waitcnt vmcnt(12) lgkmcnt(0)
v_mfma_f32_16x16x32_bf16 v[64:67], v[36:39], a[68:71], v[64:67]
ds_read_b128 v[16:19], v4 offset:15360
v_mfma_f32_16x16x32_bf16 v[84:87], v[36:39], a[164:167], v[84:87]
ds_read_b128 v[20:23], v4 offset:16384
v_mfma_f32_16x16x32_bf16 v[68:71], v[40:43], a[68:71], v[68:71]
ds_read_b128 v[24:27], v4 offset:17408
v_mfma_f32_16x16x32_bf16 v[88:91], v[40:43], a[164:167], v[88:91]
ds_read_b128 v[28:31], v4 offset:18432
v_mfma_f32_16x16x32_bf16 v[72:75], v[44:47], a[68:71], v[72:75]
ds_read_b128 v[32:35], v4 offset:19456
v_mfma_f32_16x16x32_bf16 v[92:95], v[44:47], a[164:167], v[92:95]
v_mfma_f32_16x16x32_bf16 v[76:79], v[48:51], a[68:71], v[76:79]
v_mfma_f32_16x16x32_bf16 v[96:99], v[48:51], a[164:167], v[96:99]
v_mfma_f32_16x16x32_bf16 v[80:83], v[52:55], a[68:71], v[80:83]
v_mfma_f32_16x16x32_bf16 v[100:103], v[52:55], a[164:167], v[100:103]
s_waitcnt vmcnt(10) lgkmcnt(0)
v_mfma_f32_16x16x32_bf16 v[64:67], v[16:19], a[72:75], v[64:67]
ds_read_b128 v[36:39], v4 offset:20480
v_mfma_f32_16x16x32_bf16 v[84:87], v[16:19], a[168:171], v[84:87]
ds_read_b128 v[40:43], v4 offset:21504
v_mfma_f32_16x16x32_bf16 v[68:71], v[20:23], a[72:75], v[68:71]
ds_read_b128 v[44:47], v4 offset:22528
v_mfma_f32_16x16x32_bf16 v[88:91], v[20:23], a[168:171], v[88:91]
ds_read_b128 v[48:51], v4 offset:23552
v_mfma_f32_16x16x32_bf16 v[72:75], v[24:27], a[72:75], v[72:75]
ds_read_b128 v[52:55], v4 offset:24576
v_mfma_f32_16x16x32_bf16 v[92:95], v[24:27], a[168:171], v[92:95]
v_mfma_f32_16x16x32_bf16 v[76:79], v[28:31], a[72:75], v[76:79]
v_mfma_f32_16x16x32_bf16 v[96:99], v[28:31], a[168:171], v[96:99]
v_mfma_f32_16x16x32_bf16 v[80:83], v[32:35], a[72:75], v[80:83]
v_mfma_f32_16x16x32_bf16 v[100:103], v[32:35], a[168:171], v[100:103]
s_waitcnt vmcnt(8) lgkmcnt(0)
v_mfma_f32_16x16x32_bf16 v[64:67], v[36:39], a[76:79], v[64:67]
ds_read_b128 v[16:19], v4 offset:25600
v_mfma_f32_16x16x32_bf16 v[84:87], v[36:39], a[172:175], v[84:87]
ds_read_b128 v[20:23], v4 offset:26624
v_mfma_f32_16x16x32_bf16 v[68:71], v[40:43], a[76:79], v[68:71]
ds_read_b128 v[24:27], v4 offset:27648
v_mfma_f32_16x16x32_bf16 v[88:91], v[40:43], a[172:175], v[88:91]
ds_read_b128 v[28:31], v4 offset:28672
v_mfma_f32_16x16x32_bf16 v[72:75], v[44:47], a[76:79], v[72:75]
ds_read_b128 v[32:35], v4 offset:29696
v_mfma_f32_16x16x32_bf16 v[92:95], v[44:47], a[172:175], v[92:95]
v_mfma_f32_16x16x32_bf16 v[76:79], v[48:51], a[76:79], v[76:79]
v_mfma_f32_16x16x32_bf16 v[96:99], v[48:51], a[172:175], v[96:99]
v_mfma_f32_16x16x32_bf16 v[80:83], v[52:55], a[76:79], v[80:83]
v_mfma_f32_16x16x32_bf16 v[100:103], v[52:55], a[172:175], v[100:103]
s_waitcnt vmcnt(6) lgkmcnt(0)
v_mfma_f32_16x16x32_bf16 v[64:67], v[16:19], a[80:83], v[64:67]
ds_read_b128 v[36:39], v4 offset:30720
v_mfma_f32_16x16x32_bf16 v[84:87], v[16:19], a[176:179], v[84:87]
ds_read_b128 v[40:43], v4 offset:31744
v_mfma_f32_16x16x32_bf16 v[68:71], v[20:23], a[80:83], v[68:71]
ds_read_b128 v[44:47], v4 offset:32768
v_mfma_f32_16x16x32_bf16 v[88:91], v[20:23], a[176:179], v[88:91]
ds_read_b128 v[48:51], v4 offset:33792
v_mfma_f32_16x16x32_bf16 v[72:75], v[24:27], a[80:83], v[72:75]
ds_read_b128 v[52:55], v4 offset:34816
v_mfma_f32_16x16x32_bf16 v[92:95], v[24:27], a[176:179], v[92:95]
v_mfma_f32_16x16x32_bf16 v[76:79], v[28:31], a[80:83], v[76:79]
v_mfma_f32_16x16x32_bf16 v[96:99], v[28:31], a[176:179], v[96:99]
v_mfma_f32_16x16x32_bf16 v[80:83], v[32:35], a[80:83], v[80:83]
v_mfma_f32_16x16x32_bf16 v[100:103], v[32:35], a[176:179], v[100:103]
s_waitcnt vmcnt(4) lgkmcnt(0)
v_mfma_f32_16x16x32_bf16 v[64:67], v[36:39], a[84:87], v[64:67]
ds_read_b128 v[16:19], v4 offset:35840
v_mfma_f32_16x16x32_bf16 v[84:87], v[36:39], a[180:183], v[84:87]
ds_read_b128 v[20:23], v4 offset:36864
v_mfma_f32_16x16x32_bf16 v[68:71], v[40:43], a[84:87], v[68:71]
ds_read_b128 v[24:27], v4 offset:37888
v_mfma_f32_16x16x32_bf16 v[88:91], v[40:43], a[180:183], v[88:91]
ds_read_b128 v[28:31], v4 offset:38912
v_mfma_f32_16x16x32_bf16 v[72:75], v[44:47], a[84:87], v[72:75]
ds_read_b128 v[32:35], v4 offset:39936
v_mfma_f32_16x16x32_bf16 v[92:95], v[44:47], a[180:183], v[92:95]
v_mfma_f32_16x16x32_bf16 v[76:79], v[48:51], a[84:87], v[76:79]
v_mfma_f32_16x16x32_bf16 v[96:99], v[48:51], a[180:183], v[96:99]
v_mfma_f32_16x16x32_bf16 v[80:83], v[52:55], a[84:87], v[80:83]
v_mfma_f32_16x16x32_bf16 v[100:103], v[52:55], a[180:183], v[100:103]
s_waitcnt vmcnt(2) lgkmcnt(0)
v_mfma_f32_16x16x32_bf16 v[64:67], v[16:19], a[88:91], v[64:67]
ds_read_b128 v[36:39], v5 offset:0
v_mfma_f32_16x16x32_bf16 v[84:87], v[16:19], a[184:187], v[84:87]
ds_read_b128 v[40:43], v5 offset:1024
v_mfma_f32_16x16x32_bf16 v[68:71], v[20:23], a[88:91], v[68:71]
ds_read_b128 v[44:47], v5 offset:2048
v_mfma_f32_16x16x32_bf16 v[88:91], v[20:23], a[184:187], v[88:91]
ds_read_b128 v[48:51], v5 offset:3072
v_mfma_f32_16x16x32_bf16 v[72:75], v[24:27], a[88:91], v[72:75]
ds_read_b128 v[52:55], v5 offset:4096
v_mfma_f32_16x16x32_bf16 v[92:95], v[24:27], a[184:187], v[92:95]
v_mfma_f32_16x16x32_bf16 v[76:79], v[28:31], a[88:91], v[76:79]
v_mfma_f32_16x16x32_bf16 v[96:99], v[28:31], a[184:187], v[96:99]
v_mfma_f32_16x16x32_bf16 v[80:83], v[32:35], a[88:91], v[80:83]
v_mfma_f32_16x16x32_bf16 v[100:103], v[32:35], a[184:187], v[100:103]
s_waitcnt vmcnt(0) lgkmcnt(0)
v_mfma_f32_16x16x32_bf16 v[64:67], v[36:39], a[92:95], v[64:67]
v_mfma_f32_16x16x32_bf16 v[84:87], v[36:39], a[188:191], v[84:87]
v_mfma_f32_16x16x32_bf16 v[68:71], v[40:43], a[92:95], v[68:71]
v_mfma_f32_16x16x32_bf16 v[88:91], v[40:43], a[188:191], v[88:91]
v_mfma_f32_16x16x32_bf16 v[72:75], v[44:47], a[92:95], v[72:75]
v_mfma_f32_16x16x32_bf16 v[92:95], v[44:47], a[188:191], v[92:95]
v_mfma_f32_16x16x32_bf16 v[76:79], v[48:51], a[92:95], v[76:79]
v_mfma_f32_16x16x32_bf16 v[96:99], v[48:51], a[188:191], v[96:99]
v_mfma_f32_16x16x32_bf16 v[80:83], v[52:55], a[92:95], v[80:83]
v_mfma_f32_16x16x32_bf16 v[100:103], v[52:55], a[188:191], v[100:103]
s_mul_i32 s12, s4, 5120
s_add_u32 s12, s12, 0
v_add_u32 v8, s12, v2
s_xor_b32 s12, s4, 2
s_mul_i32 s12, s12, 5120
s_add_u32 s12, s12, 0
v_add_u32 v9, s12, v2
v_lshrrev_b32 v10, 4, v1
v_lshlrev_b32 v11, 4, v10
v_add_u32 v11, 153600, v11
s_barrier
ds_write_b128 v8, v[84:87] offset:0
ds_write_b128 v8, v[88:91] offset:1024
ds_write_b128 v8, v[92:95] offset:2048
ds_write_b128 v8, v[96:99] offset:3072
ds_write_b128 v8, v[100:103] offset:4096
ds_read_b128 v[36:39], v11 offset:960
ds_read_b128 v[40:43], v11 offset:1024
ds_read_b128 v[44:47], v11 offset:1088
ds_read_b128 v[48:51], v11 offset:1152
ds_read_b128 v[52:55], v11 offset:1216
ds_read_b128 v[132:135], v11 offset:640
ds_read_b128 v[136:139], v11 offset:704
ds_read_b128 v[140:143], v11 offset:768
ds_read_b128 v[144:147], v11 offset:832
ds_read_b128 v[148:151], v11 offset:896
s_mov_b32 s56, s36
s_mov_b32 s57, s37
s_mov_b32 s58, 0x280000
s_mov_b32 s59, 0x00020000
v_and_b32 v8, 15, v1
s_lshl_b32 s12, s42, 4
v_add_u32 v8, s12, v8
v_mul_u32_u24 v8, 1280, v8
v_lshl_add_u32 v15, v10, 3, v8
s_mul_i32 s12, s9, 160
s_waitcnt lgkmcnt(10)
s_barrier
ds_read_b128 v[16:19], v9 offset:0
ds_read_b128 v[20:23], v9 offset:1024
ds_read_b128 v[24:27], v9 offset:2048
ds_read_b128 v[28:31], v9 offset:3072
ds_read_b128 v[32:35], v9 offset:4096
s_waitcnt lgkmcnt(5)
v_add_f32 v64, v64, v36
v_add_f32 v65, v65, v37
v_add_f32 v66, v66, v38
v_add_f32 v67, v67, v39
v_add_f32 v68, v68, v40
v_add_f32 v69, v69, v41
v_add_f32 v70, v70, v42
v_add_f32 v71, v71, v43
v_add_f32 v72, v72, v44
v_add_f32 v73, v73, v45
v_add_f32 v74, v74, v46
v_add_f32 v75, v75, v47
v_add_f32 v76, v76, v48
v_add_f32 v77, v77, v49
v_add_f32 v78, v78, v50
v_add_f32 v79, v79, v51
v_add_f32 v80, v80, v52
v_add_f32 v81, v81, v53
v_add_f32 v82, v82, v54
v_add_f32 v83, v83, v55
s_waitcnt lgkmcnt(0)
v_add_f32 v64, v64, v16
v_add_f32 v65, v65, v17
v_add_f32 v66, v66, v18
v_add_f32 v67, v67, v19
v_lshlrev_b32 v56, 16, v214
v_and_b32 v57, 0xffff0000, v214
v_fmac_f32 v56, v132, v64
v_fmac_f32 v57, v133, v65
v_cvt_pk_bf16_f32 v104, v56, v57
v_lshlrev_b32 v56, 16, v215
v_and_b32 v57, 0xffff0000, v215
v_fmac_f32 v56, v134, v66
v_fmac_f32 v57, v135, v67
v_cvt_pk_bf16_f32 v105, v56, v57
buffer_store_dwordx2 v[104:105], v15, s[56:59], s12 offen offset:0
v_add_f32 v68, v68, v20
v_add_f32 v69, v69, v21
v_add_f32 v70, v70, v22
v_add_f32 v71, v71, v23
v_lshlrev_b32 v56, 16, v216
v_and_b32 v57, 0xffff0000, v216
v_fmac_f32 v56, v136, v68
v_fmac_f32 v57, v137, v69
v_cvt_pk_bf16_f32 v106, v56, v57
v_lshlrev_b32 v56, 16, v217
v_and_b32 v57, 0xffff0000, v217
v_fmac_f32 v56, v138, v70
v_fmac_f32 v57, v139, v71
v_cvt_pk_bf16_f32 v107, v56, v57
buffer_store_dwordx2 v[106:107], v15, s[56:59], s12 offen offset:32
v_add_f32 v72, v72, v24
v_add_f32 v73, v73, v25
v_add_f32 v74, v74, v26
v_add_f32 v75, v75, v27
v_lshlrev_b32 v56, 16, v218
v_and_b32 v57, 0xffff0000, v218
v_fmac_f32 v56, v140, v72
v_fmac_f32 v57, v141, v73
v_cvt_pk_bf16_f32 v108, v56, v57
v_lshlrev_b32 v56, 16, v219
v_and_b32 v57, 0xffff0000, v219
v_fmac_f32 v56, v142, v74
v_fmac_f32 v57, v143, v75
v_cvt_pk_bf16_f32 v109, v56, v57
buffer_store_dwordx2 v[108:109], v15, s[56:59], s12 offen offset:64
v_add_f32 v76, v76, v28
v_add_f32 v77, v77, v29
v_add_f32 v78, v78, v30
v_add_f32 v79, v79, v31
v_lshlrev_b32 v56, 16, v220
v_and_b32 v57, 0xffff0000, v220
v_fmac_f32 v56, v144, v76
v_fmac_f32 v57, v145, v77
v_cvt_pk_bf16_f32 v110, v56, v57
v_lshlrev_b32 v56, 16, v221
v_and_b32 v57, 0xffff0000, v221
v_fmac_f32 v56, v146, v78
v_fmac_f32 v57, v147, v79
v_cvt_pk_bf16_f32 v111, v56, v57
buffer_store_dwordx2 v[110:111], v15, s[56:59], s12 offen offset:96
v_add_f32 v80, v80, v32
v_add_f32 v81, v81, v33
v_add_f32 v82, v82, v34
v_add_f32 v83, v83, v35
v_lshlrev_b32 v56, 16, v222
v_and_b32 v57, 0xffff0000, v222
v_fmac_f32 v56, v148, v80
v_fmac_f32 v57, v149, v81
v_cvt_pk_bf16_f32 v112, v56, v57
v_lshlrev_b32 v56, 16, v223
v_and_b32 v57, 0xffff0000, v223
v_fmac_f32 v56, v150, v82
v_fmac_f32 v57, v151, v83
v_cvt_pk_bf16_f32 v113, v56, v57
buffer_store_dwordx2 v[112:113], v15, s[56:59], s12 offen offset:128
L_end:
s_endpgm
L_slow_26:
s_waitcnt lgkmcnt(0)
s_nop 7
s_nop 7
ds_read_b128 a[16:19], v6 offset:20480
ds_read_b64 a[20:21], v7 offset:20480
ds_read_b128 a[0:3], v6 offset:0
ds_read_b64 a[4:5], v7 offset:0
ds_read_b128 a[8:11], v6 offset:17920
ds_read_b64 a[12:13], v7 offset:17920
s_waitcnt lgkmcnt(4)
v_mfma_f32_32x32x16_bf16 v[32:47], a[16:19], v[224:227], 0
v_mfma_f32_32x32x8bf16_1k v[32:47], a[20:21], v[236:237], v[32:47]
s_waitcnt lgkmcnt(2)
v_mfma_f32_32x32x16_bf16 v[16:31], a[0:3], v[224:227], 0
v_mfma_f32_32x32x8bf16_1k v[16:31], a[4:5], v[236:237], v[16:31]
ds_read_b128 a[0:3], v6 offset:15360
ds_read_b64 a[4:5], v7 offset:15360
s_nop 7
s_nop 4
s_cmp_eq_u32 s13, 0
s_cbranch_scc1 L_s1_75
v_mov_b32 v16, 0xff800000
v_mov_b32 v17, 0xff800000
v_mov_b32 v18, 0xff800000
v_mov_b32 v19, 0xff800000
v_mov_b32 v20, 0xff800000
v_mov_b32 v21, 0xff800000
v_mov_b32 v22, 0xff800000
v_mov_b32 v23, 0xff800000
v_mov_b32 v24, 0xff800000
v_mov_b32 v25, 0xff800000
v_mov_b32 v26, 0xff800000
v_mov_b32 v27, 0xff800000
v_mov_b32 v28, 0xff800000
v_mov_b32 v29, 0xff800000
v_mov_b32 v30, 0xff800000
v_mov_b32 v31, 0xff800000
L_s1_75:
v_cndmask_b32 v48, v16, v32, s[68:69]
v_cndmask_b32 v49, v17, v33, s[70:71]
v_cndmask_b32 v50, v18, v34, s[72:73]
v_cndmask_b32 v51, v19, v35, s[74:75]
v_cndmask_b32 v52, v20, v36, s[76:77]
v_cndmask_b32 v53, v21, v37, s[78:79]
v_cndmask_b32 v54, v22, v38, s[80:81]
v_cndmask_b32 v55, v23, v39, s[82:83]
v_cndmask_b32 v56, v24, v40, s[84:85]
v_cndmask_b32 v57, v25, v41, s[86:87]
v_cndmask_b32 v58, v26, v42, s[88:89]
v_cndmask_b32 v59, v27, v43, s[90:91]
v_cndmask_b32 v60, v28, v44, s[92:93]
v_cndmask_b32 v61, v29, v45, s[94:95]
v_cndmask_b32 v62, v30, v46, s[96:97]
v_cndmask_b32 v63, v31, v47, s[98:99]
s_waitcnt lgkmcnt(2)
v_mfma_f32_32x32x16_bf16 v[16:31], a[8:11], v[224:227], 0
v_mfma_f32_32x32x8bf16_1k v[16:31], a[12:13], v[236:237], v[16:31]
v_max3_f32 v8, v48, v49, v50
v_max3_f32 v8, v8, v51, v52
v_max3_f32 v8, v8, v53, v54
v_max3_f32 v8, v8, v55, v56
v_max3_f32 v8, v8, v57, v58
v_max3_f32 v8, v8, v59, v60
v_max3_f32 v8, v8, v61, v62
v_max_f32 v8, v8, v63
s_cmp_gt_u32 s13, 7
s_cbranch_scc1 L_p1d_76
ds_read_b128 a[16:19], v6 offset:12800
ds_read_b64 a[20:21], v7 offset:12800
s_waitcnt lgkmcnt(2)
v_mfma_f32_32x32x16_bf16 v[32:47], a[0:3], v[224:227], 0
v_max3_f32 v8, v8, v16, v17
v_max3_f32 v8, v8, v18, v19
v_max3_f32 v8, v8, v20, v21
v_max3_f32 v8, v8, v22, v23
v_mfma_f32_32x32x8bf16_1k v[32:47], a[4:5], v[236:237], v[32:47]
v_max3_f32 v8, v8, v24, v25
v_max3_f32 v8, v8, v26, v27
v_max3_f32 v8, v8, v28, v29
v_max3_f32 v8, v8, v30, v31
s_cmp_gt_u32 s13, 6
s_cbranch_scc1 L_p1d_76
ds_read_b128 a[8:11], v6 offset:10240
ds_read_b64 a[12:13], v7 offset:10240
s_waitcnt lgkmcnt(2)
v_mfma_f32_32x32x16_bf16 v[16:31], a[16:19], v[224:227], 0
s_nop 1
v_max3_f32 v8, v8, v32, v33
v_max3_f32 v8, v8, v34, v35
v_max3_f32 v8, v8, v36, v37
v_max3_f32 v8, v8, v38, v39
v_mfma_f32_32x32x8bf16_1k v[16:31], a[20:21], v[236:237], v[16:31]
v_max3_f32 v8, v8, v40, v41
v_max3_f32 v8, v8, v42, v43
v_max3_f32 v8, v8, v44, v45
v_max3_f32 v8, v8, v46, v47
s_cmp_gt_u32 s13, 5
s_cbranch_scc1 L_p1d_76
ds_read_b128 a[0:3], v6 offset:7680
ds_read_b64 a[4:5], v7 offset:7680
s_waitcnt lgkmcnt(2)
v_mfma_f32_32x32x16_bf16 v[32:47], a[8:11], v[224:227], 0
s_nop 1
v_max3_f32 v8, v8, v16, v17
v_max3_f32 v8, v8, v18, v19
v_max3_f32 v8, v8, v20, v21
v_max3_f32 v8, v8, v22, v23
v_mfma_f32_32x32x8bf16_1k v[32:47], a[12:13], v[236:237], v[32:47]
v_max3_f32 v8, v8, v24, v25
v_max3_f32 v8, v8, v26, v27
v_max3_f32 v8, v8, v28, v29
v_max3_f32 v8, v8, v30, v31
s_cmp_gt_u32 s13, 4
s_cbranch_scc1 L_p1d_76
ds_read_b128 a[16:19], v6 offset:5120
ds_read_b64 a[20:21], v7 offset:5120
s_waitcnt lgkmcnt(2)
v_mfma_f32_32x32x16_bf16 v[16:31], a[0:3], v[224:227], 0
s_nop 1
v_max3_f32 v8, v8, v32, v33
v_max3_f32 v8, v8, v34, v35
v_max3_f32 v8, v8, v36, v37
v_max3_f32 v8, v8, v38, v39
v_mfma_f32_32x32x8bf16_1k v[16:31], a[4:5], v[236:237], v[16:31]
v_max3_f32 v8, v8, v40, v41
v_max3_f32 v8, v8, v42, v43
v_max3_f32 v8, v8, v44, v45
v_max3_f32 v8, v8, v46, v47
s_cmp_gt_u32 s13, 3
s_cbranch_scc1 L_p1d_76
ds_read_b128 a[8:11], v6 offset:2560
ds_read_b64 a[12:13], v7 offset:2560
s_waitcnt lgkmcnt(2)
v_mfma_f32_32x32x16_bf16 v[32:47], a[16:19], v[224:227], 0
s_nop 1
v_max3_f32 v8, v8, v16, v17
v_max3_f32 v8, v8, v18, v19
v_max3_f32 v8, v8, v20, v21
v_max3_f32 v8, v8, v22, v23
v_mfma_f32_32x32x8bf16_1k v[32:47], a[20:21], v[236:237], v[32:47]
v_max3_f32 v8, v8, v24, v25
v_max3_f32 v8, v8, v26, v27
v_max3_f32 v8, v8, v28, v29
v_max3_f32 v8, v8, v30, v31
s_cmp_gt_u32 s13, 2
s_cbranch_scc1 L_p1d_76
s_waitcnt lgkmcnt(0)
v_mfma_f32_32x32x16_bf16 v[16:31], a[8:11], v[224:227], 0
s_nop 3
v_max3_f32 v8, v8, v32, v33
v_max3_f32 v8, v8, v34, v35
v_max3_f32 v8, v8, v36, v37
v_max3_f32 v8, v8, v38, v39
v_mfma_f32_32x32x8bf16_1k v[16:31], a[12:13], v[236:237], v[16:31]
v_max3_f32 v8, v8, v40, v41
v_max3_f32 v8, v8, v42, v43
v_max3_f32 v8, v8, v44, v45
v_max3_f32 v8, v8, v46, v47
s_cmp_gt_u32 s13, 1
s_cbranch_scc1 L_p1d_76
s_nop 7
s_nop 3
v_max3_f32 v8, v8, v16, v17
v_max3_f32 v8, v8, v18, v19
v_max3_f32 v8, v8, v20, v21
v_max3_f32 v8, v8, v22, v23
v_max3_f32 v8, v8, v24, v25
v_max3_f32 v8, v8, v26, v27
v_max3_f32 v8, v8, v28, v29
v_max3_f32 v8, v8, v30, v31
L_p1d_76:
s_waitcnt lgkmcnt(0)
ds_read_b128 a[8:11], v6 offset:17920
ds_read_b64 a[12:13], v7 offset:17920
ds_read_b64_tr_b16 a[96:97], v4 offset:24576
ds_read_b64_tr_b16 a[98:99], v4 offset:24832
ds_read_b64_tr_b16 a[100:101], v4 offset:25088
ds_read_b64_tr_b16 a[102:103], v4 offset:25344
ds_read_b64_tr_b16 a[104:105], v4 offset:0
ds_read_b64_tr_b16 a[106:107], v4 offset:256
ds_read_b64_tr_b16 a[108:109], v4 offset:512
ds_read_b64_tr_b16 a[110:111], v4 offset:768
ds_read_b128 a[0:3], v6 offset:15360
ds_read_b64 a[4:5], v7 offset:15360
v_mov_b32 v9, v8
s_nop 1
v_permlane32_swap_b32 v8, v9
v_max_f32 v8, v8, v9
v_sub_f32 v9, 0, v8
v_mov_b32 v64, v9
v_mov_b32 v65, v9
v_mov_b32 v66, v9
v_mov_b32 v67, v9
v_mov_b32 v68, v9
v_mov_b32 v69, v9
v_mov_b32 v70, v9
v_mov_b32 v71, v9
v_mov_b32 v72, v9
v_mov_b32 v73, v9
v_mov_b32 v74, v9
v_mov_b32 v75, v9
v_mov_b32 v76, v9
v_mov_b32 v77, v9
v_mov_b32 v78, v9
v_mov_b32 v79, v9
s_waitcnt lgkmcnt(10)
s_nop 0
v_mfma_f32_32x32x16_bf16 v[16:31], a[8:11], v[224:227], v[64:79]
v_add_f32 v48, v48, v9
v_add_f32 v49, v49, v9
v_add_f32 v50, v50, v9
v_add_f32 v51, v51, v9
v_add_f32 v52, v52, v9
v_add_f32 v53, v53, v9
v_add_f32 v54, v54, v9
v_add_f32 v55, v55, v9
v_mfma_f32_32x32x8bf16_1k v[16:31], a[12:13], v[236:237], v[16:31]
v_add_f32 v56, v56, v9
v_add_f32 v57, v57, v9
v_add_f32 v58, v58, v9
v_add_f32 v59, v59, v9
v_add_f32 v60, v60, v9
v_add_f32 v61, v61, v9
v_add_f32 v62, v62, v9
v_add_f32 v63, v63, v9
v_exp_f32 v48, v48
v_exp_f32 v49, v49
v_exp_f32 v50, v50
v_exp_f32 v51, v51
v_exp_f32 v52, v52
v_exp_f32 v53, v53
v_exp_f32 v54, v54
v_exp_f32 v55, v55
v_exp_f32 v56, v56
v_exp_f32 v57, v57
v_exp_f32 v58, v58
v_exp_f32 v59, v59
v_exp_f32 v60, v60
v_exp_f32 v61, v61
v_exp_f32 v62, v62
v_exp_f32 v63, v63
v_cvt_pk_bf16_f32 v80, v48, v49
v_cvt_pk_bf16_f32 v81, v50, v51
v_cvt_pk_bf16_f32 v82, v52, v53
v_cvt_pk_bf16_f32 v83, v54, v55
v_cvt_pk_bf16_f32 v84, v56, v57
v_cvt_pk_bf16_f32 v85, v58, v59
v_cvt_pk_bf16_f32 v86, v60, v61
v_cvt_pk_bf16_f32 v87, v62, v63
v_and_b32 v88, v112, v80
v_and_b32 v89, v113, v81
v_and_b32 v90, v114, v82
v_and_b32 v91, v115, v83
v_and_b32 v92, v116, v84
v_and_b32 v93, v117, v85
v_and_b32 v94, v118, v86
v_and_b32 v95, v119, v87
s_waitcnt lgkmcnt(2)
v_mfma_f32_32x32x16_bf16 v[96:111], a[96:99], v[88:91], 0
v_xor_b32 v80, v80, v88
v_xor_b32 v81, v81, v89
v_xor_b32 v82, v82, v90
v_xor_b32 v83, v83, v91
v_mfma_f32_32x32x16_bf16 v[96:111], a[100:103], v[92:95], v[96:111]
v_xor_b32 v84, v84, v92
v_xor_b32 v85, v85, v93
v_xor_b32 v86, v86, v94
v_xor_b32 v87, v87, v95
s_cmp_eq_u32 s13, 0
s_cbranch_scc0 L_v0_77
v_mfma_f32_32x32x16_bf16 v[96:111], a[104:107], v[80:83], v[96:111]
v_mfma_f32_32x32x16_bf16 v[96:111], a[108:111], v[84:87], v[96:111]
L_v0_77:
s_cmp_gt_u32 s13, 7
s_cbranch_scc1 L_p2e_78
s_waitcnt lgkmcnt(0)
v_mfma_f32_32x32x16_bf16 v[32:47], a[0:3], v[224:227], v[64:79]
v_exp_f32 v16, v16
v_exp_f32 v17, v17
v_exp_f32 v18, v18
ds_read_b64_tr_b16 a[104:105], v4 offset:21504
ds_read_b64_tr_b16 a[106:107], v4 offset:21760
ds_read_b64_tr_b16 a[108:109], v4 offset:22016
v_mfma_f32_32x32x8bf16_1k v[32:47], a[4:5], v[236:237], v[32:47]
v_exp_f32 v19, v19
v_cvt_pk_bf16_f32 v88, v16, v17
v_exp_f32 v20, v20
ds_read_b64_tr_b16 a[110:111], v4 offset:22272
ds_read_b128 a[16:19], v6 offset:12800
ds_read_b64 a[20:21], v7 offset:12800
v_exp_f32 v21, v21
v_cvt_pk_bf16_f32 v89, v18, v19
v_exp_f32 v22, v22
v_exp_f32 v23, v23
v_cvt_pk_bf16_f32 v90, v20, v21
v_exp_f32 v24, v24
v_exp_f32 v25, v25
v_cvt_pk_bf16_f32 v91, v22, v23
v_exp_f32 v26, v26
v_exp_f32 v27, v27
v_cvt_pk_bf16_f32 v92, v24, v25
v_exp_f32 v28, v28
v_exp_f32 v29, v29
v_cvt_pk_bf16_f32 v93, v26, v27
v_exp_f32 v30, v30
v_exp_f32 v31, v31
v_cvt_pk_bf16_f32 v94, v28, v29
v_cvt_pk_bf16_f32 v95, v30, v31
s_cmp_gt_u32 s13, 6
s_cbranch_scc1 L_fl1_80
s_waitcnt lgkmcnt(0)
v_mfma_f32_32x32x16_bf16 v[96:111], a[104:107], v[88:91], v[96:111]
v_exp_f32 v32, v32
v_exp_f32 v33, v33
v_exp_f32 v34, v34
v_mfma_f32_32x32x16_bf16 v[96:111], a[108:111], v[92:95], v[96:111]
v_exp_f32 v35, v35
v_cvt_pk_bf16_f32 v80, v32, v33
v_exp_f32 v36, v36
v_mfma_f32_32x32x16_bf16 v[16:31], a[16:19], v[224:227], v[64:79]
v_exp_f32 v37, v37
v_cvt_pk_bf16_f32 v81, v34, v35
v_exp_f32 v38, v38
ds_read_b64_tr_b16 a[96:97], v4 offset:18432
ds_read_b64_tr_b16 a[98:99], v4 offset:18688
ds_read_b64_tr_b16 a[100:101], v4 offset:18944
v_mfma_f32_32x32x8bf16_1k v[16:31], a[20:21], v[236:237], v[16:31]
v_exp_f32 v39, v39
v_cvt_pk_bf16_f32 v82, v36, v37
v_exp_f32 v40, v40
ds_read_b64_tr_b16 a[102:103], v4 offset:19200
ds_read_b128 a[8:11], v6 offset:10240
ds_read_b64 a[12:13], v7 offset:10240
v_exp_f32 v41, v41
v_cvt_pk_bf16_f32 v83, v38, v39
v_exp_f32 v42, v42
v_exp_f32 v43, v43
v_cvt_pk_bf16_f32 v84, v40, v41
v_exp_f32 v44, v44
v_exp_f32 v45, v45
v_cvt_pk_bf16_f32 v85, v42, v43
v_exp_f32 v46, v46
v_exp_f32 v47, v47
v_cvt_pk_bf16_f32 v86, v44, v45
v_cvt_pk_bf16_f32 v87, v46, v47
s_cmp_gt_u32 s13, 5
s_cbranch_scc1 L_fl0_79
s_waitcnt lgkmcnt(0)
v_mfma_f32_32x32x16_bf16 v[96:111], a[96:99], v[80:83], v[96:111]
v_exp_f32 v16, v16
v_exp_f32 v17, v17
v_exp_f32 v18, v18
v_mfma_f32_32x32x16_bf16 v[96:111], a[100:103], v[84:87], v[96:111]
v_exp_f32 v19, v19
v_cvt_pk_bf16_f32 v88, v16, v17
v_exp_f32 v20, v20
v_mfma_f32_32x32x16_bf16 v[32:47], a[8:11], v[224:227], v[64:79]
v_exp_f32 v21, v21
v_cvt_pk_bf16_f32 v89, v18, v19
v_exp_f32 v22, v22
ds_read_b64_tr_b16 a[104:105], v4 offset:15360
ds_read_b64_tr_b16 a[106:107], v4 offset:15616
ds_read_b64_tr_b16 a[108:109], v4 offset:15872
v_mfma_f32_32x32x8bf16_1k v[32:47], a[12:13], v[236:237], v[32:47]
v_exp_f32 v23, v23
v_cvt_pk_bf16_f32 v90, v20, v21
v_exp_f32 v24, v24
ds_read_b64_tr_b16 a[110:111], v4 offset:16128
ds_read_b128 a[0:3], v6 offset:7680
ds_read_b64 a[4:5], v7 offset:7680
v_exp_f32 v25, v25
v_cvt_pk_bf16_f32 v91, v22, v23
v_exp_f32 v26, v26
v_exp_f32 v27, v27
v_cvt_pk_bf16_f32 v92, v24, v25
v_exp_f32 v28, v28
v_exp_f32 v29, v29
v_cvt_pk_bf16_f32 v93, v26, v27
v_exp_f32 v30, v30
v_exp_f32 v31, v31
v_cvt_pk_bf16_f32 v94, v28, v29
v_cvt_pk_bf16_f32 v95, v30, v31
s_cmp_gt_u32 s13, 4
s_cbranch_scc1 L_fl1_80
s_waitcnt lgkmcnt(0)
v_mfma_f32_32x32x16_bf16 v[96:111], a[104:107], v[88:91], v[96:111]
v_exp_f32 v32, v32
v_exp_f32 v33, v33
v_exp_f32 v34, v34
v_mfma_f32_32x32x16_bf16 v[96:111], a[108:111], v[92:95], v[96:111]
v_exp_f32 v35, v35
v_cvt_pk_bf16_f32 v80, v32, v33
v_exp_f32 v36, v36
v_mfma_f32_32x32x16_bf16 v[16:31], a[0:3], v[224:227], v[64:79]
v_exp_f32 v37, v37
v_cvt_pk_bf16_f32 v81, v34, v35
v_exp_f32 v38, v38
ds_read_b64_tr_b16 a[96:97], v4 offset:12288
ds_read_b64_tr_b16 a[98:99], v4 offset:12544
ds_read_b64_tr_b16 a[100:101], v4 offset:12800
v_mfma_f32_32x32x8bf16_1k v[16:31], a[4:5], v[236:237], v[16:31]
v_exp_f32 v39, v39
v_cvt_pk_bf16_f32 v82, v36, v37
v_exp_f32 v40, v40
ds_read_b64_tr_b16 a[102:103], v4 offset:13056
ds_read_b128 a[16:19], v6 offset:5120
ds_read_b64 a[20:21], v7 offset:5120
v_exp_f32 v41, v41
v_cvt_pk_bf16_f32 v83, v38, v39
v_exp_f32 v42, v42
v_exp_f32 v43, v43
v_cvt_pk_bf16_f32 v84, v40, v41
v_exp_f32 v44, v44
v_exp_f32 v45, v45
v_cvt_pk_bf16_f32 v85, v42, v43
v_exp_f32 v46, v46
v_exp_f32 v47, v47
v_cvt_pk_bf16_f32 v86, v44, v45
v_cvt_pk_bf16_f32 v87, v46, v47
s_cmp_gt_u32 s13, 3
s_cbranch_scc1 L_fl0_79
s_waitcnt lgkmcnt(0)
v_mfma_f32_32x32x16_bf16 v[96:111], a[96:99], v[80:83], v[96:111]
v_exp_f32 v16, v16
v_exp_f32 v17, v17
v_exp_f32 v18, v18
v_mfma_f32_32x32x16_bf16 v[96:111], a[100:103], v[84:87], v[96:111]
v_exp_f32 v19, v19
v_cvt_pk_bf16_f32 v88, v16, v17
v_exp_f32 v20, v20
v_mfma_f32_32x32x16_bf16 v[32:47], a[16:19], v[224:227], v[64:79]
v_exp_f32 v21, v21
v_cvt_pk_bf16_f32 v89, v18, v19
v_exp_f32 v22, v22
ds_read_b64_tr_b16 a[104:105], v4 offset:9216
ds_read_b64_tr_b16 a[106:107], v4 offset:9472
ds_read_b64_tr_b16 a[108:109], v4 offset:9728
v_mfma_f32_32x32x8bf16_1k v[32:47], a[20:21], v[236:237], v[32:47]
v_exp_f32 v23, v23
v_cvt_pk_bf16_f32 v90, v20, v21
v_exp_f32 v24, v24
ds_read_b64_tr_b16 a[110:111], v4 offset:9984
ds_read_b128 a[8:11], v6 offset:2560
ds_read_b64 a[12:13], v7 offset:2560
v_exp_f32 v25, v25
v_cvt_pk_bf16_f32 v91, v22, v23
v_exp_f32 v26, v26
v_exp_f32 v27, v27
v_cvt_pk_bf16_f32 v92, v24, v25
v_exp_f32 v28, v28
v_exp_f32 v29, v29
v_cvt_pk_bf16_f32 v93, v26, v27
v_exp_f32 v30, v30
v_exp_f32 v31, v31
v_cvt_pk_bf16_f32 v94, v28, v29
v_cvt_pk_bf16_f32 v95, v30, v31
s_cmp_gt_u32 s13, 2
s_cbranch_scc1 L_fl1_80
s_waitcnt lgkmcnt(0)
v_mfma_f32_32x32x16_bf16 v[96:111], a[104:107], v[88:91], v[96:111]
v_exp_f32 v32, v32
v_exp_f32 v33, v33
v_exp_f32 v34, v34
v_mfma_f32_32x32x16_bf16 v[96:111], a[108:111], v[92:95], v[96:111]
v_exp_f32 v35, v35
v_cvt_pk_bf16_f32 v80, v32, v33
v_exp_f32 v36, v36
v_mfma_f32_32x32x16_bf16 v[16:31], a[8:11], v[224:227], v[64:79]
v_exp_f32 v37, v37
v_cvt_pk_bf16_f32 v81, v34, v35
v_exp_f32 v38, v38
ds_read_b64_tr_b16 a[96:97], v4 offset:6144
ds_read_b64_tr_b16 a[98:99], v4 offset:6400
ds_read_b64_tr_b16 a[100:101], v4 offset:6656
v_mfma_f32_32x32x8bf16_1k v[16:31], a[12:13], v[236:237], v[16:31]
v_exp_f32 v39, v39
v_cvt_pk_bf16_f32 v82, v36, v37
v_exp_f32 v40, v40
ds_read_b64_tr_b16 a[102:103], v4 offset:6912
v_exp_f32 v41, v41
v_cvt_pk_bf16_f32 v83, v38, v39
v_exp_f32 v42, v42
v_exp_f32 v43, v43
v_cvt_pk_bf16_f32 v84, v40, v41
v_exp_f32 v44, v44
v_exp_f32 v45, v45
v_cvt_pk_bf16_f32 v85, v42, v43
v_exp_f32 v46, v46
v_exp_f32 v47, v47
v_cvt_pk_bf16_f32 v86, v44, v45
v_cvt_pk_bf16_f32 v87, v46, v47
s_cmp_gt_u32 s13, 1
s_cbranch_scc1 L_fl0_79
s_waitcnt lgkmcnt(0)
v_mfma_f32_32x32x16_bf16 v[96:111], a[96:99], v[80:83], v[96:111]
v_exp_f32 v16, v16
v_exp_f32 v17, v17
v_exp_f32 v18, v18
ds_read_b64_tr_b16 a[104:105], v4 offset:3072
ds_read_b64_tr_b16 a[106:107], v4 offset:3328
ds_read_b64_tr_b16 a[108:109], v4 offset:3584
v_mfma_f32_32x32x16_bf16 v[96:111], a[100:103], v[84:87], v[96:111]
v_exp_f32 v19, v19
v_cvt_pk_bf16_f32 v88, v16, v17
v_exp_f32 v20, v20
ds_read_b64_tr_b16 a[110:111], v4 offset:3840
v_exp_f32 v21, v21
v_cvt_pk_bf16_f32 v89, v18, v19
v_exp_f32 v22, v22
v_exp_f32 v23, v23
v_cvt_pk_bf16_f32 v90, v20, v21
v_exp_f32 v24, v24
v_exp_f32 v25, v25
v_cvt_pk_bf16_f32 v91, v22, v23
v_exp_f32 v26, v26
v_exp_f32 v27, v27
v_cvt_pk_bf16_f32 v92, v24, v25
v_exp_f32 v28, v28
v_exp_f32 v29, v29
v_cvt_pk_bf16_f32 v93, v26, v27
v_exp_f32 v30, v30
v_exp_f32 v31, v31
v_cvt_pk_bf16_f32 v94, v28, v29
v_cvt_pk_bf16_f32 v95, v30, v31
L_fl1_80:
s_waitcnt lgkmcnt(0)
v_mfma_f32_32x32x16_bf16 v[96:111], a[104:107], v[88:91], v[96:111]
v_mfma_f32_32x32x16_bf16 v[96:111], a[108:111], v[92:95], v[96:111]
s_branch L_p2e_78
L_fl0_79:
s_waitcnt lgkmcnt(0)
v_mfma_f32_32x32x16_bf16 v[96:111], a[96:99], v[80:83], v[96:111]
v_mfma_f32_32x32x16_bf16 v[96:111], a[100:103], v[84:87], v[96:111]
L_p2e_78:
s_nop 7
s_nop 7
v_mov_b32 v8, v104
v_mov_b32 v9, v104
s_nop 1
v_permlane32_swap_b32 v8, v9
s_nop 1
s_branch L_norm_27
L_slow_32:
s_waitcnt lgkmcnt(0)
s_nop 7
s_nop 7
ds_read_b128 a[16:19], v6 offset:21504
ds_read_b64 a[20:21], v7 offset:20480
ds_read_b128 a[0:3], v6 offset:1024
ds_read_b64 a[4:5], v7 offset:0
ds_read_b128 a[8:11], v6 offset:18944
ds_read_b64 a[12:13], v7 offset:17920
s_waitcnt lgkmcnt(4)
v_mfma_f32_32x32x16_bf16 v[32:47], a[16:19], v[232:235], 0
v_mfma_f32_32x32x8bf16_1k v[32:47], a[20:21], v[238:239], v[32:47]
s_waitcnt lgkmcnt(2)
v_mfma_f32_32x32x16_bf16 v[16:31], a[0:3], v[232:235], 0
v_mfma_f32_32x32x8bf16_1k v[16:31], a[4:5], v[238:239], v[16:31]
ds_read_b128 a[0:3], v6 offset:16384
ds_read_b64 a[4:5], v7 offset:15360
s_nop 7
s_nop 4
s_cmp_eq_u32 s13, 0
s_cbranch_scc1 L_s1_81
v_mov_b32 v16, 0xff800000
v_mov_b32 v17, 0xff800000
v_mov_b32 v18, 0xff800000
v_mov_b32 v19, 0xff800000
v_mov_b32 v20, 0xff800000
v_mov_b32 v21, 0xff800000
v_mov_b32 v22, 0xff800000
v_mov_b32 v23, 0xff800000
v_mov_b32 v24, 0xff800000
v_mov_b32 v25, 0xff800000
v_mov_b32 v26, 0xff800000
v_mov_b32 v27, 0xff800000
v_mov_b32 v28, 0xff800000
v_mov_b32 v29, 0xff800000
v_mov_b32 v30, 0xff800000
v_mov_b32 v31, 0xff800000
L_s1_81:
v_cndmask_b32 v48, v16, v32, s[68:69]
v_cndmask_b32 v49, v17, v33, s[70:71]
v_cndmask_b32 v50, v18, v34, s[72:73]
v_cndmask_b32 v51, v19, v35, s[74:75]
v_cndmask_b32 v52, v20, v36, s[76:77]
v_cndmask_b32 v53, v21, v37, s[78:79]
v_cndmask_b32 v54, v22, v38, s[80:81]
v_cndmask_b32 v55, v23, v39, s[82:83]
v_cndmask_b32 v56, v24, v40, s[84:85]
v_cndmask_b32 v57, v25, v41, s[86:87]
v_cndmask_b32 v58, v26, v42, s[88:89]
v_cndmask_b32 v59, v27, v43, s[90:91]
v_cndmask_b32 v60, v28, v44, s[92:93]
v_cndmask_b32 v61, v29, v45, s[94:95]
v_cndmask_b32 v62, v30, v46, s[96:97]
v_cndmask_b32 v63, v31, v47, s[98:99]
s_waitcnt lgkmcnt(2)
v_mfma_f32_32x32x16_bf16 v[16:31], a[8:11], v[232:235], 0
v_mfma_f32_32x32x8bf16_1k v[16:31], a[12:13], v[238:239], v[16:31]
v_max3_f32 v8, v48, v49, v50
v_max3_f32 v8, v8, v51, v52
v_max3_f32 v8, v8, v53, v54
v_max3_f32 v8, v8, v55, v56
v_max3_f32 v8, v8, v57, v58
v_max3_f32 v8, v8, v59, v60
v_max3_f32 v8, v8, v61, v62
v_max_f32 v8, v8, v63
s_cmp_gt_u32 s13, 7
s_cbranch_scc1 L_p1d_82
ds_read_b128 a[16:19], v6 offset:13824
ds_read_b64 a[20:21], v7 offset:12800
s_waitcnt lgkmcnt(2)
v_mfma_f32_32x32x16_bf16 v[32:47], a[0:3], v[232:235], 0
v_max3_f32 v8, v8, v16, v17
v_max3_f32 v8, v8, v18, v19
v_max3_f32 v8, v8, v20, v21
v_max3_f32 v8, v8, v22, v23
v_mfma_f32_32x32x8bf16_1k v[32:47], a[4:5], v[238:239], v[32:47]
v_max3_f32 v8, v8, v24, v25
v_max3_f32 v8, v8, v26, v27
v_max3_f32 v8, v8, v28, v29
v_max3_f32 v8, v8, v30, v31
s_cmp_gt_u32 s13, 6
s_cbranch_scc1 L_p1d_82
ds_read_b128 a[8:11], v6 offset:11264
ds_read_b64 a[12:13], v7 offset:10240
s_waitcnt lgkmcnt(2)
v_mfma_f32_32x32x16_bf16 v[16:31], a[16:19], v[232:235], 0
s_nop 1
v_max3_f32 v8, v8, v32, v33
v_max3_f32 v8, v8, v34, v35
v_max3_f32 v8, v8, v36, v37
v_max3_f32 v8, v8, v38, v39
v_mfma_f32_32x32x8bf16_1k v[16:31], a[20:21], v[238:239], v[16:31]
v_max3_f32 v8, v8, v40, v41
v_max3_f32 v8, v8, v42, v43
v_max3_f32 v8, v8, v44, v45
v_max3_f32 v8, v8, v46, v47
s_cmp_gt_u32 s13, 5
s_cbranch_scc1 L_p1d_82
ds_read_b128 a[0:3], v6 offset:8704
ds_read_b64 a[4:5], v7 offset:7680
s_waitcnt lgkmcnt(2)
v_mfma_f32_32x32x16_bf16 v[32:47], a[8:11], v[232:235], 0
s_nop 1
v_max3_f32 v8, v8, v16, v17
v_max3_f32 v8, v8, v18, v19
v_max3_f32 v8, v8, v20, v21
v_max3_f32 v8, v8, v22, v23
v_mfma_f32_32x32x8bf16_1k v[32:47], a[12:13], v[238:239], v[32:47]
v_max3_f32 v8, v8, v24, v25
v_max3_f32 v8, v8, v26, v27
v_max3_f32 v8, v8, v28, v29
v_max3_f32 v8, v8, v30, v31
s_cmp_gt_u32 s13, 4
s_cbranch_scc1 L_p1d_82
ds_read_b128 a[16:19], v6 offset:6144
ds_read_b64 a[20:21], v7 offset:5120
s_waitcnt lgkmcnt(2)
v_mfma_f32_32x32x16_bf16 v[16:31], a[0:3], v[232:235], 0
s_nop 1
v_max3_f32 v8, v8, v32, v33
v_max3_f32 v8, v8, v34, v35
v_max3_f32 v8, v8, v36, v37
v_max3_f32 v8, v8, v38, v39
v_mfma_f32_32x32x8bf16_1k v[16:31], a[4:5], v[238:239], v[16:31]
v_max3_f32 v8, v8, v40, v41
v_max3_f32 v8, v8, v42, v43
v_max3_f32 v8, v8, v44, v45
v_max3_f32 v8, v8, v46, v47
s_cmp_gt_u32 s13, 3
s_cbranch_scc1 L_p1d_82
ds_read_b128 a[8:11], v6 offset:3584
ds_read_b64 a[12:13], v7 offset:2560
s_waitcnt lgkmcnt(2)
v_mfma_f32_32x32x16_bf16 v[32:47], a[16:19], v[232:235], 0
s_nop 1
v_max3_f32 v8, v8, v16, v17
v_max3_f32 v8, v8, v18, v19
v_max3_f32 v8, v8, v20, v21
v_max3_f32 v8, v8, v22, v23
v_mfma_f32_32x32x8bf16_1k v[32:47], a[20:21], v[238:239], v[32:47]
v_max3_f32 v8, v8, v24, v25
v_max3_f32 v8, v8, v26, v27
v_max3_f32 v8, v8, v28, v29
v_max3_f32 v8, v8, v30, v31
s_cmp_gt_u32 s13, 2
s_cbranch_scc1 L_p1d_82
s_waitcnt lgkmcnt(0)
v_mfma_f32_32x32x16_bf16 v[16:31], a[8:11], v[232:235], 0
s_nop 3
v_max3_f32 v8, v8, v32, v33
v_max3_f32 v8, v8, v34, v35
v_max3_f32 v8, v8, v36, v37
v_max3_f32 v8, v8, v38, v39
v_mfma_f32_32x32x8bf16_1k v[16:31], a[12:13], v[238:239], v[16:31]
v_max3_f32 v8, v8, v40, v41
v_max3_f32 v8, v8, v42, v43
v_max3_f32 v8, v8, v44, v45
v_max3_f32 v8, v8, v46, v47
s_cmp_gt_u32 s13, 1
s_cbranch_scc1 L_p1d_82
s_nop 7
s_nop 3
v_max3_f32 v8, v8, v16, v17
v_max3_f32 v8, v8, v18, v19
v_max3_f32 v8, v8, v20, v21
v_max3_f32 v8, v8, v22, v23
v_max3_f32 v8, v8, v24, v25
v_max3_f32 v8, v8, v26, v27
v_max3_f32 v8, v8, v28, v29
v_max3_f32 v8, v8, v30, v31
L_p1d_82:
s_waitcnt lgkmcnt(0)
ds_read_b128 a[8:11], v6 offset:18944
ds_read_b64 a[12:13], v7 offset:17920
ds_read_b64_tr_b16 a[96:97], v5 offset:24576
ds_read_b64_tr_b16 a[98:99], v5 offset:24832
ds_read_b64_tr_b16 a[100:101], v5 offset:25088
ds_read_b64_tr_b16 a[102:103], v5 offset:25344
ds_read_b64_tr_b16 a[104:105], v5 offset:0
ds_read_b64_tr_b16 a[106:107], v5 offset:256
ds_read_b64_tr_b16 a[108:109], v5 offset:512
ds_read_b64_tr_b16 a[110:111], v5 offset:768
ds_read_b128 a[0:3], v6 offset:16384
ds_read_b64 a[4:5], v7 offset:15360
v_mov_b32 v9, v8
s_nop 1
v_permlane32_swap_b32 v8, v9
v_max_f32 v8, v8, v9
v_sub_f32 v9, 0, v8
v_mov_b32 v64, v9
v_mov_b32 v65, v9
v_mov_b32 v66, v9
v_mov_b32 v67, v9
v_mov_b32 v68, v9
v_mov_b32 v69, v9
v_mov_b32 v70, v9
v_mov_b32 v71, v9
v_mov_b32 v72, v9
v_mov_b32 v73, v9
v_mov_b32 v74, v9
v_mov_b32 v75, v9
v_mov_b32 v76, v9
v_mov_b32 v77, v9
v_mov_b32 v78, v9
v_mov_b32 v79, v9
s_waitcnt lgkmcnt(10)
s_nop 0
v_mfma_f32_32x32x16_bf16 v[16:31], a[8:11], v[232:235], v[64:79]
v_add_f32 v48, v48, v9
v_add_f32 v49, v49, v9
v_add_f32 v50, v50, v9
v_add_f32 v51, v51, v9
v_add_f32 v52, v52, v9
v_add_f32 v53, v53, v9
v_add_f32 v54, v54, v9
v_add_f32 v55, v55, v9
v_mfma_f32_32x32x8bf16_1k v[16:31], a[12:13], v[238:239], v[16:31]
v_add_f32 v56, v56, v9
v_add_f32 v57, v57, v9
v_add_f32 v58, v58, v9
v_add_f32 v59, v59, v9
v_add_f32 v60, v60, v9
v_add_f32 v61, v61, v9
v_add_f32 v62, v62, v9
v_add_f32 v63, v63, v9
v_exp_f32 v48, v48
v_exp_f32 v49, v49
v_exp_f32 v50, v50
v_exp_f32 v51, v51
v_exp_f32 v52, v52
v_exp_f32 v53, v53
v_exp_f32 v54, v54
v_exp_f32 v55, v55
v_exp_f32 v56, v56
v_exp_f32 v57, v57
v_exp_f32 v58, v58
v_exp_f32 v59, v59
v_exp_f32 v60, v60
v_exp_f32 v61, v61
v_exp_f32 v62, v62
v_exp_f32 v63, v63
v_cvt_pk_bf16_f32 v80, v48, v49
v_cvt_pk_bf16_f32 v81, v50, v51
v_cvt_pk_bf16_f32 v82, v52, v53
v_cvt_pk_bf16_f32 v83, v54, v55
v_cvt_pk_bf16_f32 v84, v56, v57
v_cvt_pk_bf16_f32 v85, v58, v59
v_cvt_pk_bf16_f32 v86, v60, v61
v_cvt_pk_bf16_f32 v87, v62, v63
v_and_b32 v88, v112, v80
v_and_b32 v89, v113, v81
v_and_b32 v90, v114, v82
v_and_b32 v91, v115, v83
v_and_b32 v92, v116, v84
v_and_b32 v93, v117, v85
v_and_b32 v94, v118, v86
v_and_b32 v95, v119, v87
s_waitcnt lgkmcnt(2)
v_mfma_f32_32x32x16_bf16 v[96:111], a[96:99], v[88:91], 0
v_xor_b32 v80, v80, v88
v_xor_b32 v81, v81, v89
v_xor_b32 v82, v82, v90
v_xor_b32 v83, v83, v91
v_mfma_f32_32x32x16_bf16 v[96:111], a[100:103], v[92:95], v[96:111]
v_xor_b32 v84, v84, v92
v_xor_b32 v85, v85, v93
v_xor_b32 v86, v86, v94
v_xor_b32 v87, v87, v95
s_cmp_eq_u32 s13, 0
s_cbranch_scc0 L_v0_83
v_mfma_f32_32x32x16_bf16 v[96:111], a[104:107], v[80:83], v[96:111]
v_mfma_f32_32x32x16_bf16 v[96:111], a[108:111], v[84:87], v[96:111]
L_v0_83:
s_cmp_gt_u32 s13, 7
s_cbranch_scc1 L_p2e_84
s_waitcnt lgkmcnt(0)
v_mfma_f32_32x32x16_bf16 v[32:47], a[0:3], v[232:235], v[64:79]
v_exp_f32 v16, v16
v_exp_f32 v17, v17
v_exp_f32 v18, v18
ds_read_b64_tr_b16 a[104:105], v5 offset:21504
ds_read_b64_tr_b16 a[106:107], v5 offset:21760
ds_read_b64_tr_b16 a[108:109], v5 offset:22016
v_mfma_f32_32x32x8bf16_1k v[32:47], a[4:5], v[238:239], v[32:47]
v_exp_f32 v19, v19
v_cvt_pk_bf16_f32 v88, v16, v17
v_exp_f32 v20, v20
ds_read_b64_tr_b16 a[110:111], v5 offset:22272
ds_read_b128 a[16:19], v6 offset:13824
ds_read_b64 a[20:21], v7 offset:12800
v_exp_f32 v21, v21
v_cvt_pk_bf16_f32 v89, v18, v19
v_exp_f32 v22, v22
v_exp_f32 v23, v23
v_cvt_pk_bf16_f32 v90, v20, v21
v_exp_f32 v24, v24
v_exp_f32 v25, v25
v_cvt_pk_bf16_f32 v91, v22, v23
v_exp_f32 v26, v26
v_exp_f32 v27, v27
v_cvt_pk_bf16_f32 v92, v24, v25
v_exp_f32 v28, v28
v_exp_f32 v29, v29
v_cvt_pk_bf16_f32 v93, v26, v27
v_exp_f32 v30, v30
v_exp_f32 v31, v31
v_cvt_pk_bf16_f32 v94, v28, v29
v_cvt_pk_bf16_f32 v95, v30, v31
s_cmp_gt_u32 s13, 6
s_cbranch_scc1 L_fl1_86
s_waitcnt lgkmcnt(0)
v_mfma_f32_32x32x16_bf16 v[96:111], a[104:107], v[88:91], v[96:111]
v_exp_f32 v32, v32
v_exp_f32 v33, v33
v_exp_f32 v34, v34
v_mfma_f32_32x32x16_bf16 v[96:111], a[108:111], v[92:95], v[96:111]
v_exp_f32 v35, v35
v_cvt_pk_bf16_f32 v80, v32, v33
v_exp_f32 v36, v36
v_mfma_f32_32x32x16_bf16 v[16:31], a[16:19], v[232:235], v[64:79]
v_exp_f32 v37, v37
v_cvt_pk_bf16_f32 v81, v34, v35
v_exp_f32 v38, v38
ds_read_b64_tr_b16 a[96:97], v5 offset:18432
ds_read_b64_tr_b16 a[98:99], v5 offset:18688
ds_read_b64_tr_b16 a[100:101], v5 offset:18944
v_mfma_f32_32x32x8bf16_1k v[16:31], a[20:21], v[238:239], v[16:31]
v_exp_f32 v39, v39
v_cvt_pk_bf16_f32 v82, v36, v37
v_exp_f32 v40, v40
ds_read_b64_tr_b16 a[102:103], v5 offset:19200
ds_read_b128 a[8:11], v6 offset:11264
ds_read_b64 a[12:13], v7 offset:10240
v_exp_f32 v41, v41
v_cvt_pk_bf16_f32 v83, v38, v39
v_exp_f32 v42, v42
v_exp_f32 v43, v43
v_cvt_pk_bf16_f32 v84, v40, v41
v_exp_f32 v44, v44
v_exp_f32 v45, v45
v_cvt_pk_bf16_f32 v85, v42, v43
v_exp_f32 v46, v46
v_exp_f32 v47, v47
v_cvt_pk_bf16_f32 v86, v44, v45
v_cvt_pk_bf16_f32 v87, v46, v47
s_cmp_gt_u32 s13, 5
s_cbranch_scc1 L_fl0_85
s_waitcnt lgkmcnt(0)
v_mfma_f32_32x32x16_bf16 v[96:111], a[96:99], v[80:83], v[96:111]
v_exp_f32 v16, v16
v_exp_f32 v17, v17
v_exp_f32 v18, v18
v_mfma_f32_32x32x16_bf16 v[96:111], a[100:103], v[84:87], v[96:111]
v_exp_f32 v19, v19
v_cvt_pk_bf16_f32 v88, v16, v17
v_exp_f32 v20, v20
v_mfma_f32_32x32x16_bf16 v[32:47], a[8:11], v[232:235], v[64:79]
v_exp_f32 v21, v21
v_cvt_pk_bf16_f32 v89, v18, v19
v_exp_f32 v22, v22
ds_read_b64_tr_b16 a[104:105], v5 offset:15360
ds_read_b64_tr_b16 a[106:107], v5 offset:15616
ds_read_b64_tr_b16 a[108:109], v5 offset:15872
v_mfma_f32_32x32x8bf16_1k v[32:47], a[12:13], v[238:239], v[32:47]
v_exp_f32 v23, v23
v_cvt_pk_bf16_f32 v90, v20, v21
v_exp_f32 v24, v24
ds_read_b64_tr_b16 a[110:111], v5 offset:16128
ds_read_b128 a[0:3], v6 offset:8704
ds_read_b64 a[4:5], v7 offset:7680
v_exp_f32 v25, v25
v_cvt_pk_bf16_f32 v91, v22, v23
v_exp_f32 v26, v26
v_exp_f32 v27, v27
v_cvt_pk_bf16_f32 v92, v24, v25
v_exp_f32 v28, v28
v_exp_f32 v29, v29
v_cvt_pk_bf16_f32 v93, v26, v27
v_exp_f32 v30, v30
v_exp_f32 v31, v31
v_cvt_pk_bf16_f32 v94, v28, v29
v_cvt_pk_bf16_f32 v95, v30, v31
s_cmp_gt_u32 s13, 4
s_cbranch_scc1 L_fl1_86
s_waitcnt lgkmcnt(0)
v_mfma_f32_32x32x16_bf16 v[96:111], a[104:107], v[88:91], v[96:111]
v_exp_f32 v32, v32
v_exp_f32 v33, v33
v_exp_f32 v34, v34
v_mfma_f32_32x32x16_bf16 v[96:111], a[108:111], v[92:95], v[96:111]
v_exp_f32 v35, v35
v_cvt_pk_bf16_f32 v80, v32, v33
v_exp_f32 v36, v36
v_mfma_f32_32x32x16_bf16 v[16:31], a[0:3], v[232:235], v[64:79]
v_exp_f32 v37, v37
v_cvt_pk_bf16_f32 v81, v34, v35
v_exp_f32 v38, v38
ds_read_b64_tr_b16 a[96:97], v5 offset:12288
ds_read_b64_tr_b16 a[98:99], v5 offset:12544
ds_read_b64_tr_b16 a[100:101], v5 offset:12800
v_mfma_f32_32x32x8bf16_1k v[16:31], a[4:5], v[238:239], v[16:31]
v_exp_f32 v39, v39
v_cvt_pk_bf16_f32 v82, v36, v37
v_exp_f32 v40, v40
ds_read_b64_tr_b16 a[102:103], v5 offset:13056
ds_read_b128 a[16:19], v6 offset:6144
ds_read_b64 a[20:21], v7 offset:5120
v_exp_f32 v41, v41
v_cvt_pk_bf16_f32 v83, v38, v39
v_exp_f32 v42, v42
v_exp_f32 v43, v43
v_cvt_pk_bf16_f32 v84, v40, v41
v_exp_f32 v44, v44
v_exp_f32 v45, v45
v_cvt_pk_bf16_f32 v85, v42, v43
v_exp_f32 v46, v46
v_exp_f32 v47, v47
v_cvt_pk_bf16_f32 v86, v44, v45
v_cvt_pk_bf16_f32 v87, v46, v47
s_cmp_gt_u32 s13, 3
s_cbranch_scc1 L_fl0_85
s_waitcnt lgkmcnt(0)
v_mfma_f32_32x32x16_bf16 v[96:111], a[96:99], v[80:83], v[96:111]
v_exp_f32 v16, v16
v_exp_f32 v17, v17
v_exp_f32 v18, v18
v_mfma_f32_32x32x16_bf16 v[96:111], a[100:103], v[84:87], v[96:111]
v_exp_f32 v19, v19
v_cvt_pk_bf16_f32 v88, v16, v17
v_exp_f32 v20, v20
v_mfma_f32_32x32x16_bf16 v[32:47], a[16:19], v[232:235], v[64:79]
v_exp_f32 v21, v21
v_cvt_pk_bf16_f32 v89, v18, v19
v_exp_f32 v22, v22
ds_read_b64_tr_b16 a[104:105], v5 offset:9216
ds_read_b64_tr_b16 a[106:107], v5 offset:9472
ds_read_b64_tr_b16 a[108:109], v5 offset:9728
v_mfma_f32_32x32x8bf16_1k v[32:47], a[20:21], v[238:239], v[32:47]
v_exp_f32 v23, v23
v_cvt_pk_bf16_f32 v90, v20, v21
v_exp_f32 v24, v24
ds_read_b64_tr_b16 a[110:111], v5 offset:9984
ds_read_b128 a[8:11], v6 offset:3584
ds_read_b64 a[12:13], v7 offset:2560
v_exp_f32 v25, v25
v_cvt_pk_bf16_f32 v91, v22, v23
v_exp_f32 v26, v26
v_exp_f32 v27, v27
v_cvt_pk_bf16_f32 v92, v24, v25
v_exp_f32 v28, v28
v_exp_f32 v29, v29
v_cvt_pk_bf16_f32 v93, v26, v27
v_exp_f32 v30, v30
v_exp_f32 v31, v31
v_cvt_pk_bf16_f32 v94, v28, v29
v_cvt_pk_bf16_f32 v95, v30, v31
s_cmp_gt_u32 s13, 2
s_cbranch_scc1 L_fl1_86
s_waitcnt lgkmcnt(0)
v_mfma_f32_32x32x16_bf16 v[96:111], a[104:107], v[88:91], v[96:111]
v_exp_f32 v32, v32
v_exp_f32 v33, v33
v_exp_f32 v34, v34
v_mfma_f32_32x32x16_bf16 v[96:111], a[108:111], v[92:95], v[96:111]
v_exp_f32 v35, v35
v_cvt_pk_bf16_f32 v80, v32, v33
v_exp_f32 v36, v36
v_mfma_f32_32x32x16_bf16 v[16:31], a[8:11], v[232:235], v[64:79]
v_exp_f32 v37, v37
v_cvt_pk_bf16_f32 v81, v34, v35
v_exp_f32 v38, v38
ds_read_b64_tr_b16 a[96:97], v5 offset:6144
ds_read_b64_tr_b16 a[98:99], v5 offset:6400
ds_read_b64_tr_b16 a[100:101], v5 offset:6656
v_mfma_f32_32x32x8bf16_1k v[16:31], a[12:13], v[238:239], v[16:31]
v_exp_f32 v39, v39
v_cvt_pk_bf16_f32 v82, v36, v37
v_exp_f32 v40, v40
ds_read_b64_tr_b16 a[102:103], v5 offset:6912
v_exp_f32 v41, v41
v_cvt_pk_bf16_f32 v83, v38, v39
v_exp_f32 v42, v42
v_exp_f32 v43, v43
v_cvt_pk_bf16_f32 v84, v40, v41
v_exp_f32 v44, v44
v_exp_f32 v45, v45
v_cvt_pk_bf16_f32 v85, v42, v43
v_exp_f32 v46, v46
v_exp_f32 v47, v47
v_cvt_pk_bf16_f32 v86, v44, v45
v_cvt_pk_bf16_f32 v87, v46, v47
s_cmp_gt_u32 s13, 1
s_cbranch_scc1 L_fl0_85
s_waitcnt lgkmcnt(0)
v_mfma_f32_32x32x16_bf16 v[96:111], a[96:99], v[80:83], v[96:111]
v_exp_f32 v16, v16
v_exp_f32 v17, v17
v_exp_f32 v18, v18
ds_read_b64_tr_b16 a[104:105], v5 offset:3072
ds_read_b64_tr_b16 a[106:107], v5 offset:3328
ds_read_b64_tr_b16 a[108:109], v5 offset:3584
v_mfma_f32_32x32x16_bf16 v[96:111], a[100:103], v[84:87], v[96:111]
v_exp_f32 v19, v19
v_cvt_pk_bf16_f32 v88, v16, v17
v_exp_f32 v20, v20
ds_read_b64_tr_b16 a[110:111], v5 offset:3840
v_exp_f32 v21, v21
v_cvt_pk_bf16_f32 v89, v18, v19
v_exp_f32 v22, v22
v_exp_f32 v23, v23
v_cvt_pk_bf16_f32 v90, v20, v21
v_exp_f32 v24, v24
v_exp_f32 v25, v25
v_cvt_pk_bf16_f32 v91, v22, v23
v_exp_f32 v26, v26
v_exp_f32 v27, v27
v_cvt_pk_bf16_f32 v92, v24, v25
v_exp_f32 v28, v28
v_exp_f32 v29, v29
v_cvt_pk_bf16_f32 v93, v26, v27
v_exp_f32 v30, v30
v_exp_f32 v31, v31
v_cvt_pk_bf16_f32 v94, v28, v29
v_cvt_pk_bf16_f32 v95, v30, v31
L_fl1_86:
s_waitcnt lgkmcnt(0)
v_mfma_f32_32x32x16_bf16 v[96:111], a[104:107], v[88:91], v[96:111]
v_mfma_f32_32x32x16_bf16 v[96:111], a[108:111], v[92:95], v[96:111]
s_branch L_p2e_84
L_fl0_85:
s_waitcnt lgkmcnt(0)
v_mfma_f32_32x32x16_bf16 v[96:111], a[96:99], v[80:83], v[96:111]
v_mfma_f32_32x32x16_bf16 v[96:111], a[100:103], v[84:87], v[96:111]
L_p2e_84:
s_nop 7
s_nop 7
v_mov_b32 v8, v96
v_mov_b32 v9, v96
s_nop 1
v_permlane32_swap_b32 v8, v9
s_nop 1
s_branch L_norm_33
L_code_end:
.section .rodata,"a"
.p2align 6
.amdhsa_kernel adaLN_cond__sliding_block__mixer_channel_mlp__prompt_kernel
  .amdhsa_next_free_vgpr 512
  .amdhsa_next_free_sgpr 102
  .amdhsa_accum_offset 256
  .amdhsa_group_segment_fixed_size 0
  .amdhsa_kernarg_size 104
  .amdhsa_user_sgpr_count 2
  .amdhsa_user_sgpr_kernarg_segment_ptr 1
  .amdhsa_system_sgpr_workgroup_id_x 1
  .amdhsa_float_denorm_mode_32 3
.end_amdhsa_kernel
```
